```python
import torch

def _softmax(x, axis=-1):
    return torch.softmax(x, dim=axis)
def _gelu(x):
    return torch.nn.functional.gelu(x, approximate="tanh")
def _silu(x):
    return torch.nn.functional.silu(x)
def _sigmoid(x):
    return torch.sigmoid(x)
def _layernorm(x, axis=-1, eps=1e-5):
    m = x.mean(dim=axis, keepdim=True)
    v = x.var(dim=axis, keepdim=True, unbiased=False)
    return (x - m) / torch.sqrt(v + eps)
def _scatter_add(tgt, idx, src, axis=0):
    return tgt.clone().index_add_(axis, idx, src)
def _segment_sum(src, seg, n):
    out = torch.zeros((n,) + src.shape[1:], dtype=src.dtype)
    return out.index_add_(0, seg, src)
def _pad(x, pw):
    flat = tuple(v for pair in reversed(pw) for v in pair)
    return torch.nn.functional.pad(x, flat)

kernel_name = 'parallel_sum__mha_block__moe_arch_mod__prompt'

def setup_inputs():

    _w = (lambda a: (lambda t: t.to(torch.bfloat16) if t.is_floating_point() else t)(torch.as_tensor(a)))
    def _A_setup():
        B, S, D, H = 1, 2048, 640, 32
        return {
            "x": _w((lambda *s: torch.randn(*s, dtype=torch.bfloat16) * 0.05)(B, S, D)),
            "wqkv": _w((lambda *s: torch.randn(*s, dtype=torch.bfloat16) * 0.1)(D, 3 * D)),
            "wo": _w((lambda *s: torch.randn(*s, dtype=torch.bfloat16) * 0.05)(D, D)),
        }
    _A_in = _A_setup()

    def _B_setup():
        B, S, D, F, C = 1, 2048, 640, 1536, 2
        return {
            "x": _w((lambda *s: torch.randn(*s, dtype=torch.bfloat16) * 0.05)(B, S, D)),
            "w_r": _w((lambda *s: torch.randn(*s, dtype=torch.bfloat16) * 3.2)(D)),
            "w_gate": _w((lambda *s: torch.randn(*s, dtype=torch.bfloat16) * 0.1)(D, F)),
            "w_up": _w((lambda *s: torch.randn(*s, dtype=torch.bfloat16) * 0.1)(D, F)),
            "w_down": _w((lambda *s: torch.randn(*s, dtype=torch.bfloat16) * 0.1)(F, D)),
        }
    _B_in = _B_setup()

    return {
        "A_x": _A_in["x"],
        "A_wqkv": _A_in["wqkv"],
        "A_wo": _A_in["wo"],
        "B_x": _B_in["x"],
        "B_w_r": _B_in["w_r"],
        "B_w_gate": _B_in["w_gate"],
        "B_w_up": _B_in["w_up"],
        "B_w_down": _B_in["w_down"],
    }

def reference(A_x, A_wqkv, A_wo, B_x, B_w_r, B_w_gate, B_w_up, B_w_down):
    def _A_ref(x, wqkv, wo):
        B, S, D = x.shape
        H = 32
        Dh = D // H
        qkv = (lambda x, *d: x.permute(*d))((x @ wqkv).reshape(B, S, 3, H, Dh), 2, 0, 3, 1, 4)
        q, k, v = qkv[0], qkv[1], qkv[2]
        scores = torch.einsum("bhqd,bhkd->bhqk", q, k) * (Dh ** -0.5)
        p = _softmax(scores, axis=-1)
        o = torch.einsum("bhqk,bhkd->bhqd", p, v)
        return (lambda x, *d: x.permute(*d))(o, 0, 2, 1, 3).reshape(B, S, D) @ wo

    def _B_ref(x, w_r, w_gate, w_up, w_down):
        B, S, D = x.shape
        C = 2
        r = x @ w_r
        idx = torch.argsort(-r, axis=-1)[:, :C]
        idx_e = (lambda x, n, axis: torch.repeat_interleave(x, n, dim=axis))(idx.reshape(B, C, 1), D, axis=2)
        x_sel = (lambda x, i, axis: torch.take_along_dim(x, i, dim=axis))(x, idx_e, axis=1)
        g = _silu(x_sel @ w_gate)
        u = x_sel @ w_up
        y = (g * u) @ w_down
        r_sel = _sigmoid((lambda x, i, axis: torch.take_along_dim(x, i, dim=axis))(r, idx, axis=1))
        y = y * r_sel.reshape(B, C, 1)
        b_off = (torch.arange(B) * S).reshape(B, 1)
        flat_idx = (idx + b_off).reshape(B * C)
        zero = (x * 0.0).reshape(B * S, D)
        upd = _scatter_add(zero, flat_idx, y.reshape(B * C, D), axis=0)
        return x + upd.reshape(B, S, D)

    x = A_x
    xn = _layernorm(x, axis=-1)
    return x + _A_ref(xn, A_wqkv, A_wo) + _B_ref(xn, B_w_r, B_w_gate, B_w_up, B_w_down)
```

```asm
; @launch kernel=qkv_kernel grid=(256,1,1) block=(768,1,1) lds=133120
; @launch kernel=attn_proj_kernel grid=(256,1,1) block=(768,1,1) lds=163840
.amdgcn_target "amdgcn-amd-amdhsa--gfx950"
.text
.globl qkv_kernel
.p2align 8
.type qkv_kernel,@function
qkv_kernel:
    s_cmp_ge_u32 s2, 256
    s_cbranch_scc1 L_k1_exit
    s_load_dwordx4 s[4:7], s[0:1], 0
    s_load_dwordx2 s[36:37], s[0:1], 80
    s_load_dwordx2 s[38:39], s[0:1], 32
    v_lshrrev_b32 v4, 6, v0
    v_and_b32 v1, 63, v0
    v_readfirstlane_b32 s20, v4
    s_and_b32 s24, s2, 3
    s_lshl_b32 s24, s24, 2
    s_bfe_u32 s25, s2, 0x20003
    s_or_b32 s21, s24, s25
    s_bfe_u32 s24, s2, 0x10002
    s_lshl_b32 s24, s24, 3
    s_lshr_b32 s25, s2, 5
    s_or_b32 s22, s24, s25
    s_lshl_b32 s23, s21, 7
    v_and_b32 v2, 31, v1
    v_lshrrev_b32 v3, 5, v1
    s_waitcnt lgkmcnt(0)
    s_mov_b32 s8, s4
    s_and_b32 s9, s5, 0xffff
    s_mov_b32 s10, 2621440
    s_mov_b32 s11, 0x00020000
    s_mov_b32 s12, s6
    s_and_b32 s13, s7, 0xffff
    s_mov_b32 s14, 2457600
    s_mov_b32 s15, 0x00020000
    s_mov_b32 s16, s36
    s_and_b32 s17, s37, 0xffff
    s_mov_b32 s18, 11993088
    s_mov_b32 s19, 0x00020000
    s_cmp_eq_u32 s22, 15
    s_cbranch_scc1 L_k1_aux
    s_cmp_ge_u32 s20, 8
    s_cbranch_scc1 L_k1_stat
    s_cmp_ge_u32 s20, 4
    s_cbranch_scc1 L_k1_loader
    s_lshr_b32 s34, s20, 1
    s_and_b32 s35, s20, 1
    v_lshrrev_b32 v4, 1, v2
    v_and_b32 v4, 7, v4
    s_lshl_b32 s24, s34, 6
    v_add_u32 v5, s24, v2
    v_lshlrev_b32 v5, 7, v5
    s_lshl_b32 s24, s35, 12
    s_xor_b32 s25, s24, 4096
    v_add_u32 v6, 0, v3
    v_xor_b32 v6, v6, v4
    v_lshl_add_u32 v6, v6, 4, v5
    v_add_u32 v8, s24, v6
    v_add_u32 v12, s25, v6
    v_add_u32 v6, 2, v3
    v_xor_b32 v6, v6, v4
    v_lshl_add_u32 v6, v6, 4, v5
    v_add_u32 v9, s24, v6
    v_add_u32 v13, s25, v6
    v_add_u32 v6, 4, v3
    v_xor_b32 v6, v6, v4
    v_lshl_add_u32 v6, v6, 4, v5
    v_add_u32 v10, s24, v6
    v_add_u32 v14, s25, v6
    v_add_u32 v6, 6, v3
    v_xor_b32 v6, v6, v4
    v_lshl_add_u32 v6, v6, 4, v5
    v_add_u32 v11, s24, v6
    v_add_u32 v15, s25, v6
    s_sub_u32 s45, s22, 5
    s_cmp_lt_u32 s22, 5
    s_cselect_b32 s45, s22, s45
    s_mov_b32 s24, 0x76543210
    s_cmp_eq_u32 s45, 0
    s_cselect_b32 s24, 0xc765ba10, s24
    s_cmp_eq_u32 s45, 1
    s_cselect_b32 s24, 0x61875432, s24
    s_cmp_eq_u32 s45, 2
    s_cselect_b32 s24, 0x50764321, s24
    s_cmp_eq_u32 s45, 3
    s_cselect_b32 s24, 0xf4653210, s24
    s_cmp_eq_u32 s45, 4
    s_cselect_b32 s24, 0xd076cb21, s24
    s_mov_b32 s25, 0xfedcba98
    s_cmp_eq_u32 s45, 0
    s_cselect_b32 s25, 0xf298ed43, s25
    s_cmp_eq_u32 s45, 1
    s_cselect_b32 s25, 0xb0a9fedc, s25
    s_cmp_eq_u32 s45, 2
    s_cselect_b32 s25, 0xfa98edcb, s25
    s_cmp_eq_u32 s45, 3
    s_cselect_b32 s25, 0xe987dcba, s25
    s_cmp_eq_u32 s45, 4
    s_cselect_b32 s25, 0x83a9fe54, s25
    s_cmp_eq_u32 s35, 0
    s_cselect_b32 s44, s24, s25
    v_bfe_u32 v4, v1, 2, 2
    v_lshl_add_u32 v5, v3, 3, v4
    v_lshlrev_b32 v5, 8, v5
    v_and_b32 v6, 1, v1
    v_lshl_add_u32 v5, v6, 3, v5
    v_bfe_u32 v6, v1, 4, 1
    v_bfe_u32 v7, v1, 1, 1
    v_lshl_add_u32 v6, v6, 1, v7
    v_lshlrev_b32 v6, 2, v6
    v_lshlrev_b32 v4, 2, v4
    s_lshl_b32 s24, s34, 4
    s_lshr_b32 s24, s44, s24
    v_mov_b32 v7, s24
    v_lshrrev_b32 v7, v6, v7
    v_and_b32 v7, 15, v7
    v_xor_b32 v7, v7, v4
    v_lshl_add_u32 v16, v7, 4, v5
    s_xor_b32 s24, s34, 1
    s_lshl_b32 s24, s24, 4
    s_lshr_b32 s24, s44, s24
    v_mov_b32 v7, s24
    v_lshrrev_b32 v7, v6, v7
    v_and_b32 v7, 15, v7
    v_xor_b32 v7, v7, v4
    v_lshl_add_u32 v17, v7, 4, v5
    v_and_b32 v4, 15, v1
    v_bfe_u32 v5, v1, 4, 1
    v_cmp_eq_u32 vcc, v4, v5
    v_mov_b32 v6, 0x3f803f80
    s_nop 0
    v_cndmask_b32 v136, 0, v6, vcc
    v_mov_b32 v137, v136
    v_mov_b32 v138, v136
    v_mov_b32 v139, v136
    v_mov_b32 v140, 0
    v_mov_b32 v141, 0
    v_mov_b32 v142, 0
    v_mov_b32 v143, 0
    v_mov_b32 v64, 0
    v_mov_b32 v65, 0
    v_mov_b32 v66, 0
    v_mov_b32 v67, 0
    v_mov_b32 v68, 0
    v_mov_b32 v69, 0
    v_mov_b32 v70, 0
    v_mov_b32 v71, 0
    v_mov_b32 v72, 0
    v_mov_b32 v73, 0
    v_mov_b32 v74, 0
    v_mov_b32 v75, 0
    v_mov_b32 v76, 0
    v_mov_b32 v77, 0
    v_mov_b32 v78, 0
    v_mov_b32 v79, 0
    v_mov_b32 v80, 0
    v_mov_b32 v81, 0
    v_mov_b32 v82, 0
    v_mov_b32 v83, 0
    v_mov_b32 v84, 0
    v_mov_b32 v85, 0
    v_mov_b32 v86, 0
    v_mov_b32 v87, 0
    v_mov_b32 v88, 0
    v_mov_b32 v89, 0
    v_mov_b32 v90, 0
    v_mov_b32 v91, 0
    v_mov_b32 v92, 0
    v_mov_b32 v93, 0
    v_mov_b32 v94, 0
    v_mov_b32 v95, 0
    v_mov_b32 v96, 0
    v_mov_b32 v97, 0
    v_mov_b32 v98, 0
    v_mov_b32 v99, 0
    v_mov_b32 v100, 0
    v_mov_b32 v101, 0
    v_mov_b32 v102, 0
    v_mov_b32 v103, 0
    v_mov_b32 v104, 0
    v_mov_b32 v105, 0
    v_mov_b32 v106, 0
    v_mov_b32 v107, 0
    v_mov_b32 v108, 0
    v_mov_b32 v109, 0
    v_mov_b32 v110, 0
    v_mov_b32 v111, 0
    v_mov_b32 v112, 0
    v_mov_b32 v113, 0
    v_mov_b32 v114, 0
    v_mov_b32 v115, 0
    v_mov_b32 v116, 0
    v_mov_b32 v117, 0
    v_mov_b32 v118, 0
    v_mov_b32 v119, 0
    v_mov_b32 v120, 0
    v_mov_b32 v121, 0
    v_mov_b32 v122, 0
    v_mov_b32 v123, 0
    v_mov_b32 v124, 0
    v_mov_b32 v125, 0
    v_mov_b32 v126, 0
    v_mov_b32 v127, 0
    s_cmp_ge_u32 s22, 10
    s_cbranch_scc1 L_k1_v
L_k1_qk:
    s_mov_b32 s28, 2621440
    s_mov_b32 s30, 2560
    s_mov_b32 s31, 0x3f800000
    s_sub_u32 s24, s22, 5
    s_cmp_lt_u32 s22, 5
    s_cselect_b32 s28, 0, s28
    s_cselect_b32 s30, 1280, s30
    s_cselect_b32 s31, 0x3ea52b5c, s31
    s_cselect_b32 s24, s22, s24
    s_lshl_b32 s29, s30, 6
    s_lshl_b32 s25, s21, 2
    s_lshl_b32 s26, s34, 1
    s_add_u32 s25, s25, s26
    s_add_u32 s26, s25, s35
    s_mul_i32 s32, s26, s30
    s_add_u32 s32, s32, s28
    s_xor_b32 s27, s35, 1
    s_add_u32 s26, s25, s27
    s_mul_i32 s33, s26, s30
    s_add_u32 s33, s33, s28
    s_bfe_u32 s25, s44, 0x40000
    s_lshl_b32 s26, s45, 4
    s_add_u32 s25, s25, s26
    s_lshl_b32 s25, s25, 1
    v_add_u32 v4, s25, v3
    v_mul_u32_u24 v5, 52429, v4
    v_lshrrev_b32 v5, 18, v5
    v_mul_u32_u24 v6, 5, v5
    v_sub_u32 v6, v4, v6
    v_and_b32 v7, 1, v5
    v_sub_u32 v6, v6, v7
    v_mul_lo_u32 v128, v5, s29
    v_and_b32 v5, 1, v6
    v_lshlrev_b32 v5, 9, v5
    v_bfe_u32 v7, v6, 1, 1
    v_lshl_add_u32 v5, v7, 3, v5
    v_lshl_add_u32 v5, v2, 4, v5
    v_cmp_lt_u32 vcc, 3, v6
    v_lshlrev_b32 v7, 3, v2
    v_add_u32 v7, 1024, v7
    v_cndmask_b32 v5, v5, v7, vcc
    v_add_u32 v128, v128, v5
    s_bfe_u32 s25, s44, 0x40008
    s_lshl_b32 s26, s45, 4
    s_add_u32 s25, s25, s26
    s_lshl_b32 s25, s25, 1
    v_add_u32 v4, s25, v3
    v_mul_u32_u24 v5, 52429, v4
    v_lshrrev_b32 v5, 18, v5
    v_mul_u32_u24 v6, 5, v5
    v_sub_u32 v6, v4, v6
    v_and_b32 v7, 1, v5
    v_sub_u32 v6, v6, v7
    v_mul_lo_u32 v129, v5, s29
    v_and_b32 v5, 1, v6
    v_lshlrev_b32 v5, 9, v5
    v_bfe_u32 v7, v6, 1, 1
    v_lshl_add_u32 v5, v7, 3, v5
    v_lshl_add_u32 v5, v2, 4, v5
    v_cmp_lt_u32 vcc, 3, v6
    v_lshlrev_b32 v7, 3, v2
    v_add_u32 v7, 1024, v7
    v_cndmask_b32 v5, v5, v7, vcc
    v_add_u32 v129, v129, v5
    s_bfe_u32 s25, s44, 0x40010
    s_lshl_b32 s26, s45, 4
    s_add_u32 s25, s25, s26
    s_lshl_b32 s25, s25, 1
    v_add_u32 v4, s25, v3
    v_mul_u32_u24 v5, 52429, v4
    v_lshrrev_b32 v5, 18, v5
    v_mul_u32_u24 v6, 5, v5
    v_sub_u32 v6, v4, v6
    v_and_b32 v7, 1, v5
    v_sub_u32 v6, v6, v7
    v_mul_lo_u32 v130, v5, s29
    v_and_b32 v5, 1, v6
    v_lshlrev_b32 v5, 9, v5
    v_bfe_u32 v7, v6, 1, 1
    v_lshl_add_u32 v5, v7, 3, v5
    v_lshl_add_u32 v5, v2, 4, v5
    v_cmp_lt_u32 vcc, 3, v6
    v_lshlrev_b32 v7, 3, v2
    v_add_u32 v7, 1024, v7
    v_cndmask_b32 v5, v5, v7, vcc
    v_add_u32 v130, v130, v5
    s_bfe_u32 s25, s44, 0x40018
    s_lshl_b32 s26, s45, 4
    s_add_u32 s25, s25, s26
    s_lshl_b32 s25, s25, 1
    v_add_u32 v4, s25, v3
    v_mul_u32_u24 v5, 52429, v4
    v_lshrrev_b32 v5, 18, v5
    v_mul_u32_u24 v6, 5, v5
    v_sub_u32 v6, v4, v6
    v_and_b32 v7, 1, v5
    v_sub_u32 v6, v6, v7
    v_mul_lo_u32 v131, v5, s29
    v_and_b32 v5, 1, v6
    v_lshlrev_b32 v5, 9, v5
    v_bfe_u32 v7, v6, 1, 1
    v_lshl_add_u32 v5, v7, 3, v5
    v_lshl_add_u32 v5, v2, 4, v5
    v_cmp_lt_u32 vcc, 3, v6
    v_lshlrev_b32 v7, 3, v2
    v_add_u32 v7, 1024, v7
    v_cndmask_b32 v5, v5, v7, vcc
    v_add_u32 v131, v131, v5
    s_bfe_u32 s25, s44, 0x4001c
    s_lshl_b32 s26, s45, 4
    s_add_u32 s25, s25, s26
    s_lshl_b32 s25, s25, 1
    v_add_u32 v4, s25, v3
    v_mul_u32_u24 v5, 52429, v4
    v_lshrrev_b32 v5, 18, v5
    v_mul_u32_u24 v6, 5, v5
    v_sub_u32 v6, v4, v6
    v_and_b32 v7, 1, v5
    v_sub_u32 v6, v6, v7
    v_mul_lo_u32 v132, v5, s29
    v_and_b32 v5, 1, v6
    v_lshlrev_b32 v5, 9, v5
    v_bfe_u32 v7, v6, 1, 1
    v_lshl_add_u32 v5, v7, 3, v5
    v_lshl_add_u32 v5, v2, 4, v5
    v_cmp_lt_u32 vcc, 3, v6
    v_lshlrev_b32 v7, 3, v2
    v_add_u32 v7, 1024, v7
    v_cndmask_b32 v5, v5, v7, vcc
    v_add_u32 v132, v132, v5
    s_barrier
    ds_read_b128 v[32:35], v8 offset:0
    ds_read_b64_tr_b16 v[40:41], v16 offset:16384
    ds_read_b64_tr_b16 v[42:43], v16 offset:17408
    ds_read_b64_tr_b16 v[44:45], v17 offset:16384
    ds_read_b64_tr_b16 v[46:47], v17 offset:17408
    ds_read_b128 v[36:39], v12 offset:0
    s_mov_b32 s27, 5
.p2align 3
L_k1_loop_qk:
    s_waitcnt lgkmcnt(3)
    v_mfma_f32_32x32x16_bf16 v[64:79], v[40:43], v[32:35], v[64:79]
    ds_read_b128 v[48:51], v9 offset:0
    ds_read_b64_tr_b16 v[56:57], v16 offset:20480
    ds_read_b64_tr_b16 v[58:59], v16 offset:21504
    s_waitcnt lgkmcnt(4)
    v_mfma_f32_32x32x16_bf16 v[80:95], v[44:47], v[32:35], v[80:95]
    ds_read_b64_tr_b16 v[60:61], v17 offset:20480
    ds_read_b64_tr_b16 v[62:63], v17 offset:21504
    ds_read_b128 v[52:55], v13 offset:0
    s_waitcnt lgkmcnt(6)
    v_mfma_f32_32x32x16_bf16 v[96:111], v[40:43], v[36:39], v[96:111]
    v_mfma_f32_32x32x16_bf16 v[112:127], v[44:47], v[36:39], v[112:127]
    v_mfma_f32_16x16x32_bf16 v[140:143], v[136:139], v[40:43], v[140:143]
    s_waitcnt lgkmcnt(3)
    v_mfma_f32_32x32x16_bf16 v[64:79], v[56:59], v[48:51], v[64:79]
    ds_read_b128 v[32:35], v10 offset:0
    ds_read_b64_tr_b16 v[40:41], v16 offset:24576
    ds_read_b64_tr_b16 v[42:43], v16 offset:25600
    s_waitcnt lgkmcnt(4)
    v_mfma_f32_32x32x16_bf16 v[80:95], v[60:63], v[48:51], v[80:95]
    ds_read_b64_tr_b16 v[44:45], v17 offset:24576
    ds_read_b64_tr_b16 v[46:47], v17 offset:25600
    ds_read_b128 v[36:39], v14 offset:0
    s_waitcnt lgkmcnt(6)
    v_mfma_f32_32x32x16_bf16 v[96:111], v[56:59], v[52:55], v[96:111]
    v_mfma_f32_32x32x16_bf16 v[112:127], v[60:63], v[52:55], v[112:127]
    v_mfma_f32_16x16x32_bf16 v[140:143], v[136:139], v[56:59], v[140:143]
    s_waitcnt lgkmcnt(3)
    v_mfma_f32_32x32x16_bf16 v[64:79], v[40:43], v[32:35], v[64:79]
    ds_read_b128 v[48:51], v11 offset:0
    ds_read_b64_tr_b16 v[56:57], v16 offset:28672
    ds_read_b64_tr_b16 v[58:59], v16 offset:29696
    s_waitcnt lgkmcnt(4)
    v_mfma_f32_32x32x16_bf16 v[80:95], v[44:47], v[32:35], v[80:95]
    ds_read_b64_tr_b16 v[60:61], v17 offset:28672
    ds_read_b64_tr_b16 v[62:63], v17 offset:29696
    ds_read_b128 v[52:55], v15 offset:0
    s_waitcnt lgkmcnt(6)
    v_mfma_f32_32x32x16_bf16 v[96:111], v[40:43], v[36:39], v[96:111]
    v_mfma_f32_32x32x16_bf16 v[112:127], v[44:47], v[36:39], v[112:127]
    v_mfma_f32_16x16x32_bf16 v[140:143], v[136:139], v[40:43], v[140:143]
    s_waitcnt lgkmcnt(0)
    v_mfma_f32_32x32x16_bf16 v[64:79], v[56:59], v[48:51], v[64:79]
    v_mfma_f32_32x32x16_bf16 v[80:95], v[60:63], v[48:51], v[80:95]
    s_barrier
    ds_read_b128 v[32:35], v8 offset:32768
    ds_read_b64_tr_b16 v[40:41], v16 offset:49152
    ds_read_b64_tr_b16 v[42:43], v16 offset:50176
    v_mfma_f32_32x32x16_bf16 v[96:111], v[56:59], v[52:55], v[96:111]
    ds_read_b64_tr_b16 v[44:45], v17 offset:49152
    ds_read_b64_tr_b16 v[46:47], v17 offset:50176
    ds_read_b128 v[36:39], v12 offset:32768
    v_mfma_f32_32x32x16_bf16 v[112:127], v[60:63], v[52:55], v[112:127]
    v_mfma_f32_16x16x32_bf16 v[140:143], v[136:139], v[56:59], v[140:143]
    s_waitcnt lgkmcnt(3)
    v_mfma_f32_32x32x16_bf16 v[64:79], v[40:43], v[32:35], v[64:79]
    ds_read_b128 v[48:51], v9 offset:32768
    ds_read_b64_tr_b16 v[56:57], v16 offset:53248
    ds_read_b64_tr_b16 v[58:59], v16 offset:54272
    s_waitcnt lgkmcnt(4)
    v_mfma_f32_32x32x16_bf16 v[80:95], v[44:47], v[32:35], v[80:95]
    ds_read_b64_tr_b16 v[60:61], v17 offset:53248
    ds_read_b64_tr_b16 v[62:63], v17 offset:54272
    ds_read_b128 v[52:55], v13 offset:32768
    s_waitcnt lgkmcnt(6)
    v_mfma_f32_32x32x16_bf16 v[96:111], v[40:43], v[36:39], v[96:111]
    v_mfma_f32_32x32x16_bf16 v[112:127], v[44:47], v[36:39], v[112:127]
    v_mfma_f32_16x16x32_bf16 v[140:143], v[136:139], v[40:43], v[140:143]
    s_waitcnt lgkmcnt(3)
    v_mfma_f32_32x32x16_bf16 v[64:79], v[56:59], v[48:51], v[64:79]
    ds_read_b128 v[32:35], v10 offset:32768
    ds_read_b64_tr_b16 v[40:41], v16 offset:57344
    ds_read_b64_tr_b16 v[42:43], v16 offset:58368
    s_waitcnt lgkmcnt(4)
    v_mfma_f32_32x32x16_bf16 v[80:95], v[60:63], v[48:51], v[80:95]
    ds_read_b64_tr_b16 v[44:45], v17 offset:57344
    ds_read_b64_tr_b16 v[46:47], v17 offset:58368
    ds_read_b128 v[36:39], v14 offset:32768
    s_waitcnt lgkmcnt(6)
    v_mfma_f32_32x32x16_bf16 v[96:111], v[56:59], v[52:55], v[96:111]
    v_mfma_f32_32x32x16_bf16 v[112:127], v[60:63], v[52:55], v[112:127]
    v_mfma_f32_16x16x32_bf16 v[140:143], v[136:139], v[56:59], v[140:143]
    s_waitcnt lgkmcnt(3)
    v_mfma_f32_32x32x16_bf16 v[64:79], v[40:43], v[32:35], v[64:79]
    ds_read_b128 v[48:51], v11 offset:32768
    ds_read_b64_tr_b16 v[56:57], v16 offset:61440
    ds_read_b64_tr_b16 v[58:59], v16 offset:62464
    s_waitcnt lgkmcnt(4)
    v_mfma_f32_32x32x16_bf16 v[80:95], v[44:47], v[32:35], v[80:95]
    ds_read_b64_tr_b16 v[60:61], v17 offset:61440
    ds_read_b64_tr_b16 v[62:63], v17 offset:62464
    ds_read_b128 v[52:55], v15 offset:32768
    s_waitcnt lgkmcnt(6)
    v_mfma_f32_32x32x16_bf16 v[96:111], v[40:43], v[36:39], v[96:111]
    v_mfma_f32_32x32x16_bf16 v[112:127], v[44:47], v[36:39], v[112:127]
    v_mfma_f32_16x16x32_bf16 v[140:143], v[136:139], v[40:43], v[140:143]
    s_waitcnt lgkmcnt(0)
    v_mfma_f32_32x32x16_bf16 v[64:79], v[56:59], v[48:51], v[64:79]
    v_mfma_f32_32x32x16_bf16 v[80:95], v[60:63], v[48:51], v[80:95]
    s_sub_u32 s27, s27, 1
    s_cmp_eq_u32 s27, 0
    s_cbranch_scc1 L_k1_last_qk
    v_xor_b32 v8, 0x10000, v8
    v_xor_b32 v9, 0x10000, v9
    v_xor_b32 v10, 0x10000, v10
    v_xor_b32 v11, 0x10000, v11
    v_xor_b32 v12, 0x10000, v12
    v_xor_b32 v13, 0x10000, v13
    v_xor_b32 v14, 0x10000, v14
    v_xor_b32 v15, 0x10000, v15
    v_xor_b32 v16, 0x10000, v16
    v_xor_b32 v17, 0x10000, v17
    s_barrier
    ds_read_b128 v[32:35], v8 offset:0
    ds_read_b64_tr_b16 v[40:41], v16 offset:16384
    ds_read_b64_tr_b16 v[42:43], v16 offset:17408
    v_mfma_f32_32x32x16_bf16 v[96:111], v[56:59], v[52:55], v[96:111]
    ds_read_b64_tr_b16 v[44:45], v17 offset:16384
    ds_read_b64_tr_b16 v[46:47], v17 offset:17408
    ds_read_b128 v[36:39], v12 offset:0
    v_mfma_f32_32x32x16_bf16 v[112:127], v[60:63], v[52:55], v[112:127]
    v_mfma_f32_16x16x32_bf16 v[140:143], v[136:139], v[56:59], v[140:143]
    s_branch L_k1_loop_qk
L_k1_last_qk:
    v_mfma_f32_32x32x16_bf16 v[96:111], v[56:59], v[52:55], v[96:111]
    v_mfma_f32_32x32x16_bf16 v[112:127], v[60:63], v[52:55], v[112:127]
    v_mfma_f32_16x16x32_bf16 v[140:143], v[136:139], v[56:59], v[140:143]
    s_lshl_b32 s24, s35, 6
    s_lshl_b32 s25, s34, 5
    s_add_u32 s24, s24, s25
    v_add_u32 v5, s24, v1
    v_lshlrev_b32 v5, 2, v5
    v_add_u32 v5, 132096, v5
    s_mov_b64 exec, 0xffff
    s_nop 4
    ds_write_b32 v5, v140
    ds_write_b32 v5, v141 offset:64
    s_mov_b64 exec, -1
    s_waitcnt lgkmcnt(0)
    s_barrier
    s_lshl_b32 s24, s34, 6
    v_add_u32 v4, s24, v2
    v_lshlrev_b32 v4, 2, v4
    s_lshl_b32 s25, s35, 7
    v_add_u32 v5, s25, v4
    s_xor_b32 s25, s25, 128
    v_add_u32 v6, s25, v4
    v_add_u32 v5, 131072, v5
    v_add_u32 v6, 131072, v6
    ds_read_b32 v24, v5
    ds_read_b32 v26, v5 offset:512
    ds_read_b32 v25, v6
    ds_read_b32 v27, v6 offset:512
    s_lshl_b32 s24, s35, 8
    v_lshlrev_b32 v4, 4, v3
    v_add_u32 v4, s24, v4
    s_lshl_b32 s25, s34, 7
    v_add_u32 v5, s25, v4
    s_xor_b32 s25, s25, 128
    v_add_u32 v6, s25, v4
    v_add_u32 v5, 132096, v5
    v_add_u32 v6, 132096, v6
    ds_read_b128 v[28:31], v5 offset:0
    ds_read_b128 v[32:35], v5 offset:32
    ds_read_b128 v[36:39], v5 offset:64
    ds_read_b128 v[40:43], v5 offset:96
    ds_read_b128 v[44:47], v6 offset:0
    ds_read_b128 v[48:51], v6 offset:32
    ds_read_b128 v[52:55], v6 offset:64
    ds_read_b128 v[56:59], v6 offset:96
    s_waitcnt lgkmcnt(0)
    v_mul_f32 v26, s31, v26
    v_mul_f32 v27, s31, v27
    s_cmp_eq_u32 s34, 0
    s_cbranch_scc0 L_k1_qk_wr1
    v_mov_b32 v4, v24
    v_mov_b32 v5, v24
    v_mov_b32 v6, v26
    v_mov_b32 v7, v26
    v_pk_fma_f32 v[64:65], v[28:29], v[4:5], v[64:65]
    v_pk_fma_f32 v[66:67], v[30:31], v[4:5], v[66:67]
    v_pk_fma_f32 v[68:69], v[32:33], v[4:5], v[68:69]
    v_pk_fma_f32 v[70:71], v[34:35], v[4:5], v[70:71]
    v_pk_fma_f32 v[72:73], v[36:37], v[4:5], v[72:73]
    v_pk_fma_f32 v[74:75], v[38:39], v[4:5], v[74:75]
    v_pk_fma_f32 v[76:77], v[40:41], v[4:5], v[76:77]
    v_pk_fma_f32 v[78:79], v[42:43], v[4:5], v[78:79]
    v_pk_mul_f32 v[64:65], v[64:65], v[6:7]
    v_pk_mul_f32 v[66:67], v[66:67], v[6:7]
    v_pk_mul_f32 v[68:69], v[68:69], v[6:7]
    v_pk_mul_f32 v[70:71], v[70:71], v[6:7]
    v_pk_mul_f32 v[72:73], v[72:73], v[6:7]
    v_pk_mul_f32 v[74:75], v[74:75], v[6:7]
    v_pk_mul_f32 v[76:77], v[76:77], v[6:7]
    v_pk_mul_f32 v[78:79], v[78:79], v[6:7]
    v_cvt_pk_bf16_f32 v64, v64, v65
    v_cvt_pk_bf16_f32 v65, v66, v67
    v_cvt_pk_bf16_f32 v66, v68, v69
    v_cvt_pk_bf16_f32 v67, v70, v71
    v_cvt_pk_bf16_f32 v68, v72, v73
    v_cvt_pk_bf16_f32 v69, v74, v75
    v_cvt_pk_bf16_f32 v70, v76, v77
    v_cvt_pk_bf16_f32 v71, v78, v79
    buffer_store_dwordx4 v[64:67], v128, s[16:19], s32 offen
    buffer_store_dwordx4 v[68:71], v129, s[16:19], s32 offen
    v_pk_fma_f32 v[80:81], v[44:45], v[4:5], v[80:81]
    v_pk_fma_f32 v[82:83], v[46:47], v[4:5], v[82:83]
    v_pk_fma_f32 v[84:85], v[48:49], v[4:5], v[84:85]
    v_pk_fma_f32 v[86:87], v[50:51], v[4:5], v[86:87]
    v_pk_fma_f32 v[88:89], v[52:53], v[4:5], v[88:89]
    v_pk_fma_f32 v[90:91], v[54:55], v[4:5], v[90:91]
    v_pk_fma_f32 v[92:93], v[56:57], v[4:5], v[92:93]
    v_pk_fma_f32 v[94:95], v[58:59], v[4:5], v[94:95]
    v_pk_mul_f32 v[80:81], v[80:81], v[6:7]
    v_pk_mul_f32 v[82:83], v[82:83], v[6:7]
    v_pk_mul_f32 v[84:85], v[84:85], v[6:7]
    v_pk_mul_f32 v[86:87], v[86:87], v[6:7]
    v_pk_mul_f32 v[88:89], v[88:89], v[6:7]
    v_pk_mul_f32 v[90:91], v[90:91], v[6:7]
    v_pk_mul_f32 v[92:93], v[92:93], v[6:7]
    v_pk_mul_f32 v[94:95], v[94:95], v[6:7]
    v_cvt_pk_bf16_f32 v80, v80, v81
    v_cvt_pk_bf16_f32 v81, v82, v83
    v_cvt_pk_bf16_f32 v82, v84, v85
    v_cvt_pk_bf16_f32 v83, v86, v87
    v_cvt_pk_bf16_f32 v84, v88, v89
    v_cvt_pk_bf16_f32 v85, v90, v91
    v_cvt_pk_bf16_f32 v86, v92, v93
    v_cvt_pk_bf16_f32 v87, v94, v95
    buffer_store_dwordx4 v[80:83], v130, s[16:19], s32 offen
    buffer_store_dwordx2 v[84:85], v131, s[16:19], s32 offen
    buffer_store_dwordx2 v[86:87], v132, s[16:19], s32 offen
    v_mov_b32 v4, v25
    v_mov_b32 v5, v25
    v_mov_b32 v6, v27
    v_mov_b32 v7, v27
    v_pk_fma_f32 v[96:97], v[28:29], v[4:5], v[96:97]
    v_pk_fma_f32 v[98:99], v[30:31], v[4:5], v[98:99]
    v_pk_fma_f32 v[100:101], v[32:33], v[4:5], v[100:101]
    v_pk_fma_f32 v[102:103], v[34:35], v[4:5], v[102:103]
    v_pk_fma_f32 v[104:105], v[36:37], v[4:5], v[104:105]
    v_pk_fma_f32 v[106:107], v[38:39], v[4:5], v[106:107]
    v_pk_fma_f32 v[108:109], v[40:41], v[4:5], v[108:109]
    v_pk_fma_f32 v[110:111], v[42:43], v[4:5], v[110:111]
    v_pk_mul_f32 v[96:97], v[96:97], v[6:7]
    v_pk_mul_f32 v[98:99], v[98:99], v[6:7]
    v_pk_mul_f32 v[100:101], v[100:101], v[6:7]
    v_pk_mul_f32 v[102:103], v[102:103], v[6:7]
    v_pk_mul_f32 v[104:105], v[104:105], v[6:7]
    v_pk_mul_f32 v[106:107], v[106:107], v[6:7]
    v_pk_mul_f32 v[108:109], v[108:109], v[6:7]
    v_pk_mul_f32 v[110:111], v[110:111], v[6:7]
    v_cvt_pk_bf16_f32 v96, v96, v97
    v_cvt_pk_bf16_f32 v97, v98, v99
    v_cvt_pk_bf16_f32 v98, v100, v101
    v_cvt_pk_bf16_f32 v99, v102, v103
    v_cvt_pk_bf16_f32 v100, v104, v105
    v_cvt_pk_bf16_f32 v101, v106, v107
    v_cvt_pk_bf16_f32 v102, v108, v109
    v_cvt_pk_bf16_f32 v103, v110, v111
    buffer_store_dwordx4 v[96:99], v128, s[16:19], s33 offen
    buffer_store_dwordx4 v[100:103], v129, s[16:19], s33 offen
    v_pk_fma_f32 v[112:113], v[44:45], v[4:5], v[112:113]
    v_pk_fma_f32 v[114:115], v[46:47], v[4:5], v[114:115]
    v_pk_fma_f32 v[116:117], v[48:49], v[4:5], v[116:117]
    v_pk_fma_f32 v[118:119], v[50:51], v[4:5], v[118:119]
    v_pk_fma_f32 v[120:121], v[52:53], v[4:5], v[120:121]
    v_pk_fma_f32 v[122:123], v[54:55], v[4:5], v[122:123]
    v_pk_fma_f32 v[124:125], v[56:57], v[4:5], v[124:125]
    v_pk_fma_f32 v[126:127], v[58:59], v[4:5], v[126:127]
    v_pk_mul_f32 v[112:113], v[112:113], v[6:7]
    v_pk_mul_f32 v[114:115], v[114:115], v[6:7]
    v_pk_mul_f32 v[116:117], v[116:117], v[6:7]
    v_pk_mul_f32 v[118:119], v[118:119], v[6:7]
    v_pk_mul_f32 v[120:121], v[120:121], v[6:7]
    v_pk_mul_f32 v[122:123], v[122:123], v[6:7]
    v_pk_mul_f32 v[124:125], v[124:125], v[6:7]
    v_pk_mul_f32 v[126:127], v[126:127], v[6:7]
    v_cvt_pk_bf16_f32 v112, v112, v113
    v_cvt_pk_bf16_f32 v113, v114, v115
    v_cvt_pk_bf16_f32 v114, v116, v117
    v_cvt_pk_bf16_f32 v115, v118, v119
    v_cvt_pk_bf16_f32 v116, v120, v121
    v_cvt_pk_bf16_f32 v117, v122, v123
    v_cvt_pk_bf16_f32 v118, v124, v125
    v_cvt_pk_bf16_f32 v119, v126, v127
    buffer_store_dwordx4 v[112:115], v130, s[16:19], s33 offen
    buffer_store_dwordx2 v[116:117], v131, s[16:19], s33 offen
    buffer_store_dwordx2 v[118:119], v132, s[16:19], s33 offen
    s_branch L_k1_qk_done
L_k1_qk_wr1:
    v_mov_b32 v4, v24
    v_mov_b32 v5, v24
    v_mov_b32 v6, v26
    v_mov_b32 v7, v26
    v_pk_fma_f32 v[64:65], v[28:29], v[4:5], v[64:65]
    v_pk_fma_f32 v[66:67], v[30:31], v[4:5], v[66:67]
    v_pk_fma_f32 v[68:69], v[32:33], v[4:5], v[68:69]
    v_pk_fma_f32 v[70:71], v[34:35], v[4:5], v[70:71]
    v_pk_fma_f32 v[72:73], v[36:37], v[4:5], v[72:73]
    v_pk_fma_f32 v[74:75], v[38:39], v[4:5], v[74:75]
    v_pk_fma_f32 v[76:77], v[40:41], v[4:5], v[76:77]
    v_pk_fma_f32 v[78:79], v[42:43], v[4:5], v[78:79]
    v_pk_mul_f32 v[64:65], v[64:65], v[6:7]
    v_pk_mul_f32 v[66:67], v[66:67], v[6:7]
    v_pk_mul_f32 v[68:69], v[68:69], v[6:7]
    v_pk_mul_f32 v[70:71], v[70:71], v[6:7]
    v_pk_mul_f32 v[72:73], v[72:73], v[6:7]
    v_pk_mul_f32 v[74:75], v[74:75], v[6:7]
    v_pk_mul_f32 v[76:77], v[76:77], v[6:7]
    v_pk_mul_f32 v[78:79], v[78:79], v[6:7]
    v_cvt_pk_bf16_f32 v64, v64, v65
    v_cvt_pk_bf16_f32 v65, v66, v67
    v_cvt_pk_bf16_f32 v66, v68, v69
    v_cvt_pk_bf16_f32 v67, v70, v71
    v_cvt_pk_bf16_f32 v68, v72, v73
    v_cvt_pk_bf16_f32 v69, v74, v75
    v_cvt_pk_bf16_f32 v70, v76, v77
    v_cvt_pk_bf16_f32 v71, v78, v79
    buffer_store_dwordx4 v[64:67], v130, s[16:19], s32 offen
    buffer_store_dwordx2 v[68:69], v131, s[16:19], s32 offen
    buffer_store_dwordx2 v[70:71], v132, s[16:19], s32 offen
    v_pk_fma_f32 v[80:81], v[44:45], v[4:5], v[80:81]
    v_pk_fma_f32 v[82:83], v[46:47], v[4:5], v[82:83]
    v_pk_fma_f32 v[84:85], v[48:49], v[4:5], v[84:85]
    v_pk_fma_f32 v[86:87], v[50:51], v[4:5], v[86:87]
    v_pk_fma_f32 v[88:89], v[52:53], v[4:5], v[88:89]
    v_pk_fma_f32 v[90:91], v[54:55], v[4:5], v[90:91]
    v_pk_fma_f32 v[92:93], v[56:57], v[4:5], v[92:93]
    v_pk_fma_f32 v[94:95], v[58:59], v[4:5], v[94:95]
    v_pk_mul_f32 v[80:81], v[80:81], v[6:7]
    v_pk_mul_f32 v[82:83], v[82:83], v[6:7]
    v_pk_mul_f32 v[84:85], v[84:85], v[6:7]
    v_pk_mul_f32 v[86:87], v[86:87], v[6:7]
    v_pk_mul_f32 v[88:89], v[88:89], v[6:7]
    v_pk_mul_f32 v[90:91], v[90:91], v[6:7]
    v_pk_mul_f32 v[92:93], v[92:93], v[6:7]
    v_pk_mul_f32 v[94:95], v[94:95], v[6:7]
    v_cvt_pk_bf16_f32 v80, v80, v81
    v_cvt_pk_bf16_f32 v81, v82, v83
    v_cvt_pk_bf16_f32 v82, v84, v85
    v_cvt_pk_bf16_f32 v83, v86, v87
    v_cvt_pk_bf16_f32 v84, v88, v89
    v_cvt_pk_bf16_f32 v85, v90, v91
    v_cvt_pk_bf16_f32 v86, v92, v93
    v_cvt_pk_bf16_f32 v87, v94, v95
    buffer_store_dwordx4 v[80:83], v128, s[16:19], s32 offen
    buffer_store_dwordx4 v[84:87], v129, s[16:19], s32 offen
    v_mov_b32 v4, v25
    v_mov_b32 v5, v25
    v_mov_b32 v6, v27
    v_mov_b32 v7, v27
    v_pk_fma_f32 v[96:97], v[28:29], v[4:5], v[96:97]
    v_pk_fma_f32 v[98:99], v[30:31], v[4:5], v[98:99]
    v_pk_fma_f32 v[100:101], v[32:33], v[4:5], v[100:101]
    v_pk_fma_f32 v[102:103], v[34:35], v[4:5], v[102:103]
    v_pk_fma_f32 v[104:105], v[36:37], v[4:5], v[104:105]
    v_pk_fma_f32 v[106:107], v[38:39], v[4:5], v[106:107]
    v_pk_fma_f32 v[108:109], v[40:41], v[4:5], v[108:109]
    v_pk_fma_f32 v[110:111], v[42:43], v[4:5], v[110:111]
    v_pk_mul_f32 v[96:97], v[96:97], v[6:7]
    v_pk_mul_f32 v[98:99], v[98:99], v[6:7]
    v_pk_mul_f32 v[100:101], v[100:101], v[6:7]
    v_pk_mul_f32 v[102:103], v[102:103], v[6:7]
    v_pk_mul_f32 v[104:105], v[104:105], v[6:7]
    v_pk_mul_f32 v[106:107], v[106:107], v[6:7]
    v_pk_mul_f32 v[108:109], v[108:109], v[6:7]
    v_pk_mul_f32 v[110:111], v[110:111], v[6:7]
    v_cvt_pk_bf16_f32 v96, v96, v97
    v_cvt_pk_bf16_f32 v97, v98, v99
    v_cvt_pk_bf16_f32 v98, v100, v101
    v_cvt_pk_bf16_f32 v99, v102, v103
    v_cvt_pk_bf16_f32 v100, v104, v105
    v_cvt_pk_bf16_f32 v101, v106, v107
    v_cvt_pk_bf16_f32 v102, v108, v109
    v_cvt_pk_bf16_f32 v103, v110, v111
    buffer_store_dwordx4 v[96:99], v130, s[16:19], s33 offen
    buffer_store_dwordx2 v[100:101], v131, s[16:19], s33 offen
    buffer_store_dwordx2 v[102:103], v132, s[16:19], s33 offen
    v_pk_fma_f32 v[112:113], v[44:45], v[4:5], v[112:113]
    v_pk_fma_f32 v[114:115], v[46:47], v[4:5], v[114:115]
    v_pk_fma_f32 v[116:117], v[48:49], v[4:5], v[116:117]
    v_pk_fma_f32 v[118:119], v[50:51], v[4:5], v[118:119]
    v_pk_fma_f32 v[120:121], v[52:53], v[4:5], v[120:121]
    v_pk_fma_f32 v[122:123], v[54:55], v[4:5], v[122:123]
    v_pk_fma_f32 v[124:125], v[56:57], v[4:5], v[124:125]
    v_pk_fma_f32 v[126:127], v[58:59], v[4:5], v[126:127]
    v_pk_mul_f32 v[112:113], v[112:113], v[6:7]
    v_pk_mul_f32 v[114:115], v[114:115], v[6:7]
    v_pk_mul_f32 v[116:117], v[116:117], v[6:7]
    v_pk_mul_f32 v[118:119], v[118:119], v[6:7]
    v_pk_mul_f32 v[120:121], v[120:121], v[6:7]
    v_pk_mul_f32 v[122:123], v[122:123], v[6:7]
    v_pk_mul_f32 v[124:125], v[124:125], v[6:7]
    v_pk_mul_f32 v[126:127], v[126:127], v[6:7]
    v_cvt_pk_bf16_f32 v112, v112, v113
    v_cvt_pk_bf16_f32 v113, v114, v115
    v_cvt_pk_bf16_f32 v114, v116, v117
    v_cvt_pk_bf16_f32 v115, v118, v119
    v_cvt_pk_bf16_f32 v116, v120, v121
    v_cvt_pk_bf16_f32 v117, v122, v123
    v_cvt_pk_bf16_f32 v118, v124, v125
    v_cvt_pk_bf16_f32 v119, v126, v127
    buffer_store_dwordx4 v[112:115], v128, s[16:19], s33 offen
    buffer_store_dwordx4 v[116:119], v129, s[16:19], s33 offen
L_k1_qk_done:
    s_endpgm
L_k1_v:
    s_lshl_b32 s25, s21, 2
    s_lshl_b32 s26, s34, 1
    s_add_u32 s25, s25, s26
    s_add_u32 s26, s25, s35
    s_mul_i32 s32, s26, 2560
    s_add_u32 s32, s32, 2622720
    s_xor_b32 s27, s35, 1
    s_add_u32 s26, s25, s27
    s_mul_i32 s33, s26, 2560
    s_add_u32 s33, s33, 2622720
    s_sub_u32 s24, s22, 10
    s_lshl_b32 s24, s24, 7
    s_lshl_b32 s25, s35, 6
    s_add_u32 s24, s24, s25
    s_lshl_b32 s25, s34, 5
    s_add_u32 s25, s25, s24
    v_add_u32 v4, s25, v2
    v_mul_u32_u24 v5, 52429, v4
    v_lshrrev_b32 v5, 20, v5
    v_mul_u32_u24 v6, 20, v5
    v_sub_u32 v6, v4, v6
    s_mov_b32 s26, 163840
    v_mul_lo_u32 v128, v5, s26
    v_lshlrev_b32 v6, 4, v6
    v_mul_u32_u24 v7, 320, v3
    v_add3_u32 v128, v128, v6, v7
    s_xor_b32 s25, s34, 1
    s_lshl_b32 s25, s25, 5
    s_add_u32 s25, s25, s24
    v_add_u32 v4, s25, v2
    v_mul_u32_u24 v5, 52429, v4
    v_lshrrev_b32 v5, 20, v5
    v_mul_u32_u24 v6, 20, v5
    v_sub_u32 v6, v4, v6
    s_mov_b32 s26, 163840
    v_mul_lo_u32 v129, v5, s26
    v_lshlrev_b32 v6, 4, v6
    v_mul_u32_u24 v7, 320, v3
    v_add3_u32 v129, v129, v6, v7
    s_barrier
    ds_read_b128 v[32:35], v8 offset:0
    ds_read_b64_tr_b16 v[40:41], v16 offset:16384
    ds_read_b64_tr_b16 v[42:43], v16 offset:17408
    ds_read_b64_tr_b16 v[44:45], v17 offset:16384
    ds_read_b64_tr_b16 v[46:47], v17 offset:17408
    ds_read_b128 v[36:39], v12 offset:0
    s_mov_b32 s27, 5
.p2align 3
L_k1_loop_v:
    s_waitcnt lgkmcnt(3)
    v_mfma_f32_32x32x16_bf16 v[64:79], v[32:35], v[40:43], v[64:79]
    ds_read_b128 v[48:51], v9 offset:0
    ds_read_b64_tr_b16 v[56:57], v16 offset:20480
    ds_read_b64_tr_b16 v[58:59], v16 offset:21504
    s_waitcnt lgkmcnt(4)
    v_mfma_f32_32x32x16_bf16 v[80:95], v[32:35], v[44:47], v[80:95]
    ds_read_b64_tr_b16 v[60:61], v17 offset:20480
    ds_read_b64_tr_b16 v[62:63], v17 offset:21504
    ds_read_b128 v[52:55], v13 offset:0
    s_waitcnt lgkmcnt(6)
    v_mfma_f32_32x32x16_bf16 v[96:111], v[36:39], v[40:43], v[96:111]
    v_mfma_f32_32x32x16_bf16 v[112:127], v[36:39], v[44:47], v[112:127]
    v_mfma_f32_16x16x32_bf16 v[140:143], v[136:139], v[40:43], v[140:143]
    s_waitcnt lgkmcnt(3)
    v_mfma_f32_32x32x16_bf16 v[64:79], v[48:51], v[56:59], v[64:79]
    ds_read_b128 v[32:35], v10 offset:0
    ds_read_b64_tr_b16 v[40:41], v16 offset:24576
    ds_read_b64_tr_b16 v[42:43], v16 offset:25600
    s_waitcnt lgkmcnt(4)
    v_mfma_f32_32x32x16_bf16 v[80:95], v[48:51], v[60:63], v[80:95]
    ds_read_b64_tr_b16 v[44:45], v17 offset:24576
    ds_read_b64_tr_b16 v[46:47], v17 offset:25600
    ds_read_b128 v[36:39], v14 offset:0
    s_waitcnt lgkmcnt(6)
    v_mfma_f32_32x32x16_bf16 v[96:111], v[52:55], v[56:59], v[96:111]
    v_mfma_f32_32x32x16_bf16 v[112:127], v[52:55], v[60:63], v[112:127]
    v_mfma_f32_16x16x32_bf16 v[140:143], v[136:139], v[56:59], v[140:143]
    s_waitcnt lgkmcnt(3)
    v_mfma_f32_32x32x16_bf16 v[64:79], v[32:35], v[40:43], v[64:79]
    ds_read_b128 v[48:51], v11 offset:0
    ds_read_b64_tr_b16 v[56:57], v16 offset:28672
    ds_read_b64_tr_b16 v[58:59], v16 offset:29696
    s_waitcnt lgkmcnt(4)
    v_mfma_f32_32x32x16_bf16 v[80:95], v[32:35], v[44:47], v[80:95]
    ds_read_b64_tr_b16 v[60:61], v17 offset:28672
    ds_read_b64_tr_b16 v[62:63], v17 offset:29696
    ds_read_b128 v[52:55], v15 offset:0
    s_waitcnt lgkmcnt(6)
    v_mfma_f32_32x32x16_bf16 v[96:111], v[36:39], v[40:43], v[96:111]
    v_mfma_f32_32x32x16_bf16 v[112:127], v[36:39], v[44:47], v[112:127]
    v_mfma_f32_16x16x32_bf16 v[140:143], v[136:139], v[40:43], v[140:143]
    s_waitcnt lgkmcnt(0)
    v_mfma_f32_32x32x16_bf16 v[64:79], v[48:51], v[56:59], v[64:79]
    v_mfma_f32_32x32x16_bf16 v[80:95], v[48:51], v[60:63], v[80:95]
    s_barrier
    ds_read_b128 v[32:35], v8 offset:32768
    ds_read_b64_tr_b16 v[40:41], v16 offset:49152
    ds_read_b64_tr_b16 v[42:43], v16 offset:50176
    v_mfma_f32_32x32x16_bf16 v[96:111], v[52:55], v[56:59], v[96:111]
    ds_read_b64_tr_b16 v[44:45], v17 offset:49152
    ds_read_b64_tr_b16 v[46:47], v17 offset:50176
    ds_read_b128 v[36:39], v12 offset:32768
    v_mfma_f32_32x32x16_bf16 v[112:127], v[52:55], v[60:63], v[112:127]
    v_mfma_f32_16x16x32_bf16 v[140:143], v[136:139], v[56:59], v[140:143]
    s_waitcnt lgkmcnt(3)
    v_mfma_f32_32x32x16_bf16 v[64:79], v[32:35], v[40:43], v[64:79]
    ds_read_b128 v[48:51], v9 offset:32768
    ds_read_b64_tr_b16 v[56:57], v16 offset:53248
    ds_read_b64_tr_b16 v[58:59], v16 offset:54272
    s_waitcnt lgkmcnt(4)
    v_mfma_f32_32x32x16_bf16 v[80:95], v[32:35], v[44:47], v[80:95]
    ds_read_b64_tr_b16 v[60:61], v17 offset:53248
    ds_read_b64_tr_b16 v[62:63], v17 offset:54272
    ds_read_b128 v[52:55], v13 offset:32768
    s_waitcnt lgkmcnt(6)
    v_mfma_f32_32x32x16_bf16 v[96:111], v[36:39], v[40:43], v[96:111]
    v_mfma_f32_32x32x16_bf16 v[112:127], v[36:39], v[44:47], v[112:127]
    v_mfma_f32_16x16x32_bf16 v[140:143], v[136:139], v[40:43], v[140:143]
    s_waitcnt lgkmcnt(3)
    v_mfma_f32_32x32x16_bf16 v[64:79], v[48:51], v[56:59], v[64:79]
    ds_read_b128 v[32:35], v10 offset:32768
    ds_read_b64_tr_b16 v[40:41], v16 offset:57344
    ds_read_b64_tr_b16 v[42:43], v16 offset:58368
    s_waitcnt lgkmcnt(4)
    v_mfma_f32_32x32x16_bf16 v[80:95], v[48:51], v[60:63], v[80:95]
    ds_read_b64_tr_b16 v[44:45], v17 offset:57344
    ds_read_b64_tr_b16 v[46:47], v17 offset:58368
    ds_read_b128 v[36:39], v14 offset:32768
    s_waitcnt lgkmcnt(6)
    v_mfma_f32_32x32x16_bf16 v[96:111], v[52:55], v[56:59], v[96:111]
    v_mfma_f32_32x32x16_bf16 v[112:127], v[52:55], v[60:63], v[112:127]
    v_mfma_f32_16x16x32_bf16 v[140:143], v[136:139], v[56:59], v[140:143]
    s_waitcnt lgkmcnt(3)
    v_mfma_f32_32x32x16_bf16 v[64:79], v[32:35], v[40:43], v[64:79]
    ds_read_b128 v[48:51], v11 offset:32768
    ds_read_b64_tr_b16 v[56:57], v16 offset:61440
    ds_read_b64_tr_b16 v[58:59], v16 offset:62464
    s_waitcnt lgkmcnt(4)
    v_mfma_f32_32x32x16_bf16 v[80:95], v[32:35], v[44:47], v[80:95]
    ds_read_b64_tr_b16 v[60:61], v17 offset:61440
    ds_read_b64_tr_b16 v[62:63], v17 offset:62464
    ds_read_b128 v[52:55], v15 offset:32768
    s_waitcnt lgkmcnt(6)
    v_mfma_f32_32x32x16_bf16 v[96:111], v[36:39], v[40:43], v[96:111]
    v_mfma_f32_32x32x16_bf16 v[112:127], v[36:39], v[44:47], v[112:127]
    v_mfma_f32_16x16x32_bf16 v[140:143], v[136:139], v[40:43], v[140:143]
    s_waitcnt lgkmcnt(0)
    v_mfma_f32_32x32x16_bf16 v[64:79], v[48:51], v[56:59], v[64:79]
    v_mfma_f32_32x32x16_bf16 v[80:95], v[48:51], v[60:63], v[80:95]
    s_sub_u32 s27, s27, 1
    s_cmp_eq_u32 s27, 0
    s_cbranch_scc1 L_k1_last_v
    v_xor_b32 v8, 0x10000, v8
    v_xor_b32 v9, 0x10000, v9
    v_xor_b32 v10, 0x10000, v10
    v_xor_b32 v11, 0x10000, v11
    v_xor_b32 v12, 0x10000, v12
    v_xor_b32 v13, 0x10000, v13
    v_xor_b32 v14, 0x10000, v14
    v_xor_b32 v15, 0x10000, v15
    v_xor_b32 v16, 0x10000, v16
    v_xor_b32 v17, 0x10000, v17
    s_barrier
    ds_read_b128 v[32:35], v8 offset:0
    ds_read_b64_tr_b16 v[40:41], v16 offset:16384
    ds_read_b64_tr_b16 v[42:43], v16 offset:17408
    v_mfma_f32_32x32x16_bf16 v[96:111], v[52:55], v[56:59], v[96:111]
    ds_read_b64_tr_b16 v[44:45], v17 offset:16384
    ds_read_b64_tr_b16 v[46:47], v17 offset:17408
    ds_read_b128 v[36:39], v12 offset:0
    v_mfma_f32_32x32x16_bf16 v[112:127], v[52:55], v[60:63], v[112:127]
    v_mfma_f32_16x16x32_bf16 v[140:143], v[136:139], v[56:59], v[140:143]
    s_branch L_k1_loop_v
L_k1_last_v:
    v_mfma_f32_32x32x16_bf16 v[96:111], v[52:55], v[56:59], v[96:111]
    v_mfma_f32_32x32x16_bf16 v[112:127], v[52:55], v[60:63], v[112:127]
    v_mfma_f32_16x16x32_bf16 v[140:143], v[136:139], v[56:59], v[140:143]
    s_lshl_b32 s24, s35, 6
    s_lshl_b32 s25, s34, 5
    s_add_u32 s24, s24, s25
    v_add_u32 v5, s24, v1
    v_lshlrev_b32 v5, 2, v5
    v_add_u32 v5, 132096, v5
    s_mov_b64 exec, 0xffff
    s_nop 4
    ds_write_b32 v5, v140
    ds_write_b32 v5, v141 offset:64
    s_mov_b64 exec, -1
    s_waitcnt lgkmcnt(0)
    s_barrier
    s_lshl_b32 s24, s35, 6
    v_add_u32 v4, s24, v2
    v_lshlrev_b32 v4, 2, v4
    s_lshl_b32 s25, s34, 7
    v_add_u32 v5, s25, v4
    s_xor_b32 s25, s25, 128
    v_add_u32 v6, s25, v4
    v_add_u32 v5, 132096, v5
    v_add_u32 v6, 132096, v6
    ds_read_b32 v24, v5
    ds_read_b32 v26, v6
    s_waitcnt lgkmcnt(0)
    v_mov_b32 v25, v24
    v_mov_b32 v27, v26
    s_lshl_b32 s24, s34, 8
    s_lshl_b32 s25, s35, 7
    s_add_u32 s24, s24, s25
    v_lshlrev_b32 v4, 4, v3
    v_add_u32 v4, s24, v4
    v_add_u32 v4, 131072, v4
    ds_read_b128 v[28:31], v4 offset:0
    ds_read_b128 v[44:47], v4 offset:512
    ds_read_b128 v[32:35], v4 offset:32
    ds_read_b128 v[48:51], v4 offset:544
    ds_read_b128 v[36:39], v4 offset:64
    ds_read_b128 v[52:55], v4 offset:576
    ds_read_b128 v[40:43], v4 offset:96
    ds_read_b128 v[56:59], v4 offset:608
    s_waitcnt lgkmcnt(0)
    v_pk_fma_f32 v[64:65], v[28:29], v[24:25], v[64:65]
    v_pk_fma_f32 v[66:67], v[30:31], v[24:25], v[66:67]
    v_pk_fma_f32 v[68:69], v[32:33], v[24:25], v[68:69]
    v_pk_fma_f32 v[70:71], v[34:35], v[24:25], v[70:71]
    v_pk_fma_f32 v[72:73], v[36:37], v[24:25], v[72:73]
    v_pk_fma_f32 v[74:75], v[38:39], v[24:25], v[74:75]
    v_pk_fma_f32 v[76:77], v[40:41], v[24:25], v[76:77]
    v_pk_fma_f32 v[78:79], v[42:43], v[24:25], v[78:79]
    v_pk_mul_f32 v[64:65], v[64:65], v[44:45]
    v_pk_mul_f32 v[66:67], v[66:67], v[46:47]
    v_pk_mul_f32 v[68:69], v[68:69], v[48:49]
    v_pk_mul_f32 v[70:71], v[70:71], v[50:51]
    v_pk_mul_f32 v[72:73], v[72:73], v[52:53]
    v_pk_mul_f32 v[74:75], v[74:75], v[54:55]
    v_pk_mul_f32 v[76:77], v[76:77], v[56:57]
    v_pk_mul_f32 v[78:79], v[78:79], v[58:59]
    v_cvt_pk_bf16_f32 v64, v64, v65
    v_cvt_pk_bf16_f32 v65, v66, v67
    v_cvt_pk_bf16_f32 v66, v68, v69
    v_cvt_pk_bf16_f32 v67, v70, v71
    v_cvt_pk_bf16_f32 v68, v72, v73
    v_cvt_pk_bf16_f32 v69, v74, v75
    v_cvt_pk_bf16_f32 v70, v76, v77
    v_cvt_pk_bf16_f32 v71, v78, v79
    buffer_store_dwordx4 v[64:67], v128, s[16:19], s32 offen offset:0
    buffer_store_dwordx4 v[68:71], v128, s[16:19], s32 offen offset:640
    v_pk_fma_f32 v[80:81], v[28:29], v[26:27], v[80:81]
    v_pk_fma_f32 v[82:83], v[30:31], v[26:27], v[82:83]
    v_pk_fma_f32 v[84:85], v[32:33], v[26:27], v[84:85]
    v_pk_fma_f32 v[86:87], v[34:35], v[26:27], v[86:87]
    v_pk_fma_f32 v[88:89], v[36:37], v[26:27], v[88:89]
    v_pk_fma_f32 v[90:91], v[38:39], v[26:27], v[90:91]
    v_pk_fma_f32 v[92:93], v[40:41], v[26:27], v[92:93]
    v_pk_fma_f32 v[94:95], v[42:43], v[26:27], v[94:95]
    v_pk_mul_f32 v[80:81], v[80:81], v[44:45]
    v_pk_mul_f32 v[82:83], v[82:83], v[46:47]
    v_pk_mul_f32 v[84:85], v[84:85], v[48:49]
    v_pk_mul_f32 v[86:87], v[86:87], v[50:51]
    v_pk_mul_f32 v[88:89], v[88:89], v[52:53]
    v_pk_mul_f32 v[90:91], v[90:91], v[54:55]
    v_pk_mul_f32 v[92:93], v[92:93], v[56:57]
    v_pk_mul_f32 v[94:95], v[94:95], v[58:59]
    v_cvt_pk_bf16_f32 v80, v80, v81
    v_cvt_pk_bf16_f32 v81, v82, v83
    v_cvt_pk_bf16_f32 v82, v84, v85
    v_cvt_pk_bf16_f32 v83, v86, v87
    v_cvt_pk_bf16_f32 v84, v88, v89
    v_cvt_pk_bf16_f32 v85, v90, v91
    v_cvt_pk_bf16_f32 v86, v92, v93
    v_cvt_pk_bf16_f32 v87, v94, v95
    buffer_store_dwordx4 v[80:83], v129, s[16:19], s32 offen offset:0
    buffer_store_dwordx4 v[84:87], v129, s[16:19], s32 offen offset:640
    s_lshl_b32 s24, s34, 8
    s_lshl_b32 s25, s35, 7
    s_xor_b32 s25, s25, 128
    s_add_u32 s24, s24, s25
    v_lshlrev_b32 v4, 4, v3
    v_add_u32 v4, s24, v4
    v_add_u32 v4, 131072, v4
    ds_read_b128 v[28:31], v4 offset:0
    ds_read_b128 v[44:47], v4 offset:512
    ds_read_b128 v[32:35], v4 offset:32
    ds_read_b128 v[48:51], v4 offset:544
    ds_read_b128 v[36:39], v4 offset:64
    ds_read_b128 v[52:55], v4 offset:576
    ds_read_b128 v[40:43], v4 offset:96
    ds_read_b128 v[56:59], v4 offset:608
    s_waitcnt lgkmcnt(0)
    v_pk_fma_f32 v[96:97], v[28:29], v[24:25], v[96:97]
    v_pk_fma_f32 v[98:99], v[30:31], v[24:25], v[98:99]
    v_pk_fma_f32 v[100:101], v[32:33], v[24:25], v[100:101]
    v_pk_fma_f32 v[102:103], v[34:35], v[24:25], v[102:103]
    v_pk_fma_f32 v[104:105], v[36:37], v[24:25], v[104:105]
    v_pk_fma_f32 v[106:107], v[38:39], v[24:25], v[106:107]
    v_pk_fma_f32 v[108:109], v[40:41], v[24:25], v[108:109]
    v_pk_fma_f32 v[110:111], v[42:43], v[24:25], v[110:111]
    v_pk_mul_f32 v[96:97], v[96:97], v[44:45]
    v_pk_mul_f32 v[98:99], v[98:99], v[46:47]
    v_pk_mul_f32 v[100:101], v[100:101], v[48:49]
    v_pk_mul_f32 v[102:103], v[102:103], v[50:51]
    v_pk_mul_f32 v[104:105], v[104:105], v[52:53]
    v_pk_mul_f32 v[106:107], v[106:107], v[54:55]
    v_pk_mul_f32 v[108:109], v[108:109], v[56:57]
    v_pk_mul_f32 v[110:111], v[110:111], v[58:59]
    v_cvt_pk_bf16_f32 v96, v96, v97
    v_cvt_pk_bf16_f32 v97, v98, v99
    v_cvt_pk_bf16_f32 v98, v100, v101
    v_cvt_pk_bf16_f32 v99, v102, v103
    v_cvt_pk_bf16_f32 v100, v104, v105
    v_cvt_pk_bf16_f32 v101, v106, v107
    v_cvt_pk_bf16_f32 v102, v108, v109
    v_cvt_pk_bf16_f32 v103, v110, v111
    buffer_store_dwordx4 v[96:99], v128, s[16:19], s33 offen offset:0
    buffer_store_dwordx4 v[100:103], v128, s[16:19], s33 offen offset:640
    v_pk_fma_f32 v[112:113], v[28:29], v[26:27], v[112:113]
    v_pk_fma_f32 v[114:115], v[30:31], v[26:27], v[114:115]
    v_pk_fma_f32 v[116:117], v[32:33], v[26:27], v[116:117]
    v_pk_fma_f32 v[118:119], v[34:35], v[26:27], v[118:119]
    v_pk_fma_f32 v[120:121], v[36:37], v[26:27], v[120:121]
    v_pk_fma_f32 v[122:123], v[38:39], v[26:27], v[122:123]
    v_pk_fma_f32 v[124:125], v[40:41], v[26:27], v[124:125]
    v_pk_fma_f32 v[126:127], v[42:43], v[26:27], v[126:127]
    v_pk_mul_f32 v[112:113], v[112:113], v[44:45]
    v_pk_mul_f32 v[114:115], v[114:115], v[46:47]
    v_pk_mul_f32 v[116:117], v[116:117], v[48:49]
    v_pk_mul_f32 v[118:119], v[118:119], v[50:51]
    v_pk_mul_f32 v[120:121], v[120:121], v[52:53]
    v_pk_mul_f32 v[122:123], v[122:123], v[54:55]
    v_pk_mul_f32 v[124:125], v[124:125], v[56:57]
    v_pk_mul_f32 v[126:127], v[126:127], v[58:59]
    v_cvt_pk_bf16_f32 v112, v112, v113
    v_cvt_pk_bf16_f32 v113, v114, v115
    v_cvt_pk_bf16_f32 v114, v116, v117
    v_cvt_pk_bf16_f32 v115, v118, v119
    v_cvt_pk_bf16_f32 v116, v120, v121
    v_cvt_pk_bf16_f32 v117, v122, v123
    v_cvt_pk_bf16_f32 v118, v124, v125
    v_cvt_pk_bf16_f32 v119, v126, v127
    buffer_store_dwordx4 v[112:115], v129, s[16:19], s33 offen offset:0
    buffer_store_dwordx4 v[116:119], v129, s[16:19], s33 offen offset:640
    s_endpgm
L_k1_loader:
    s_setprio 0
    s_sub_u32 s24, s20, 4
    v_lshrrev_b32 v4, 3, v1
    s_lshl_b32 s25, s24, 3
    s_add_u32 s25, s25, s23
    v_add_u32 v4, s25, v4
    v_mul_u32_u24 v4, 1280, v4
    v_lshrrev_b32 v5, 4, v1
    s_and_b32 s25, s24, 1
    s_lshl_b32 s25, s25, 2
    v_add_u32 v6, s25, v5
    v_and_b32 v7, 7, v1
    v_xor_b32 v6, v6, v7
    v_lshl_add_u32 v8, v6, 4, v4
    s_lshl_b32 s25, s24, 2
    v_add_u32 v4, s25, v5
    v_mul_u32_u24 v4, 3840, v4
    v_and_b32 v6, 15, v1
    v_lshlrev_b32 v7, 2, v5
    v_xor_b32 v6, v6, v7
    v_lshl_add_u32 v4, v6, 4, v4
    s_lshl_b32 s25, s22, 8
    v_add_u32 v9, s25, v4
    s_lshl_b32 s26, s24, 10
    v_add_u32 v44, 0, v8
    v_add_u32 v48, 0, v9
    v_add_u32 v45, 40960, v8
    v_add_u32 v49, 61440, v9
    v_add_u32 v46, 81920, v8
    v_add_u32 v50, 122880, v9
    v_add_u32 v47, 122880, v8
    v_add_u32 v51, 184320, v9
    s_lshr_b32 s42, s2, 5
    s_bfe_u32 s43, s2, 0x20003
    s_mul_i32 s43, s43, 3
    s_add_u32 s42, s42, s43
    s_cmp_ge_u32 s42, 10
    s_cselect_b32 s43, 10, 0
    s_sub_u32 s42, s42, s43
    s_mov_b32 s42, 0
    s_lshl_b32 s40, s42, 7
    s_mul_i32 s41, s42, 245760
    s_add_u32 s42, s42, 1
    s_cmp_eq_u32 s42, 10
    s_cselect_b32 s42, 0, s42
    s_add_u32 m0, s26, 0
    s_nop 0
    buffer_load_dwordx4 v44, s[8:11], s40 offen lds
    s_add_u32 m0, s26, 16384
    s_nop 0
    buffer_load_dwordx4 v48, s[12:15], s41 offen lds
    s_add_u32 m0, s26, 4096
    s_nop 0
    buffer_load_dwordx4 v45, s[8:11], s40 offen lds
    s_add_u32 m0, s26, 20480
    s_nop 0
    buffer_load_dwordx4 v49, s[12:15], s41 offen lds
    s_add_u32 m0, s26, 8192
    s_nop 0
    buffer_load_dwordx4 v46, s[8:11], s40 offen lds
    s_add_u32 m0, s26, 24576
    s_nop 0
    buffer_load_dwordx4 v50, s[12:15], s41 offen lds
    s_add_u32 m0, s26, 12288
    s_nop 0
    buffer_load_dwordx4 v47, s[8:11], s40 offen lds
    s_add_u32 m0, s26, 28672
    s_nop 0
    buffer_load_dwordx4 v51, s[12:15], s41 offen lds
    s_lshl_b32 s40, s42, 7
    s_mul_i32 s41, s42, 245760
    s_add_u32 s42, s42, 1
    s_cmp_eq_u32 s42, 10
    s_cselect_b32 s42, 0, s42
    s_add_u32 m0, s26, 32768
    s_nop 0
    buffer_load_dwordx4 v44, s[8:11], s40 offen lds
    s_add_u32 m0, s26, 49152
    s_nop 0
    buffer_load_dwordx4 v48, s[12:15], s41 offen lds
    s_add_u32 m0, s26, 36864
    s_nop 0
    buffer_load_dwordx4 v45, s[8:11], s40 offen lds
    s_add_u32 m0, s26, 53248
    s_nop 0
    buffer_load_dwordx4 v49, s[12:15], s41 offen lds
    s_add_u32 m0, s26, 40960
    s_nop 0
    buffer_load_dwordx4 v46, s[8:11], s40 offen lds
    s_add_u32 m0, s26, 57344
    s_nop 0
    buffer_load_dwordx4 v50, s[12:15], s41 offen lds
    s_add_u32 m0, s26, 45056
    s_nop 0
    buffer_load_dwordx4 v47, s[8:11], s40 offen lds
    s_add_u32 m0, s26, 61440
    s_nop 0
    buffer_load_dwordx4 v51, s[12:15], s41 offen lds
    s_waitcnt vmcnt(8)
    s_barrier
    s_lshl_b32 s40, s42, 7
    s_mul_i32 s41, s42, 245760
    s_add_u32 s42, s42, 1
    s_cmp_eq_u32 s42, 10
    s_cselect_b32 s42, 0, s42
    s_add_u32 m0, s26, 65536
    s_nop 0
    buffer_load_dwordx4 v44, s[8:11], s40 offen lds
    s_add_u32 m0, s26, 81920
    s_nop 0
    buffer_load_dwordx4 v48, s[12:15], s41 offen lds
    s_add_u32 m0, s26, 69632
    s_nop 0
    buffer_load_dwordx4 v45, s[8:11], s40 offen lds
    s_add_u32 m0, s26, 86016
    s_nop 0
    buffer_load_dwordx4 v49, s[12:15], s41 offen lds
    s_add_u32 m0, s26, 73728
    s_nop 0
    buffer_load_dwordx4 v46, s[8:11], s40 offen lds
    s_add_u32 m0, s26, 90112
    s_nop 0
    buffer_load_dwordx4 v50, s[12:15], s41 offen lds
    s_add_u32 m0, s26, 77824
    s_nop 0
    buffer_load_dwordx4 v47, s[8:11], s40 offen lds
    s_add_u32 m0, s26, 94208
    s_nop 0
    buffer_load_dwordx4 v51, s[12:15], s41 offen lds
    s_lshl_b32 s40, s42, 7
    s_mul_i32 s41, s42, 245760
    s_add_u32 s42, s42, 1
    s_cmp_eq_u32 s42, 10
    s_cselect_b32 s42, 0, s42
    s_add_u32 m0, s26, 98304
    s_nop 0
    buffer_load_dwordx4 v44, s[8:11], s40 offen lds
    s_add_u32 m0, s26, 114688
    s_nop 0
    buffer_load_dwordx4 v48, s[12:15], s41 offen lds
    s_add_u32 m0, s26, 102400
    s_nop 0
    buffer_load_dwordx4 v45, s[8:11], s40 offen lds
    s_add_u32 m0, s26, 118784
    s_nop 0
    buffer_load_dwordx4 v49, s[12:15], s41 offen lds
    s_add_u32 m0, s26, 106496
    s_nop 0
    buffer_load_dwordx4 v46, s[8:11], s40 offen lds
    s_add_u32 m0, s26, 122880
    s_nop 0
    buffer_load_dwordx4 v50, s[12:15], s41 offen lds
    s_add_u32 m0, s26, 110592
    s_nop 0
    buffer_load_dwordx4 v47, s[8:11], s40 offen lds
    s_add_u32 m0, s26, 126976
    s_nop 0
    buffer_load_dwordx4 v51, s[12:15], s41 offen lds
    s_waitcnt vmcnt(16)
    s_barrier
    s_lshl_b32 s40, s42, 7
    s_mul_i32 s41, s42, 245760
    s_add_u32 s42, s42, 1
    s_cmp_eq_u32 s42, 10
    s_cselect_b32 s42, 0, s42
    s_add_u32 m0, s26, 0
    s_nop 0
    buffer_load_dwordx4 v44, s[8:11], s40 offen lds
    s_add_u32 m0, s26, 16384
    s_nop 0
    buffer_load_dwordx4 v48, s[12:15], s41 offen lds
    s_add_u32 m0, s26, 4096
    s_nop 0
    buffer_load_dwordx4 v45, s[8:11], s40 offen lds
    s_add_u32 m0, s26, 20480
    s_nop 0
    buffer_load_dwordx4 v49, s[12:15], s41 offen lds
    s_add_u32 m0, s26, 8192
    s_nop 0
    buffer_load_dwordx4 v46, s[8:11], s40 offen lds
    s_add_u32 m0, s26, 24576
    s_nop 0
    buffer_load_dwordx4 v50, s[12:15], s41 offen lds
    s_add_u32 m0, s26, 12288
    s_nop 0
    buffer_load_dwordx4 v47, s[8:11], s40 offen lds
    s_add_u32 m0, s26, 28672
    s_nop 0
    buffer_load_dwordx4 v51, s[12:15], s41 offen lds
    s_waitcnt vmcnt(16)
    s_barrier
    s_lshl_b32 s40, s42, 7
    s_mul_i32 s41, s42, 245760
    s_add_u32 s42, s42, 1
    s_cmp_eq_u32 s42, 10
    s_cselect_b32 s42, 0, s42
    s_add_u32 m0, s26, 32768
    s_nop 0
    buffer_load_dwordx4 v44, s[8:11], s40 offen lds
    s_add_u32 m0, s26, 49152
    s_nop 0
    buffer_load_dwordx4 v48, s[12:15], s41 offen lds
    s_add_u32 m0, s26, 36864
    s_nop 0
    buffer_load_dwordx4 v45, s[8:11], s40 offen lds
    s_add_u32 m0, s26, 53248
    s_nop 0
    buffer_load_dwordx4 v49, s[12:15], s41 offen lds
    s_add_u32 m0, s26, 40960
    s_nop 0
    buffer_load_dwordx4 v46, s[8:11], s40 offen lds
    s_add_u32 m0, s26, 57344
    s_nop 0
    buffer_load_dwordx4 v50, s[12:15], s41 offen lds
    s_add_u32 m0, s26, 45056
    s_nop 0
    buffer_load_dwordx4 v47, s[8:11], s40 offen lds
    s_add_u32 m0, s26, 61440
    s_nop 0
    buffer_load_dwordx4 v51, s[12:15], s41 offen lds
    s_waitcnt vmcnt(16)
    s_barrier
    s_lshl_b32 s40, s42, 7
    s_mul_i32 s41, s42, 245760
    s_add_u32 s42, s42, 1
    s_cmp_eq_u32 s42, 10
    s_cselect_b32 s42, 0, s42
    s_add_u32 m0, s26, 65536
    s_nop 0
    buffer_load_dwordx4 v44, s[8:11], s40 offen lds
    s_add_u32 m0, s26, 81920
    s_nop 0
    buffer_load_dwordx4 v48, s[12:15], s41 offen lds
    s_add_u32 m0, s26, 69632
    s_nop 0
    buffer_load_dwordx4 v45, s[8:11], s40 offen lds
    s_add_u32 m0, s26, 86016
    s_nop 0
    buffer_load_dwordx4 v49, s[12:15], s41 offen lds
    s_add_u32 m0, s26, 73728
    s_nop 0
    buffer_load_dwordx4 v46, s[8:11], s40 offen lds
    s_add_u32 m0, s26, 90112
    s_nop 0
    buffer_load_dwordx4 v50, s[12:15], s41 offen lds
    s_add_u32 m0, s26, 77824
    s_nop 0
    buffer_load_dwordx4 v47, s[8:11], s40 offen lds
    s_add_u32 m0, s26, 94208
    s_nop 0
    buffer_load_dwordx4 v51, s[12:15], s41 offen lds
    s_waitcnt vmcnt(16)
    s_barrier
    s_lshl_b32 s40, s42, 7
    s_mul_i32 s41, s42, 245760
    s_add_u32 s42, s42, 1
    s_cmp_eq_u32 s42, 10
    s_cselect_b32 s42, 0, s42
    s_add_u32 m0, s26, 98304
    s_nop 0
    buffer_load_dwordx4 v44, s[8:11], s40 offen lds
    s_add_u32 m0, s26, 114688
    s_nop 0
    buffer_load_dwordx4 v48, s[12:15], s41 offen lds
    s_add_u32 m0, s26, 102400
    s_nop 0
    buffer_load_dwordx4 v45, s[8:11], s40 offen lds
    s_add_u32 m0, s26, 118784
    s_nop 0
    buffer_load_dwordx4 v49, s[12:15], s41 offen lds
    s_add_u32 m0, s26, 106496
    s_nop 0
    buffer_load_dwordx4 v46, s[8:11], s40 offen lds
    s_add_u32 m0, s26, 122880
    s_nop 0
    buffer_load_dwordx4 v50, s[12:15], s41 offen lds
    s_add_u32 m0, s26, 110592
    s_nop 0
    buffer_load_dwordx4 v47, s[8:11], s40 offen lds
    s_add_u32 m0, s26, 126976
    s_nop 0
    buffer_load_dwordx4 v51, s[12:15], s41 offen lds
    s_waitcnt vmcnt(16)
    s_barrier
    s_lshl_b32 s40, s42, 7
    s_mul_i32 s41, s42, 245760
    s_add_u32 s42, s42, 1
    s_cmp_eq_u32 s42, 10
    s_cselect_b32 s42, 0, s42
    s_add_u32 m0, s26, 0
    s_nop 0
    buffer_load_dwordx4 v44, s[8:11], s40 offen lds
    s_add_u32 m0, s26, 16384
    s_nop 0
    buffer_load_dwordx4 v48, s[12:15], s41 offen lds
    s_add_u32 m0, s26, 4096
    s_nop 0
    buffer_load_dwordx4 v45, s[8:11], s40 offen lds
    s_add_u32 m0, s26, 20480
    s_nop 0
    buffer_load_dwordx4 v49, s[12:15], s41 offen lds
    s_add_u32 m0, s26, 8192
    s_nop 0
    buffer_load_dwordx4 v46, s[8:11], s40 offen lds
    s_add_u32 m0, s26, 24576
    s_nop 0
    buffer_load_dwordx4 v50, s[12:15], s41 offen lds
    s_add_u32 m0, s26, 12288
    s_nop 0
    buffer_load_dwordx4 v47, s[8:11], s40 offen lds
    s_add_u32 m0, s26, 28672
    s_nop 0
    buffer_load_dwordx4 v51, s[12:15], s41 offen lds
    s_waitcnt vmcnt(16)
    s_barrier
    s_lshl_b32 s40, s42, 7
    s_mul_i32 s41, s42, 245760
    s_add_u32 s42, s42, 1
    s_cmp_eq_u32 s42, 10
    s_cselect_b32 s42, 0, s42
    s_add_u32 m0, s26, 32768
    s_nop 0
    buffer_load_dwordx4 v44, s[8:11], s40 offen lds
    s_add_u32 m0, s26, 49152
    s_nop 0
    buffer_load_dwordx4 v48, s[12:15], s41 offen lds
    s_add_u32 m0, s26, 36864
    s_nop 0
    buffer_load_dwordx4 v45, s[8:11], s40 offen lds
    s_add_u32 m0, s26, 53248
    s_nop 0
    buffer_load_dwordx4 v49, s[12:15], s41 offen lds
    s_add_u32 m0, s26, 40960
    s_nop 0
    buffer_load_dwordx4 v46, s[8:11], s40 offen lds
    s_add_u32 m0, s26, 57344
    s_nop 0
    buffer_load_dwordx4 v50, s[12:15], s41 offen lds
    s_add_u32 m0, s26, 45056
    s_nop 0
    buffer_load_dwordx4 v47, s[8:11], s40 offen lds
    s_add_u32 m0, s26, 61440
    s_nop 0
    buffer_load_dwordx4 v51, s[12:15], s41 offen lds
    s_waitcnt vmcnt(16)
    s_barrier
    s_waitcnt vmcnt(8)
    s_barrier
    s_waitcnt vmcnt(0)
    s_barrier
    s_endpgm
L_k1_stat:
    s_sub_u32 s24, s20, 8
    v_lshrrev_b32 v4, 1, v1
    s_lshl_b32 s25, s24, 5
    v_add_u32 v4, s25, v4
    v_lshlrev_b32 v5, 7, v4
    v_and_b32 v6, 1, v1
    v_lshl_add_u32 v5, v6, 6, v5
    v_bfe_u32 v6, v1, 2, 2
    v_xor_b32 v7, 0, v6
    v_lshl_add_u32 v8, v7, 4, v5
    v_add_u32 v12, 65536, v8
    v_xor_b32 v7, 1, v6
    v_lshl_add_u32 v9, v7, 4, v5
    v_add_u32 v13, 65536, v9
    v_xor_b32 v7, 2, v6
    v_lshl_add_u32 v10, v7, 4, v5
    v_add_u32 v14, 65536, v10
    v_xor_b32 v7, 3, v6
    v_lshl_add_u32 v11, v7, 4, v5
    v_add_u32 v15, 65536, v11
    v_lshlrev_b32 v40, 2, v4
    v_mov_b32 v36, 0
    v_mov_b32 v37, 0
    v_mov_b32 v38, 0
    v_mov_b32 v39, 0
    v_lshlrev_b32 v41, 16, v1
    s_cmp_lg_u32 s20, 8
    s_cbranch_scc1 L_k1_touch2
L_k1_touch2:
    s_barrier
    ds_read_b128 v[48:51], v8 offset:0
    ds_read_b128 v[52:55], v9 offset:0
    ds_read_b128 v[56:59], v10 offset:0
    ds_read_b128 v[60:63], v11 offset:0
    s_waitcnt lgkmcnt(3)
    v_lshlrev_b32 v32, 16, v48
    v_and_b32 v33, 0xffff0000, v48
    v_add_f32 v36, v36, v32
    v_fmac_f32 v38, v32, v32
    v_add_f32 v37, v37, v33
    v_fmac_f32 v39, v33, v33
    v_lshlrev_b32 v34, 16, v49
    v_and_b32 v35, 0xffff0000, v49
    v_add_f32 v36, v36, v34
    v_fmac_f32 v38, v34, v34
    v_add_f32 v37, v37, v35
    v_fmac_f32 v39, v35, v35
    v_lshlrev_b32 v32, 16, v50
    v_and_b32 v33, 0xffff0000, v50
    v_add_f32 v36, v36, v32
    v_fmac_f32 v38, v32, v32
    v_add_f32 v37, v37, v33
    v_fmac_f32 v39, v33, v33
    v_lshlrev_b32 v34, 16, v51
    v_and_b32 v35, 0xffff0000, v51
    v_add_f32 v36, v36, v34
    v_fmac_f32 v38, v34, v34
    v_add_f32 v37, v37, v35
    v_fmac_f32 v39, v35, v35
    s_waitcnt lgkmcnt(2)
    v_lshlrev_b32 v32, 16, v52
    v_and_b32 v33, 0xffff0000, v52
    v_add_f32 v36, v36, v32
    v_fmac_f32 v38, v32, v32
    v_add_f32 v37, v37, v33
    v_fmac_f32 v39, v33, v33
    v_lshlrev_b32 v34, 16, v53
    v_and_b32 v35, 0xffff0000, v53
    v_add_f32 v36, v36, v34
    v_fmac_f32 v38, v34, v34
    v_add_f32 v37, v37, v35
    v_fmac_f32 v39, v35, v35
    v_lshlrev_b32 v32, 16, v54
    v_and_b32 v33, 0xffff0000, v54
    v_add_f32 v36, v36, v32
    v_fmac_f32 v38, v32, v32
    v_add_f32 v37, v37, v33
    v_fmac_f32 v39, v33, v33
    v_lshlrev_b32 v34, 16, v55
    v_and_b32 v35, 0xffff0000, v55
    v_add_f32 v36, v36, v34
    v_fmac_f32 v38, v34, v34
    v_add_f32 v37, v37, v35
    v_fmac_f32 v39, v35, v35
    s_waitcnt lgkmcnt(1)
    v_lshlrev_b32 v32, 16, v56
    v_and_b32 v33, 0xffff0000, v56
    v_add_f32 v36, v36, v32
    v_fmac_f32 v38, v32, v32
    v_add_f32 v37, v37, v33
    v_fmac_f32 v39, v33, v33
    v_lshlrev_b32 v34, 16, v57
    v_and_b32 v35, 0xffff0000, v57
    v_add_f32 v36, v36, v34
    v_fmac_f32 v38, v34, v34
    v_add_f32 v37, v37, v35
    v_fmac_f32 v39, v35, v35
    v_lshlrev_b32 v32, 16, v58
    v_and_b32 v33, 0xffff0000, v58
    v_add_f32 v36, v36, v32
    v_fmac_f32 v38, v32, v32
    v_add_f32 v37, v37, v33
    v_fmac_f32 v39, v33, v33
    v_lshlrev_b32 v34, 16, v59
    v_and_b32 v35, 0xffff0000, v59
    v_add_f32 v36, v36, v34
    v_fmac_f32 v38, v34, v34
    v_add_f32 v37, v37, v35
    v_fmac_f32 v39, v35, v35
    s_waitcnt lgkmcnt(0)
    v_lshlrev_b32 v32, 16, v60
    v_and_b32 v33, 0xffff0000, v60
    v_add_f32 v36, v36, v32
    v_fmac_f32 v38, v32, v32
    v_add_f32 v37, v37, v33
    v_fmac_f32 v39, v33, v33
    v_lshlrev_b32 v34, 16, v61
    v_and_b32 v35, 0xffff0000, v61
    v_add_f32 v36, v36, v34
    v_fmac_f32 v38, v34, v34
    v_add_f32 v37, v37, v35
    v_fmac_f32 v39, v35, v35
    v_lshlrev_b32 v32, 16, v62
    v_and_b32 v33, 0xffff0000, v62
    v_add_f32 v36, v36, v32
    v_fmac_f32 v38, v32, v32
    v_add_f32 v37, v37, v33
    v_fmac_f32 v39, v33, v33
    v_lshlrev_b32 v34, 16, v63
    v_and_b32 v35, 0xffff0000, v63
    v_add_f32 v36, v36, v34
    v_fmac_f32 v38, v34, v34
    v_add_f32 v37, v37, v35
    v_fmac_f32 v39, v35, v35
    s_barrier
    ds_read_b128 v[48:51], v8 offset:32768
    ds_read_b128 v[52:55], v9 offset:32768
    ds_read_b128 v[56:59], v10 offset:32768
    ds_read_b128 v[60:63], v11 offset:32768
    s_waitcnt lgkmcnt(3)
    v_lshlrev_b32 v32, 16, v48
    v_and_b32 v33, 0xffff0000, v48
    v_add_f32 v36, v36, v32
    v_fmac_f32 v38, v32, v32
    v_add_f32 v37, v37, v33
    v_fmac_f32 v39, v33, v33
    v_lshlrev_b32 v34, 16, v49
    v_and_b32 v35, 0xffff0000, v49
    v_add_f32 v36, v36, v34
    v_fmac_f32 v38, v34, v34
    v_add_f32 v37, v37, v35
    v_fmac_f32 v39, v35, v35
    v_lshlrev_b32 v32, 16, v50
    v_and_b32 v33, 0xffff0000, v50
    v_add_f32 v36, v36, v32
    v_fmac_f32 v38, v32, v32
    v_add_f32 v37, v37, v33
    v_fmac_f32 v39, v33, v33
    v_lshlrev_b32 v34, 16, v51
    v_and_b32 v35, 0xffff0000, v51
    v_add_f32 v36, v36, v34
    v_fmac_f32 v38, v34, v34
    v_add_f32 v37, v37, v35
    v_fmac_f32 v39, v35, v35
    s_waitcnt lgkmcnt(2)
    v_lshlrev_b32 v32, 16, v52
    v_and_b32 v33, 0xffff0000, v52
    v_add_f32 v36, v36, v32
    v_fmac_f32 v38, v32, v32
    v_add_f32 v37, v37, v33
    v_fmac_f32 v39, v33, v33
    v_lshlrev_b32 v34, 16, v53
    v_and_b32 v35, 0xffff0000, v53
    v_add_f32 v36, v36, v34
    v_fmac_f32 v38, v34, v34
    v_add_f32 v37, v37, v35
    v_fmac_f32 v39, v35, v35
    v_lshlrev_b32 v32, 16, v54
    v_and_b32 v33, 0xffff0000, v54
    v_add_f32 v36, v36, v32
    v_fmac_f32 v38, v32, v32
    v_add_f32 v37, v37, v33
    v_fmac_f32 v39, v33, v33
    v_lshlrev_b32 v34, 16, v55
    v_and_b32 v35, 0xffff0000, v55
    v_add_f32 v36, v36, v34
    v_fmac_f32 v38, v34, v34
    v_add_f32 v37, v37, v35
    v_fmac_f32 v39, v35, v35
    s_waitcnt lgkmcnt(1)
    v_lshlrev_b32 v32, 16, v56
    v_and_b32 v33, 0xffff0000, v56
    v_add_f32 v36, v36, v32
    v_fmac_f32 v38, v32, v32
    v_add_f32 v37, v37, v33
    v_fmac_f32 v39, v33, v33
    v_lshlrev_b32 v34, 16, v57
    v_and_b32 v35, 0xffff0000, v57
    v_add_f32 v36, v36, v34
    v_fmac_f32 v38, v34, v34
    v_add_f32 v37, v37, v35
    v_fmac_f32 v39, v35, v35
    v_lshlrev_b32 v32, 16, v58
    v_and_b32 v33, 0xffff0000, v58
    v_add_f32 v36, v36, v32
    v_fmac_f32 v38, v32, v32
    v_add_f32 v37, v37, v33
    v_fmac_f32 v39, v33, v33
    v_lshlrev_b32 v34, 16, v59
    v_and_b32 v35, 0xffff0000, v59
    v_add_f32 v36, v36, v34
    v_fmac_f32 v38, v34, v34
    v_add_f32 v37, v37, v35
    v_fmac_f32 v39, v35, v35
    s_waitcnt lgkmcnt(0)
    v_lshlrev_b32 v32, 16, v60
    v_and_b32 v33, 0xffff0000, v60
    v_add_f32 v36, v36, v32
    v_fmac_f32 v38, v32, v32
    v_add_f32 v37, v37, v33
    v_fmac_f32 v39, v33, v33
    v_lshlrev_b32 v34, 16, v61
    v_and_b32 v35, 0xffff0000, v61
    v_add_f32 v36, v36, v34
    v_fmac_f32 v38, v34, v34
    v_add_f32 v37, v37, v35
    v_fmac_f32 v39, v35, v35
    v_lshlrev_b32 v32, 16, v62
    v_and_b32 v33, 0xffff0000, v62
    v_add_f32 v36, v36, v32
    v_fmac_f32 v38, v32, v32
    v_add_f32 v37, v37, v33
    v_fmac_f32 v39, v33, v33
    v_lshlrev_b32 v34, 16, v63
    v_and_b32 v35, 0xffff0000, v63
    v_add_f32 v36, v36, v34
    v_fmac_f32 v38, v34, v34
    v_add_f32 v37, v37, v35
    v_fmac_f32 v39, v35, v35
    s_barrier
    ds_read_b128 v[48:51], v12 offset:0
    ds_read_b128 v[52:55], v13 offset:0
    ds_read_b128 v[56:59], v14 offset:0
    ds_read_b128 v[60:63], v15 offset:0
    s_waitcnt lgkmcnt(3)
    v_lshlrev_b32 v32, 16, v48
    v_and_b32 v33, 0xffff0000, v48
    v_add_f32 v36, v36, v32
    v_fmac_f32 v38, v32, v32
    v_add_f32 v37, v37, v33
    v_fmac_f32 v39, v33, v33
    v_lshlrev_b32 v34, 16, v49
    v_and_b32 v35, 0xffff0000, v49
    v_add_f32 v36, v36, v34
    v_fmac_f32 v38, v34, v34
    v_add_f32 v37, v37, v35
    v_fmac_f32 v39, v35, v35
    v_lshlrev_b32 v32, 16, v50
    v_and_b32 v33, 0xffff0000, v50
    v_add_f32 v36, v36, v32
    v_fmac_f32 v38, v32, v32
    v_add_f32 v37, v37, v33
    v_fmac_f32 v39, v33, v33
    v_lshlrev_b32 v34, 16, v51
    v_and_b32 v35, 0xffff0000, v51
    v_add_f32 v36, v36, v34
    v_fmac_f32 v38, v34, v34
    v_add_f32 v37, v37, v35
    v_fmac_f32 v39, v35, v35
    s_waitcnt lgkmcnt(2)
    v_lshlrev_b32 v32, 16, v52
    v_and_b32 v33, 0xffff0000, v52
    v_add_f32 v36, v36, v32
    v_fmac_f32 v38, v32, v32
    v_add_f32 v37, v37, v33
    v_fmac_f32 v39, v33, v33
    v_lshlrev_b32 v34, 16, v53
    v_and_b32 v35, 0xffff0000, v53
    v_add_f32 v36, v36, v34
    v_fmac_f32 v38, v34, v34
    v_add_f32 v37, v37, v35
    v_fmac_f32 v39, v35, v35
    v_lshlrev_b32 v32, 16, v54
    v_and_b32 v33, 0xffff0000, v54
    v_add_f32 v36, v36, v32
    v_fmac_f32 v38, v32, v32
    v_add_f32 v37, v37, v33
    v_fmac_f32 v39, v33, v33
    v_lshlrev_b32 v34, 16, v55
    v_and_b32 v35, 0xffff0000, v55
    v_add_f32 v36, v36, v34
    v_fmac_f32 v38, v34, v34
    v_add_f32 v37, v37, v35
    v_fmac_f32 v39, v35, v35
    s_waitcnt lgkmcnt(1)
    v_lshlrev_b32 v32, 16, v56
    v_and_b32 v33, 0xffff0000, v56
    v_add_f32 v36, v36, v32
    v_fmac_f32 v38, v32, v32
    v_add_f32 v37, v37, v33
    v_fmac_f32 v39, v33, v33
    v_lshlrev_b32 v34, 16, v57
    v_and_b32 v35, 0xffff0000, v57
    v_add_f32 v36, v36, v34
    v_fmac_f32 v38, v34, v34
    v_add_f32 v37, v37, v35
    v_fmac_f32 v39, v35, v35
    v_lshlrev_b32 v32, 16, v58
    v_and_b32 v33, 0xffff0000, v58
    v_add_f32 v36, v36, v32
    v_fmac_f32 v38, v32, v32
    v_add_f32 v37, v37, v33
    v_fmac_f32 v39, v33, v33
    v_lshlrev_b32 v34, 16, v59
    v_and_b32 v35, 0xffff0000, v59
    v_add_f32 v36, v36, v34
    v_fmac_f32 v38, v34, v34
    v_add_f32 v37, v37, v35
    v_fmac_f32 v39, v35, v35
    s_waitcnt lgkmcnt(0)
    v_lshlrev_b32 v32, 16, v60
    v_and_b32 v33, 0xffff0000, v60
    v_add_f32 v36, v36, v32
    v_fmac_f32 v38, v32, v32
    v_add_f32 v37, v37, v33
    v_fmac_f32 v39, v33, v33
    v_lshlrev_b32 v34, 16, v61
    v_and_b32 v35, 0xffff0000, v61
    v_add_f32 v36, v36, v34
    v_fmac_f32 v38, v34, v34
    v_add_f32 v37, v37, v35
    v_fmac_f32 v39, v35, v35
    v_lshlrev_b32 v32, 16, v62
    v_and_b32 v33, 0xffff0000, v62
    v_add_f32 v36, v36, v32
    v_fmac_f32 v38, v32, v32
    v_add_f32 v37, v37, v33
    v_fmac_f32 v39, v33, v33
    v_lshlrev_b32 v34, 16, v63
    v_and_b32 v35, 0xffff0000, v63
    v_add_f32 v36, v36, v34
    v_fmac_f32 v38, v34, v34
    v_add_f32 v37, v37, v35
    v_fmac_f32 v39, v35, v35
    s_barrier
    ds_read_b128 v[48:51], v12 offset:32768
    ds_read_b128 v[52:55], v13 offset:32768
    ds_read_b128 v[56:59], v14 offset:32768
    ds_read_b128 v[60:63], v15 offset:32768
    s_waitcnt lgkmcnt(3)
    v_lshlrev_b32 v32, 16, v48
    v_and_b32 v33, 0xffff0000, v48
    v_add_f32 v36, v36, v32
    v_fmac_f32 v38, v32, v32
    v_add_f32 v37, v37, v33
    v_fmac_f32 v39, v33, v33
    v_lshlrev_b32 v34, 16, v49
    v_and_b32 v35, 0xffff0000, v49
    v_add_f32 v36, v36, v34
    v_fmac_f32 v38, v34, v34
    v_add_f32 v37, v37, v35
    v_fmac_f32 v39, v35, v35
    v_lshlrev_b32 v32, 16, v50
    v_and_b32 v33, 0xffff0000, v50
    v_add_f32 v36, v36, v32
    v_fmac_f32 v38, v32, v32
    v_add_f32 v37, v37, v33
    v_fmac_f32 v39, v33, v33
    v_lshlrev_b32 v34, 16, v51
    v_and_b32 v35, 0xffff0000, v51
    v_add_f32 v36, v36, v34
    v_fmac_f32 v38, v34, v34
    v_add_f32 v37, v37, v35
    v_fmac_f32 v39, v35, v35
    s_waitcnt lgkmcnt(2)
    v_lshlrev_b32 v32, 16, v52
    v_and_b32 v33, 0xffff0000, v52
    v_add_f32 v36, v36, v32
    v_fmac_f32 v38, v32, v32
    v_add_f32 v37, v37, v33
    v_fmac_f32 v39, v33, v33
    v_lshlrev_b32 v34, 16, v53
    v_and_b32 v35, 0xffff0000, v53
    v_add_f32 v36, v36, v34
    v_fmac_f32 v38, v34, v34
    v_add_f32 v37, v37, v35
    v_fmac_f32 v39, v35, v35
    v_lshlrev_b32 v32, 16, v54
    v_and_b32 v33, 0xffff0000, v54
    v_add_f32 v36, v36, v32
    v_fmac_f32 v38, v32, v32
    v_add_f32 v37, v37, v33
    v_fmac_f32 v39, v33, v33
    v_lshlrev_b32 v34, 16, v55
    v_and_b32 v35, 0xffff0000, v55
    v_add_f32 v36, v36, v34
    v_fmac_f32 v38, v34, v34
    v_add_f32 v37, v37, v35
    v_fmac_f32 v39, v35, v35
    s_waitcnt lgkmcnt(1)
    v_lshlrev_b32 v32, 16, v56
    v_and_b32 v33, 0xffff0000, v56
    v_add_f32 v36, v36, v32
    v_fmac_f32 v38, v32, v32
    v_add_f32 v37, v37, v33
    v_fmac_f32 v39, v33, v33
    v_lshlrev_b32 v34, 16, v57
    v_and_b32 v35, 0xffff0000, v57
    v_add_f32 v36, v36, v34
    v_fmac_f32 v38, v34, v34
    v_add_f32 v37, v37, v35
    v_fmac_f32 v39, v35, v35
    v_lshlrev_b32 v32, 16, v58
    v_and_b32 v33, 0xffff0000, v58
    v_add_f32 v36, v36, v32
    v_fmac_f32 v38, v32, v32
    v_add_f32 v37, v37, v33
    v_fmac_f32 v39, v33, v33
    v_lshlrev_b32 v34, 16, v59
    v_and_b32 v35, 0xffff0000, v59
    v_add_f32 v36, v36, v34
    v_fmac_f32 v38, v34, v34
    v_add_f32 v37, v37, v35
    v_fmac_f32 v39, v35, v35
    s_waitcnt lgkmcnt(0)
    v_lshlrev_b32 v32, 16, v60
    v_and_b32 v33, 0xffff0000, v60
    v_add_f32 v36, v36, v32
    v_fmac_f32 v38, v32, v32
    v_add_f32 v37, v37, v33
    v_fmac_f32 v39, v33, v33
    v_lshlrev_b32 v34, 16, v61
    v_and_b32 v35, 0xffff0000, v61
    v_add_f32 v36, v36, v34
    v_fmac_f32 v38, v34, v34
    v_add_f32 v37, v37, v35
    v_fmac_f32 v39, v35, v35
    v_lshlrev_b32 v32, 16, v62
    v_and_b32 v33, 0xffff0000, v62
    v_add_f32 v36, v36, v32
    v_fmac_f32 v38, v32, v32
    v_add_f32 v37, v37, v33
    v_fmac_f32 v39, v33, v33
    v_lshlrev_b32 v34, 16, v63
    v_and_b32 v35, 0xffff0000, v63
    v_add_f32 v36, v36, v34
    v_fmac_f32 v38, v34, v34
    v_add_f32 v37, v37, v35
    v_fmac_f32 v39, v35, v35
    s_barrier
    ds_read_b128 v[48:51], v8 offset:0
    ds_read_b128 v[52:55], v9 offset:0
    ds_read_b128 v[56:59], v10 offset:0
    ds_read_b128 v[60:63], v11 offset:0
    s_waitcnt lgkmcnt(3)
    v_lshlrev_b32 v32, 16, v48
    v_and_b32 v33, 0xffff0000, v48
    v_add_f32 v36, v36, v32
    v_fmac_f32 v38, v32, v32
    v_add_f32 v37, v37, v33
    v_fmac_f32 v39, v33, v33
    v_lshlrev_b32 v34, 16, v49
    v_and_b32 v35, 0xffff0000, v49
    v_add_f32 v36, v36, v34
    v_fmac_f32 v38, v34, v34
    v_add_f32 v37, v37, v35
    v_fmac_f32 v39, v35, v35
    v_lshlrev_b32 v32, 16, v50
    v_and_b32 v33, 0xffff0000, v50
    v_add_f32 v36, v36, v32
    v_fmac_f32 v38, v32, v32
    v_add_f32 v37, v37, v33
    v_fmac_f32 v39, v33, v33
    v_lshlrev_b32 v34, 16, v51
    v_and_b32 v35, 0xffff0000, v51
    v_add_f32 v36, v36, v34
    v_fmac_f32 v38, v34, v34
    v_add_f32 v37, v37, v35
    v_fmac_f32 v39, v35, v35
    s_waitcnt lgkmcnt(2)
    v_lshlrev_b32 v32, 16, v52
    v_and_b32 v33, 0xffff0000, v52
    v_add_f32 v36, v36, v32
    v_fmac_f32 v38, v32, v32
    v_add_f32 v37, v37, v33
    v_fmac_f32 v39, v33, v33
    v_lshlrev_b32 v34, 16, v53
    v_and_b32 v35, 0xffff0000, v53
    v_add_f32 v36, v36, v34
    v_fmac_f32 v38, v34, v34
    v_add_f32 v37, v37, v35
    v_fmac_f32 v39, v35, v35
    v_lshlrev_b32 v32, 16, v54
    v_and_b32 v33, 0xffff0000, v54
    v_add_f32 v36, v36, v32
    v_fmac_f32 v38, v32, v32
    v_add_f32 v37, v37, v33
    v_fmac_f32 v39, v33, v33
    v_lshlrev_b32 v34, 16, v55
    v_and_b32 v35, 0xffff0000, v55
    v_add_f32 v36, v36, v34
    v_fmac_f32 v38, v34, v34
    v_add_f32 v37, v37, v35
    v_fmac_f32 v39, v35, v35
    s_waitcnt lgkmcnt(1)
    v_lshlrev_b32 v32, 16, v56
    v_and_b32 v33, 0xffff0000, v56
    v_add_f32 v36, v36, v32
    v_fmac_f32 v38, v32, v32
    v_add_f32 v37, v37, v33
    v_fmac_f32 v39, v33, v33
    v_lshlrev_b32 v34, 16, v57
    v_and_b32 v35, 0xffff0000, v57
    v_add_f32 v36, v36, v34
    v_fmac_f32 v38, v34, v34
    v_add_f32 v37, v37, v35
    v_fmac_f32 v39, v35, v35
    v_lshlrev_b32 v32, 16, v58
    v_and_b32 v33, 0xffff0000, v58
    v_add_f32 v36, v36, v32
    v_fmac_f32 v38, v32, v32
    v_add_f32 v37, v37, v33
    v_fmac_f32 v39, v33, v33
    v_lshlrev_b32 v34, 16, v59
    v_and_b32 v35, 0xffff0000, v59
    v_add_f32 v36, v36, v34
    v_fmac_f32 v38, v34, v34
    v_add_f32 v37, v37, v35
    v_fmac_f32 v39, v35, v35
    s_waitcnt lgkmcnt(0)
    v_lshlrev_b32 v32, 16, v60
    v_and_b32 v33, 0xffff0000, v60
    v_add_f32 v36, v36, v32
    v_fmac_f32 v38, v32, v32
    v_add_f32 v37, v37, v33
    v_fmac_f32 v39, v33, v33
    v_lshlrev_b32 v34, 16, v61
    v_and_b32 v35, 0xffff0000, v61
    v_add_f32 v36, v36, v34
    v_fmac_f32 v38, v34, v34
    v_add_f32 v37, v37, v35
    v_fmac_f32 v39, v35, v35
    v_lshlrev_b32 v32, 16, v62
    v_and_b32 v33, 0xffff0000, v62
    v_add_f32 v36, v36, v32
    v_fmac_f32 v38, v32, v32
    v_add_f32 v37, v37, v33
    v_fmac_f32 v39, v33, v33
    v_lshlrev_b32 v34, 16, v63
    v_and_b32 v35, 0xffff0000, v63
    v_add_f32 v36, v36, v34
    v_fmac_f32 v38, v34, v34
    v_add_f32 v37, v37, v35
    v_fmac_f32 v39, v35, v35
    s_barrier
    ds_read_b128 v[48:51], v8 offset:32768
    ds_read_b128 v[52:55], v9 offset:32768
    ds_read_b128 v[56:59], v10 offset:32768
    ds_read_b128 v[60:63], v11 offset:32768
    s_waitcnt lgkmcnt(3)
    v_lshlrev_b32 v32, 16, v48
    v_and_b32 v33, 0xffff0000, v48
    v_add_f32 v36, v36, v32
    v_fmac_f32 v38, v32, v32
    v_add_f32 v37, v37, v33
    v_fmac_f32 v39, v33, v33
    v_lshlrev_b32 v34, 16, v49
    v_and_b32 v35, 0xffff0000, v49
    v_add_f32 v36, v36, v34
    v_fmac_f32 v38, v34, v34
    v_add_f32 v37, v37, v35
    v_fmac_f32 v39, v35, v35
    v_lshlrev_b32 v32, 16, v50
    v_and_b32 v33, 0xffff0000, v50
    v_add_f32 v36, v36, v32
    v_fmac_f32 v38, v32, v32
    v_add_f32 v37, v37, v33
    v_fmac_f32 v39, v33, v33
    v_lshlrev_b32 v34, 16, v51
    v_and_b32 v35, 0xffff0000, v51
    v_add_f32 v36, v36, v34
    v_fmac_f32 v38, v34, v34
    v_add_f32 v37, v37, v35
    v_fmac_f32 v39, v35, v35
    s_waitcnt lgkmcnt(2)
    v_lshlrev_b32 v32, 16, v52
    v_and_b32 v33, 0xffff0000, v52
    v_add_f32 v36, v36, v32
    v_fmac_f32 v38, v32, v32
    v_add_f32 v37, v37, v33
    v_fmac_f32 v39, v33, v33
    v_lshlrev_b32 v34, 16, v53
    v_and_b32 v35, 0xffff0000, v53
    v_add_f32 v36, v36, v34
    v_fmac_f32 v38, v34, v34
    v_add_f32 v37, v37, v35
    v_fmac_f32 v39, v35, v35
    v_lshlrev_b32 v32, 16, v54
    v_and_b32 v33, 0xffff0000, v54
    v_add_f32 v36, v36, v32
    v_fmac_f32 v38, v32, v32
    v_add_f32 v37, v37, v33
    v_fmac_f32 v39, v33, v33
    v_lshlrev_b32 v34, 16, v55
    v_and_b32 v35, 0xffff0000, v55
    v_add_f32 v36, v36, v34
    v_fmac_f32 v38, v34, v34
    v_add_f32 v37, v37, v35
    v_fmac_f32 v39, v35, v35
    s_waitcnt lgkmcnt(1)
    v_lshlrev_b32 v32, 16, v56
    v_and_b32 v33, 0xffff0000, v56
    v_add_f32 v36, v36, v32
    v_fmac_f32 v38, v32, v32
    v_add_f32 v37, v37, v33
    v_fmac_f32 v39, v33, v33
    v_lshlrev_b32 v34, 16, v57
    v_and_b32 v35, 0xffff0000, v57
    v_add_f32 v36, v36, v34
    v_fmac_f32 v38, v34, v34
    v_add_f32 v37, v37, v35
    v_fmac_f32 v39, v35, v35
    v_lshlrev_b32 v32, 16, v58
    v_and_b32 v33, 0xffff0000, v58
    v_add_f32 v36, v36, v32
    v_fmac_f32 v38, v32, v32
    v_add_f32 v37, v37, v33
    v_fmac_f32 v39, v33, v33
    v_lshlrev_b32 v34, 16, v59
    v_and_b32 v35, 0xffff0000, v59
    v_add_f32 v36, v36, v34
    v_fmac_f32 v38, v34, v34
    v_add_f32 v37, v37, v35
    v_fmac_f32 v39, v35, v35
    s_waitcnt lgkmcnt(0)
    v_lshlrev_b32 v32, 16, v60
    v_and_b32 v33, 0xffff0000, v60
    v_add_f32 v36, v36, v32
    v_fmac_f32 v38, v32, v32
    v_add_f32 v37, v37, v33
    v_fmac_f32 v39, v33, v33
    v_lshlrev_b32 v34, 16, v61
    v_and_b32 v35, 0xffff0000, v61
    v_add_f32 v36, v36, v34
    v_fmac_f32 v38, v34, v34
    v_add_f32 v37, v37, v35
    v_fmac_f32 v39, v35, v35
    v_lshlrev_b32 v32, 16, v62
    v_and_b32 v33, 0xffff0000, v62
    v_add_f32 v36, v36, v32
    v_fmac_f32 v38, v32, v32
    v_add_f32 v37, v37, v33
    v_fmac_f32 v39, v33, v33
    v_lshlrev_b32 v34, 16, v63
    v_and_b32 v35, 0xffff0000, v63
    v_add_f32 v36, v36, v34
    v_fmac_f32 v38, v34, v34
    v_add_f32 v37, v37, v35
    v_fmac_f32 v39, v35, v35
    s_barrier
    ds_read_b128 v[48:51], v12 offset:0
    ds_read_b128 v[52:55], v13 offset:0
    ds_read_b128 v[56:59], v14 offset:0
    ds_read_b128 v[60:63], v15 offset:0
    s_waitcnt lgkmcnt(3)
    v_lshlrev_b32 v32, 16, v48
    v_and_b32 v33, 0xffff0000, v48
    v_add_f32 v36, v36, v32
    v_fmac_f32 v38, v32, v32
    v_add_f32 v37, v37, v33
    v_fmac_f32 v39, v33, v33
    v_lshlrev_b32 v34, 16, v49
    v_and_b32 v35, 0xffff0000, v49
    v_add_f32 v36, v36, v34
    v_fmac_f32 v38, v34, v34
    v_add_f32 v37, v37, v35
    v_fmac_f32 v39, v35, v35
    v_lshlrev_b32 v32, 16, v50
    v_and_b32 v33, 0xffff0000, v50
    v_add_f32 v36, v36, v32
    v_fmac_f32 v38, v32, v32
    v_add_f32 v37, v37, v33
    v_fmac_f32 v39, v33, v33
    v_lshlrev_b32 v34, 16, v51
    v_and_b32 v35, 0xffff0000, v51
    v_add_f32 v36, v36, v34
    v_fmac_f32 v38, v34, v34
    v_add_f32 v37, v37, v35
    v_fmac_f32 v39, v35, v35
    s_waitcnt lgkmcnt(2)
    v_lshlrev_b32 v32, 16, v52
    v_and_b32 v33, 0xffff0000, v52
    v_add_f32 v36, v36, v32
    v_fmac_f32 v38, v32, v32
    v_add_f32 v37, v37, v33
    v_fmac_f32 v39, v33, v33
    v_lshlrev_b32 v34, 16, v53
    v_and_b32 v35, 0xffff0000, v53
    v_add_f32 v36, v36, v34
    v_fmac_f32 v38, v34, v34
    v_add_f32 v37, v37, v35
    v_fmac_f32 v39, v35, v35
    v_lshlrev_b32 v32, 16, v54
    v_and_b32 v33, 0xffff0000, v54
    v_add_f32 v36, v36, v32
    v_fmac_f32 v38, v32, v32
    v_add_f32 v37, v37, v33
    v_fmac_f32 v39, v33, v33
    v_lshlrev_b32 v34, 16, v55
    v_and_b32 v35, 0xffff0000, v55
    v_add_f32 v36, v36, v34
    v_fmac_f32 v38, v34, v34
    v_add_f32 v37, v37, v35
    v_fmac_f32 v39, v35, v35
    s_waitcnt lgkmcnt(1)
    v_lshlrev_b32 v32, 16, v56
    v_and_b32 v33, 0xffff0000, v56
    v_add_f32 v36, v36, v32
    v_fmac_f32 v38, v32, v32
    v_add_f32 v37, v37, v33
    v_fmac_f32 v39, v33, v33
    v_lshlrev_b32 v34, 16, v57
    v_and_b32 v35, 0xffff0000, v57
    v_add_f32 v36, v36, v34
    v_fmac_f32 v38, v34, v34
    v_add_f32 v37, v37, v35
    v_fmac_f32 v39, v35, v35
    v_lshlrev_b32 v32, 16, v58
    v_and_b32 v33, 0xffff0000, v58
    v_add_f32 v36, v36, v32
    v_fmac_f32 v38, v32, v32
    v_add_f32 v37, v37, v33
    v_fmac_f32 v39, v33, v33
    v_lshlrev_b32 v34, 16, v59
    v_and_b32 v35, 0xffff0000, v59
    v_add_f32 v36, v36, v34
    v_fmac_f32 v38, v34, v34
    v_add_f32 v37, v37, v35
    v_fmac_f32 v39, v35, v35
    s_waitcnt lgkmcnt(0)
    v_lshlrev_b32 v32, 16, v60
    v_and_b32 v33, 0xffff0000, v60
    v_add_f32 v36, v36, v32
    v_fmac_f32 v38, v32, v32
    v_add_f32 v37, v37, v33
    v_fmac_f32 v39, v33, v33
    v_lshlrev_b32 v34, 16, v61
    v_and_b32 v35, 0xffff0000, v61
    v_add_f32 v36, v36, v34
    v_fmac_f32 v38, v34, v34
    v_add_f32 v37, v37, v35
    v_fmac_f32 v39, v35, v35
    v_lshlrev_b32 v32, 16, v62
    v_and_b32 v33, 0xffff0000, v62
    v_add_f32 v36, v36, v32
    v_fmac_f32 v38, v32, v32
    v_add_f32 v37, v37, v33
    v_fmac_f32 v39, v33, v33
    v_lshlrev_b32 v34, 16, v63
    v_and_b32 v35, 0xffff0000, v63
    v_add_f32 v36, v36, v34
    v_fmac_f32 v38, v34, v34
    v_add_f32 v37, v37, v35
    v_fmac_f32 v39, v35, v35
    s_barrier
    ds_read_b128 v[48:51], v12 offset:32768
    ds_read_b128 v[52:55], v13 offset:32768
    ds_read_b128 v[56:59], v14 offset:32768
    ds_read_b128 v[60:63], v15 offset:32768
    s_waitcnt lgkmcnt(3)
    v_lshlrev_b32 v32, 16, v48
    v_and_b32 v33, 0xffff0000, v48
    v_add_f32 v36, v36, v32
    v_fmac_f32 v38, v32, v32
    v_add_f32 v37, v37, v33
    v_fmac_f32 v39, v33, v33
    v_lshlrev_b32 v34, 16, v49
    v_and_b32 v35, 0xffff0000, v49
    v_add_f32 v36, v36, v34
    v_fmac_f32 v38, v34, v34
    v_add_f32 v37, v37, v35
    v_fmac_f32 v39, v35, v35
    v_lshlrev_b32 v32, 16, v50
    v_and_b32 v33, 0xffff0000, v50
    v_add_f32 v36, v36, v32
    v_fmac_f32 v38, v32, v32
    v_add_f32 v37, v37, v33
    v_fmac_f32 v39, v33, v33
    v_lshlrev_b32 v34, 16, v51
    v_and_b32 v35, 0xffff0000, v51
    v_add_f32 v36, v36, v34
    v_fmac_f32 v38, v34, v34
    v_add_f32 v37, v37, v35
    v_fmac_f32 v39, v35, v35
    s_waitcnt lgkmcnt(2)
    v_lshlrev_b32 v32, 16, v52
    v_and_b32 v33, 0xffff0000, v52
    v_add_f32 v36, v36, v32
    v_fmac_f32 v38, v32, v32
    v_add_f32 v37, v37, v33
    v_fmac_f32 v39, v33, v33
    v_lshlrev_b32 v34, 16, v53
    v_and_b32 v35, 0xffff0000, v53
    v_add_f32 v36, v36, v34
    v_fmac_f32 v38, v34, v34
    v_add_f32 v37, v37, v35
    v_fmac_f32 v39, v35, v35
    v_lshlrev_b32 v32, 16, v54
    v_and_b32 v33, 0xffff0000, v54
    v_add_f32 v36, v36, v32
    v_fmac_f32 v38, v32, v32
    v_add_f32 v37, v37, v33
    v_fmac_f32 v39, v33, v33
    v_lshlrev_b32 v34, 16, v55
    v_and_b32 v35, 0xffff0000, v55
    v_add_f32 v36, v36, v34
    v_fmac_f32 v38, v34, v34
    v_add_f32 v37, v37, v35
    v_fmac_f32 v39, v35, v35
    s_waitcnt lgkmcnt(1)
    v_lshlrev_b32 v32, 16, v56
    v_and_b32 v33, 0xffff0000, v56
    v_add_f32 v36, v36, v32
    v_fmac_f32 v38, v32, v32
    v_add_f32 v37, v37, v33
    v_fmac_f32 v39, v33, v33
    v_lshlrev_b32 v34, 16, v57
    v_and_b32 v35, 0xffff0000, v57
    v_add_f32 v36, v36, v34
    v_fmac_f32 v38, v34, v34
    v_add_f32 v37, v37, v35
    v_fmac_f32 v39, v35, v35
    v_lshlrev_b32 v32, 16, v58
    v_and_b32 v33, 0xffff0000, v58
    v_add_f32 v36, v36, v32
    v_fmac_f32 v38, v32, v32
    v_add_f32 v37, v37, v33
    v_fmac_f32 v39, v33, v33
    v_lshlrev_b32 v34, 16, v59
    v_and_b32 v35, 0xffff0000, v59
    v_add_f32 v36, v36, v34
    v_fmac_f32 v38, v34, v34
    v_add_f32 v37, v37, v35
    v_fmac_f32 v39, v35, v35
    s_waitcnt lgkmcnt(0)
    v_lshlrev_b32 v32, 16, v60
    v_and_b32 v33, 0xffff0000, v60
    v_add_f32 v36, v36, v32
    v_fmac_f32 v38, v32, v32
    v_add_f32 v37, v37, v33
    v_fmac_f32 v39, v33, v33
    v_lshlrev_b32 v34, 16, v61
    v_and_b32 v35, 0xffff0000, v61
    v_add_f32 v36, v36, v34
    v_fmac_f32 v38, v34, v34
    v_add_f32 v37, v37, v35
    v_fmac_f32 v39, v35, v35
    v_lshlrev_b32 v32, 16, v62
    v_and_b32 v33, 0xffff0000, v62
    v_add_f32 v36, v36, v32
    v_fmac_f32 v38, v32, v32
    v_add_f32 v37, v37, v33
    v_fmac_f32 v39, v33, v33
    v_lshlrev_b32 v34, 16, v63
    v_and_b32 v35, 0xffff0000, v63
    v_add_f32 v36, v36, v34
    v_fmac_f32 v38, v34, v34
    v_add_f32 v37, v37, v35
    v_fmac_f32 v39, v35, v35
    s_barrier
    ds_read_b128 v[48:51], v8 offset:0
    ds_read_b128 v[52:55], v9 offset:0
    ds_read_b128 v[56:59], v10 offset:0
    ds_read_b128 v[60:63], v11 offset:0
    s_waitcnt lgkmcnt(3)
    v_lshlrev_b32 v32, 16, v48
    v_and_b32 v33, 0xffff0000, v48
    v_add_f32 v36, v36, v32
    v_fmac_f32 v38, v32, v32
    v_add_f32 v37, v37, v33
    v_fmac_f32 v39, v33, v33
    v_lshlrev_b32 v34, 16, v49
    v_and_b32 v35, 0xffff0000, v49
    v_add_f32 v36, v36, v34
    v_fmac_f32 v38, v34, v34
    v_add_f32 v37, v37, v35
    v_fmac_f32 v39, v35, v35
    v_lshlrev_b32 v32, 16, v50
    v_and_b32 v33, 0xffff0000, v50
    v_add_f32 v36, v36, v32
    v_fmac_f32 v38, v32, v32
    v_add_f32 v37, v37, v33
    v_fmac_f32 v39, v33, v33
    v_lshlrev_b32 v34, 16, v51
    v_and_b32 v35, 0xffff0000, v51
    v_add_f32 v36, v36, v34
    v_fmac_f32 v38, v34, v34
    v_add_f32 v37, v37, v35
    v_fmac_f32 v39, v35, v35
    s_waitcnt lgkmcnt(2)
    v_lshlrev_b32 v32, 16, v52
    v_and_b32 v33, 0xffff0000, v52
    v_add_f32 v36, v36, v32
    v_fmac_f32 v38, v32, v32
    v_add_f32 v37, v37, v33
    v_fmac_f32 v39, v33, v33
    v_lshlrev_b32 v34, 16, v53
    v_and_b32 v35, 0xffff0000, v53
    v_add_f32 v36, v36, v34
    v_fmac_f32 v38, v34, v34
    v_add_f32 v37, v37, v35
    v_fmac_f32 v39, v35, v35
    v_lshlrev_b32 v32, 16, v54
    v_and_b32 v33, 0xffff0000, v54
    v_add_f32 v36, v36, v32
    v_fmac_f32 v38, v32, v32
    v_add_f32 v37, v37, v33
    v_fmac_f32 v39, v33, v33
    v_lshlrev_b32 v34, 16, v55
    v_and_b32 v35, 0xffff0000, v55
    v_add_f32 v36, v36, v34
    v_fmac_f32 v38, v34, v34
    v_add_f32 v37, v37, v35
    v_fmac_f32 v39, v35, v35
    s_waitcnt lgkmcnt(1)
    v_lshlrev_b32 v32, 16, v56
    v_and_b32 v33, 0xffff0000, v56
    v_add_f32 v36, v36, v32
    v_fmac_f32 v38, v32, v32
    v_add_f32 v37, v37, v33
    v_fmac_f32 v39, v33, v33
    v_lshlrev_b32 v34, 16, v57
    v_and_b32 v35, 0xffff0000, v57
    v_add_f32 v36, v36, v34
    v_fmac_f32 v38, v34, v34
    v_add_f32 v37, v37, v35
    v_fmac_f32 v39, v35, v35
    v_lshlrev_b32 v32, 16, v58
    v_and_b32 v33, 0xffff0000, v58
    v_add_f32 v36, v36, v32
    v_fmac_f32 v38, v32, v32
    v_add_f32 v37, v37, v33
    v_fmac_f32 v39, v33, v33
    v_lshlrev_b32 v34, 16, v59
    v_and_b32 v35, 0xffff0000, v59
    v_add_f32 v36, v36, v34
    v_fmac_f32 v38, v34, v34
    v_add_f32 v37, v37, v35
    v_fmac_f32 v39, v35, v35
    s_waitcnt lgkmcnt(0)
    v_lshlrev_b32 v32, 16, v60
    v_and_b32 v33, 0xffff0000, v60
    v_add_f32 v36, v36, v32
    v_fmac_f32 v38, v32, v32
    v_add_f32 v37, v37, v33
    v_fmac_f32 v39, v33, v33
    v_lshlrev_b32 v34, 16, v61
    v_and_b32 v35, 0xffff0000, v61
    v_add_f32 v36, v36, v34
    v_fmac_f32 v38, v34, v34
    v_add_f32 v37, v37, v35
    v_fmac_f32 v39, v35, v35
    v_lshlrev_b32 v32, 16, v62
    v_and_b32 v33, 0xffff0000, v62
    v_add_f32 v36, v36, v32
    v_fmac_f32 v38, v32, v32
    v_add_f32 v37, v37, v33
    v_fmac_f32 v39, v33, v33
    v_lshlrev_b32 v34, 16, v63
    v_and_b32 v35, 0xffff0000, v63
    v_add_f32 v36, v36, v34
    v_fmac_f32 v38, v34, v34
    v_add_f32 v37, v37, v35
    v_fmac_f32 v39, v35, v35
    s_barrier
    s_setprio 0
    ds_read_b128 v[48:51], v8 offset:32768
    ds_read_b128 v[52:55], v9 offset:32768
    ds_read_b128 v[56:59], v10 offset:32768
    ds_read_b128 v[60:63], v11 offset:32768
    s_waitcnt lgkmcnt(3)
    v_lshlrev_b32 v32, 16, v48
    v_and_b32 v33, 0xffff0000, v48
    v_add_f32 v36, v36, v32
    v_fmac_f32 v38, v32, v32
    v_add_f32 v37, v37, v33
    v_fmac_f32 v39, v33, v33
    v_lshlrev_b32 v34, 16, v49
    v_and_b32 v35, 0xffff0000, v49
    v_add_f32 v36, v36, v34
    v_fmac_f32 v38, v34, v34
    v_add_f32 v37, v37, v35
    v_fmac_f32 v39, v35, v35
    v_lshlrev_b32 v32, 16, v50
    v_and_b32 v33, 0xffff0000, v50
    v_add_f32 v36, v36, v32
    v_fmac_f32 v38, v32, v32
    v_add_f32 v37, v37, v33
    v_fmac_f32 v39, v33, v33
    v_lshlrev_b32 v34, 16, v51
    v_and_b32 v35, 0xffff0000, v51
    v_add_f32 v36, v36, v34
    v_fmac_f32 v38, v34, v34
    v_add_f32 v37, v37, v35
    v_fmac_f32 v39, v35, v35
    s_waitcnt lgkmcnt(2)
    v_lshlrev_b32 v32, 16, v52
    v_and_b32 v33, 0xffff0000, v52
    v_add_f32 v36, v36, v32
    v_fmac_f32 v38, v32, v32
    v_add_f32 v37, v37, v33
    v_fmac_f32 v39, v33, v33
    v_lshlrev_b32 v34, 16, v53
    v_and_b32 v35, 0xffff0000, v53
    v_add_f32 v36, v36, v34
    v_fmac_f32 v38, v34, v34
    v_add_f32 v37, v37, v35
    v_fmac_f32 v39, v35, v35
    v_lshlrev_b32 v32, 16, v54
    v_and_b32 v33, 0xffff0000, v54
    v_add_f32 v36, v36, v32
    v_fmac_f32 v38, v32, v32
    v_add_f32 v37, v37, v33
    v_fmac_f32 v39, v33, v33
    v_lshlrev_b32 v34, 16, v55
    v_and_b32 v35, 0xffff0000, v55
    v_add_f32 v36, v36, v34
    v_fmac_f32 v38, v34, v34
    v_add_f32 v37, v37, v35
    v_fmac_f32 v39, v35, v35
    s_waitcnt lgkmcnt(1)
    v_lshlrev_b32 v32, 16, v56
    v_and_b32 v33, 0xffff0000, v56
    v_add_f32 v36, v36, v32
    v_fmac_f32 v38, v32, v32
    v_add_f32 v37, v37, v33
    v_fmac_f32 v39, v33, v33
    v_lshlrev_b32 v34, 16, v57
    v_and_b32 v35, 0xffff0000, v57
    v_add_f32 v36, v36, v34
    v_fmac_f32 v38, v34, v34
    v_add_f32 v37, v37, v35
    v_fmac_f32 v39, v35, v35
    v_lshlrev_b32 v32, 16, v58
    v_and_b32 v33, 0xffff0000, v58
    v_add_f32 v36, v36, v32
    v_fmac_f32 v38, v32, v32
    v_add_f32 v37, v37, v33
    v_fmac_f32 v39, v33, v33
    v_lshlrev_b32 v34, 16, v59
    v_and_b32 v35, 0xffff0000, v59
    v_add_f32 v36, v36, v34
    v_fmac_f32 v38, v34, v34
    v_add_f32 v37, v37, v35
    v_fmac_f32 v39, v35, v35
    s_waitcnt lgkmcnt(0)
    v_lshlrev_b32 v32, 16, v60
    v_and_b32 v33, 0xffff0000, v60
    v_add_f32 v36, v36, v32
    v_fmac_f32 v38, v32, v32
    v_add_f32 v37, v37, v33
    v_fmac_f32 v39, v33, v33
    v_lshlrev_b32 v34, 16, v61
    v_and_b32 v35, 0xffff0000, v61
    v_add_f32 v36, v36, v34
    v_fmac_f32 v38, v34, v34
    v_add_f32 v37, v37, v35
    v_fmac_f32 v39, v35, v35
    v_lshlrev_b32 v32, 16, v62
    v_and_b32 v33, 0xffff0000, v62
    v_add_f32 v36, v36, v32
    v_fmac_f32 v38, v32, v32
    v_add_f32 v37, v37, v33
    v_fmac_f32 v39, v33, v33
    v_lshlrev_b32 v34, 16, v63
    v_and_b32 v35, 0xffff0000, v63
    v_add_f32 v36, v36, v34
    v_fmac_f32 v38, v34, v34
    v_add_f32 v37, v37, v35
    v_fmac_f32 v39, v35, v35
    v_add_f32 v36, v36, v37
    v_add_f32 v38, v38, v39
    s_nop 1
    v_add_f32_dpp v37, v36, v36 quad_perm:[1,0,3,2] row_mask:0xf bank_mask:0xf
    v_add_f32_dpp v39, v38, v38 quad_perm:[1,0,3,2] row_mask:0xf bank_mask:0xf
    v_mul_f32 v36, 0x3acccccd, v37
    v_mul_f32 v38, 0x3acccccd, v39
    v_fma_f32 v38, -v36, v36, v38
    v_max_f32 v38, 0, v38
    v_add_f32 v38, 0x3727c5ac, v38
    v_rsq_f32 v38, v38
    v_sub_f32 v36, 0, v36
    v_add_u32 v40, 131072, v40
    ds_write_b32 v40, v36
    ds_write_b32 v40, v38 offset:512
    s_waitcnt lgkmcnt(0)
    s_barrier
    s_endpgm
L_k1_aux:
    s_cmp_ge_u32 s20, 8
    s_cbranch_scc1 L_k1_exit
    s_load_dwordx2 s[6:7], s[0:1], 16
    s_mov_b32 s40, s38
    s_and_b32 s41, s39, 0xffff
    s_mov_b32 s42, 1280
    s_mov_b32 s43, 0x00020000
    v_lshrrev_b32 v4, 3, v1
    s_lshl_b32 s24, s20, 4
    s_add_u32 s24, s24, s23
    v_add_u32 v14, s24, v4
    v_and_b32 v15, 7, v1
    v_lshlrev_b32 v9, 4, v15
    v_mul_u32_u24 v8, 1280, v14
    v_add_u32 v8, v8, v9
    s_mov_b32 s25, 10240
    s_lshl_b32 s26, s20, 11
    s_add_u32 s26, s26, 52224
    s_mov_b32 m0, s26
    v_lshlrev_b32 v146, 4, v1
    buffer_load_dwordx4 v146, s[40:43], 0 offen lds
    buffer_load_dwordx4 v146, s[40:43], 0 offen offset:1024 lds
    v_add_u32 v9, s26, v9
    buffer_load_dwordx4 v[16:19], v8, s[8:11], 0 offen offset:0
    buffer_load_dwordx4 v[20:23], v8, s[8:11], 0 offen offset:128
    buffer_load_dwordx4 v[24:27], v8, s[8:11], 0 offen offset:256
    buffer_load_dwordx4 v[28:31], v8, s[8:11], 0 offen offset:384
    buffer_load_dwordx4 v[32:35], v8, s[8:11], 0 offen offset:512
    buffer_load_dwordx4 v[36:39], v8, s[8:11], 0 offen offset:640
    buffer_load_dwordx4 v[40:43], v8, s[8:11], 0 offen offset:768
    buffer_load_dwordx4 v[44:47], v8, s[8:11], 0 offen offset:896
    buffer_load_dwordx4 v[48:51], v8, s[8:11], 0 offen offset:1024
    buffer_load_dwordx4 v[52:55], v8, s[8:11], 0 offen offset:1152
    buffer_load_dwordx4 v[56:59], v8, s[8:11], s25 offen offset:0
    buffer_load_dwordx4 v[60:63], v8, s[8:11], s25 offen offset:128
    buffer_load_dwordx4 v[64:67], v8, s[8:11], s25 offen offset:256
    buffer_load_dwordx4 v[68:71], v8, s[8:11], s25 offen offset:384
    buffer_load_dwordx4 v[72:75], v8, s[8:11], s25 offen offset:512
    buffer_load_dwordx4 v[76:79], v8, s[8:11], s25 offen offset:640
    buffer_load_dwordx4 v[80:83], v8, s[8:11], s25 offen offset:768
    buffer_load_dwordx4 v[84:87], v8, s[8:11], s25 offen offset:896
    buffer_load_dwordx4 v[88:91], v8, s[8:11], s25 offen offset:1024
    buffer_load_dwordx4 v[92:95], v8, s[8:11], s25 offen offset:1152
    s_waitcnt vmcnt(20)
    ds_read_b128 v[96:99], v9 offset:0
    ds_read_b128 v[100:103], v9 offset:128
    ds_read_b128 v[104:107], v9 offset:256
    ds_read_b128 v[108:111], v9 offset:384
    ds_read_b128 v[112:115], v9 offset:512
    ds_read_b128 v[116:119], v9 offset:640
    ds_read_b128 v[120:123], v9 offset:768
    ds_read_b128 v[124:127], v9 offset:896
    ds_read_b128 v[128:131], v9 offset:1024
    ds_read_b128 v[132:135], v9 offset:1152
    v_mov_b32 v10, 0
    v_mov_b32 v136, 0
    v_mov_b32 v11, 0
    v_mov_b32 v137, 0
    v_mov_b32 v12, 0
    v_mov_b32 v138, 0
    v_mov_b32 v13, 0
    v_mov_b32 v139, 0x3f803f80
    s_waitcnt vmcnt(10) lgkmcnt(0)
    v_dot2c_f32_bf16 v10, v16, v139
    v_dot2c_f32_bf16 v11, v16, v16
    v_dot2c_f32_bf16 v12, v16, v96
    v_dot2c_f32_bf16 v13, v96, v139
    v_dot2c_f32_bf16 v10, v17, v139
    v_dot2c_f32_bf16 v11, v17, v17
    v_dot2c_f32_bf16 v12, v17, v97
    v_dot2c_f32_bf16 v13, v97, v139
    v_dot2c_f32_bf16 v10, v18, v139
    v_dot2c_f32_bf16 v11, v18, v18
    v_dot2c_f32_bf16 v12, v18, v98
    v_dot2c_f32_bf16 v13, v98, v139
    v_dot2c_f32_bf16 v10, v19, v139
    v_dot2c_f32_bf16 v11, v19, v19
    v_dot2c_f32_bf16 v12, v19, v99
    v_dot2c_f32_bf16 v13, v99, v139
    v_dot2c_f32_bf16 v10, v20, v139
    v_dot2c_f32_bf16 v11, v20, v20
    v_dot2c_f32_bf16 v12, v20, v100
    v_dot2c_f32_bf16 v13, v100, v139
    v_dot2c_f32_bf16 v10, v21, v139
    v_dot2c_f32_bf16 v11, v21, v21
    v_dot2c_f32_bf16 v12, v21, v101
    v_dot2c_f32_bf16 v13, v101, v139
    v_dot2c_f32_bf16 v10, v22, v139
    v_dot2c_f32_bf16 v11, v22, v22
    v_dot2c_f32_bf16 v12, v22, v102
    v_dot2c_f32_bf16 v13, v102, v139
    v_dot2c_f32_bf16 v10, v23, v139
    v_dot2c_f32_bf16 v11, v23, v23
    v_dot2c_f32_bf16 v12, v23, v103
    v_dot2c_f32_bf16 v13, v103, v139
    v_dot2c_f32_bf16 v10, v24, v139
    v_dot2c_f32_bf16 v11, v24, v24
    v_dot2c_f32_bf16 v12, v24, v104
    v_dot2c_f32_bf16 v13, v104, v139
    v_dot2c_f32_bf16 v10, v25, v139
    v_dot2c_f32_bf16 v11, v25, v25
    v_dot2c_f32_bf16 v12, v25, v105
    v_dot2c_f32_bf16 v13, v105, v139
    v_dot2c_f32_bf16 v10, v26, v139
    v_dot2c_f32_bf16 v11, v26, v26
    v_dot2c_f32_bf16 v12, v26, v106
    v_dot2c_f32_bf16 v13, v106, v139
    v_dot2c_f32_bf16 v10, v27, v139
    v_dot2c_f32_bf16 v11, v27, v27
    v_dot2c_f32_bf16 v12, v27, v107
    v_dot2c_f32_bf16 v13, v107, v139
    v_dot2c_f32_bf16 v10, v28, v139
    v_dot2c_f32_bf16 v11, v28, v28
    v_dot2c_f32_bf16 v12, v28, v108
    v_dot2c_f32_bf16 v13, v108, v139
    v_dot2c_f32_bf16 v10, v29, v139
    v_dot2c_f32_bf16 v11, v29, v29
    v_dot2c_f32_bf16 v12, v29, v109
    v_dot2c_f32_bf16 v13, v109, v139
    v_dot2c_f32_bf16 v10, v30, v139
    v_dot2c_f32_bf16 v11, v30, v30
    v_dot2c_f32_bf16 v12, v30, v110
    v_dot2c_f32_bf16 v13, v110, v139
    v_dot2c_f32_bf16 v10, v31, v139
    v_dot2c_f32_bf16 v11, v31, v31
    v_dot2c_f32_bf16 v12, v31, v111
    v_dot2c_f32_bf16 v13, v111, v139
    v_dot2c_f32_bf16 v10, v32, v139
    v_dot2c_f32_bf16 v11, v32, v32
    v_dot2c_f32_bf16 v12, v32, v112
    v_dot2c_f32_bf16 v13, v112, v139
    v_dot2c_f32_bf16 v10, v33, v139
    v_dot2c_f32_bf16 v11, v33, v33
    v_dot2c_f32_bf16 v12, v33, v113
    v_dot2c_f32_bf16 v13, v113, v139
    v_dot2c_f32_bf16 v10, v34, v139
    v_dot2c_f32_bf16 v11, v34, v34
    v_dot2c_f32_bf16 v12, v34, v114
    v_dot2c_f32_bf16 v13, v114, v139
    v_dot2c_f32_bf16 v10, v35, v139
    v_dot2c_f32_bf16 v11, v35, v35
    v_dot2c_f32_bf16 v12, v35, v115
    v_dot2c_f32_bf16 v13, v115, v139
    v_dot2c_f32_bf16 v10, v36, v139
    v_dot2c_f32_bf16 v11, v36, v36
    v_dot2c_f32_bf16 v12, v36, v116
    v_dot2c_f32_bf16 v13, v116, v139
    v_dot2c_f32_bf16 v10, v37, v139
    v_dot2c_f32_bf16 v11, v37, v37
    v_dot2c_f32_bf16 v12, v37, v117
    v_dot2c_f32_bf16 v13, v117, v139
    v_dot2c_f32_bf16 v10, v38, v139
    v_dot2c_f32_bf16 v11, v38, v38
    v_dot2c_f32_bf16 v12, v38, v118
    v_dot2c_f32_bf16 v13, v118, v139
    v_dot2c_f32_bf16 v10, v39, v139
    v_dot2c_f32_bf16 v11, v39, v39
    v_dot2c_f32_bf16 v12, v39, v119
    v_dot2c_f32_bf16 v13, v119, v139
    v_dot2c_f32_bf16 v10, v40, v139
    v_dot2c_f32_bf16 v11, v40, v40
    v_dot2c_f32_bf16 v12, v40, v120
    v_dot2c_f32_bf16 v13, v120, v139
    v_dot2c_f32_bf16 v10, v41, v139
    v_dot2c_f32_bf16 v11, v41, v41
    v_dot2c_f32_bf16 v12, v41, v121
    v_dot2c_f32_bf16 v13, v121, v139
    v_dot2c_f32_bf16 v10, v42, v139
    v_dot2c_f32_bf16 v11, v42, v42
    v_dot2c_f32_bf16 v12, v42, v122
    v_dot2c_f32_bf16 v13, v122, v139
    v_dot2c_f32_bf16 v10, v43, v139
    v_dot2c_f32_bf16 v11, v43, v43
    v_dot2c_f32_bf16 v12, v43, v123
    v_dot2c_f32_bf16 v13, v123, v139
    v_dot2c_f32_bf16 v10, v44, v139
    v_dot2c_f32_bf16 v11, v44, v44
    v_dot2c_f32_bf16 v12, v44, v124
    v_dot2c_f32_bf16 v13, v124, v139
    v_dot2c_f32_bf16 v10, v45, v139
    v_dot2c_f32_bf16 v11, v45, v45
    v_dot2c_f32_bf16 v12, v45, v125
    v_dot2c_f32_bf16 v13, v125, v139
    v_dot2c_f32_bf16 v10, v46, v139
    v_dot2c_f32_bf16 v11, v46, v46
    v_dot2c_f32_bf16 v12, v46, v126
    v_dot2c_f32_bf16 v13, v126, v139
    v_dot2c_f32_bf16 v10, v47, v139
    v_dot2c_f32_bf16 v11, v47, v47
    v_dot2c_f32_bf16 v12, v47, v127
    v_dot2c_f32_bf16 v13, v127, v139
    v_dot2c_f32_bf16 v10, v48, v139
    v_dot2c_f32_bf16 v11, v48, v48
    v_dot2c_f32_bf16 v12, v48, v128
    v_dot2c_f32_bf16 v13, v128, v139
    v_dot2c_f32_bf16 v10, v49, v139
    v_dot2c_f32_bf16 v11, v49, v49
    v_dot2c_f32_bf16 v12, v49, v129
    v_dot2c_f32_bf16 v13, v129, v139
    v_dot2c_f32_bf16 v10, v50, v139
    v_dot2c_f32_bf16 v11, v50, v50
    v_dot2c_f32_bf16 v12, v50, v130
    v_dot2c_f32_bf16 v13, v130, v139
    v_dot2c_f32_bf16 v10, v51, v139
    v_dot2c_f32_bf16 v11, v51, v51
    v_dot2c_f32_bf16 v12, v51, v131
    v_dot2c_f32_bf16 v13, v131, v139
    v_dot2c_f32_bf16 v10, v52, v139
    v_dot2c_f32_bf16 v11, v52, v52
    v_dot2c_f32_bf16 v12, v52, v132
    v_dot2c_f32_bf16 v13, v132, v139
    v_dot2c_f32_bf16 v10, v53, v139
    v_dot2c_f32_bf16 v11, v53, v53
    v_dot2c_f32_bf16 v12, v53, v133
    v_dot2c_f32_bf16 v13, v133, v139
    v_dot2c_f32_bf16 v10, v54, v139
    v_dot2c_f32_bf16 v11, v54, v54
    v_dot2c_f32_bf16 v12, v54, v134
    v_dot2c_f32_bf16 v13, v134, v139
    v_dot2c_f32_bf16 v10, v55, v139
    v_dot2c_f32_bf16 v11, v55, v55
    v_dot2c_f32_bf16 v12, v55, v135
    v_dot2c_f32_bf16 v13, v135, v139
    s_waitcnt vmcnt(0)
    v_dot2c_f32_bf16 v136, v56, v139
    v_dot2c_f32_bf16 v137, v56, v56
    v_dot2c_f32_bf16 v138, v56, v96
    v_dot2c_f32_bf16 v136, v57, v139
    v_dot2c_f32_bf16 v137, v57, v57
    v_dot2c_f32_bf16 v138, v57, v97
    v_dot2c_f32_bf16 v136, v58, v139
    v_dot2c_f32_bf16 v137, v58, v58
    v_dot2c_f32_bf16 v138, v58, v98
    v_dot2c_f32_bf16 v136, v59, v139
    v_dot2c_f32_bf16 v137, v59, v59
    v_dot2c_f32_bf16 v138, v59, v99
    v_dot2c_f32_bf16 v136, v60, v139
    v_dot2c_f32_bf16 v137, v60, v60
    v_dot2c_f32_bf16 v138, v60, v100
    v_dot2c_f32_bf16 v136, v61, v139
    v_dot2c_f32_bf16 v137, v61, v61
    v_dot2c_f32_bf16 v138, v61, v101
    v_dot2c_f32_bf16 v136, v62, v139
    v_dot2c_f32_bf16 v137, v62, v62
    v_dot2c_f32_bf16 v138, v62, v102
    v_dot2c_f32_bf16 v136, v63, v139
    v_dot2c_f32_bf16 v137, v63, v63
    v_dot2c_f32_bf16 v138, v63, v103
    v_dot2c_f32_bf16 v136, v64, v139
    v_dot2c_f32_bf16 v137, v64, v64
    v_dot2c_f32_bf16 v138, v64, v104
    v_dot2c_f32_bf16 v136, v65, v139
    v_dot2c_f32_bf16 v137, v65, v65
    v_dot2c_f32_bf16 v138, v65, v105
    v_dot2c_f32_bf16 v136, v66, v139
    v_dot2c_f32_bf16 v137, v66, v66
    v_dot2c_f32_bf16 v138, v66, v106
    v_dot2c_f32_bf16 v136, v67, v139
    v_dot2c_f32_bf16 v137, v67, v67
    v_dot2c_f32_bf16 v138, v67, v107
    v_dot2c_f32_bf16 v136, v68, v139
    v_dot2c_f32_bf16 v137, v68, v68
    v_dot2c_f32_bf16 v138, v68, v108
    v_dot2c_f32_bf16 v136, v69, v139
    v_dot2c_f32_bf16 v137, v69, v69
    v_dot2c_f32_bf16 v138, v69, v109
    v_dot2c_f32_bf16 v136, v70, v139
    v_dot2c_f32_bf16 v137, v70, v70
    v_dot2c_f32_bf16 v138, v70, v110
    v_dot2c_f32_bf16 v136, v71, v139
    v_dot2c_f32_bf16 v137, v71, v71
    v_dot2c_f32_bf16 v138, v71, v111
    v_dot2c_f32_bf16 v136, v72, v139
    v_dot2c_f32_bf16 v137, v72, v72
    v_dot2c_f32_bf16 v138, v72, v112
    v_dot2c_f32_bf16 v136, v73, v139
    v_dot2c_f32_bf16 v137, v73, v73
    v_dot2c_f32_bf16 v138, v73, v113
    v_dot2c_f32_bf16 v136, v74, v139
    v_dot2c_f32_bf16 v137, v74, v74
    v_dot2c_f32_bf16 v138, v74, v114
    v_dot2c_f32_bf16 v136, v75, v139
    v_dot2c_f32_bf16 v137, v75, v75
    v_dot2c_f32_bf16 v138, v75, v115
    v_dot2c_f32_bf16 v136, v76, v139
    v_dot2c_f32_bf16 v137, v76, v76
    v_dot2c_f32_bf16 v138, v76, v116
    v_dot2c_f32_bf16 v136, v77, v139
    v_dot2c_f32_bf16 v137, v77, v77
    v_dot2c_f32_bf16 v138, v77, v117
    v_dot2c_f32_bf16 v136, v78, v139
    v_dot2c_f32_bf16 v137, v78, v78
    v_dot2c_f32_bf16 v138, v78, v118
    v_dot2c_f32_bf16 v136, v79, v139
    v_dot2c_f32_bf16 v137, v79, v79
    v_dot2c_f32_bf16 v138, v79, v119
    v_dot2c_f32_bf16 v136, v80, v139
    v_dot2c_f32_bf16 v137, v80, v80
    v_dot2c_f32_bf16 v138, v80, v120
    v_dot2c_f32_bf16 v136, v81, v139
    v_dot2c_f32_bf16 v137, v81, v81
    v_dot2c_f32_bf16 v138, v81, v121
    v_dot2c_f32_bf16 v136, v82, v139
    v_dot2c_f32_bf16 v137, v82, v82
    v_dot2c_f32_bf16 v138, v82, v122
    v_dot2c_f32_bf16 v136, v83, v139
    v_dot2c_f32_bf16 v137, v83, v83
    v_dot2c_f32_bf16 v138, v83, v123
    v_dot2c_f32_bf16 v136, v84, v139
    v_dot2c_f32_bf16 v137, v84, v84
    v_dot2c_f32_bf16 v138, v84, v124
    v_dot2c_f32_bf16 v136, v85, v139
    v_dot2c_f32_bf16 v137, v85, v85
    v_dot2c_f32_bf16 v138, v85, v125
    v_dot2c_f32_bf16 v136, v86, v139
    v_dot2c_f32_bf16 v137, v86, v86
    v_dot2c_f32_bf16 v138, v86, v126
    v_dot2c_f32_bf16 v136, v87, v139
    v_dot2c_f32_bf16 v137, v87, v87
    v_dot2c_f32_bf16 v138, v87, v127
    v_dot2c_f32_bf16 v136, v88, v139
    v_dot2c_f32_bf16 v137, v88, v88
    v_dot2c_f32_bf16 v138, v88, v128
    v_dot2c_f32_bf16 v136, v89, v139
    v_dot2c_f32_bf16 v137, v89, v89
    v_dot2c_f32_bf16 v138, v89, v129
    v_dot2c_f32_bf16 v136, v90, v139
    v_dot2c_f32_bf16 v137, v90, v90
    v_dot2c_f32_bf16 v138, v90, v130
    v_dot2c_f32_bf16 v136, v91, v139
    v_dot2c_f32_bf16 v137, v91, v91
    v_dot2c_f32_bf16 v138, v91, v131
    v_dot2c_f32_bf16 v136, v92, v139
    v_dot2c_f32_bf16 v137, v92, v92
    v_dot2c_f32_bf16 v138, v92, v132
    v_dot2c_f32_bf16 v136, v93, v139
    v_dot2c_f32_bf16 v137, v93, v93
    v_dot2c_f32_bf16 v138, v93, v133
    v_dot2c_f32_bf16 v136, v94, v139
    v_dot2c_f32_bf16 v137, v94, v94
    v_dot2c_f32_bf16 v138, v94, v134
    v_dot2c_f32_bf16 v136, v95, v139
    v_dot2c_f32_bf16 v137, v95, v95
    v_dot2c_f32_bf16 v138, v95, v135
    s_nop 3
    v_add_f32_dpp v6, v10, v10 quad_perm:[1,0,3,2] row_mask:0xf bank_mask:0xf
    s_nop 0
    v_mov_b32 v10, v6
    v_add_f32_dpp v6, v136, v136 quad_perm:[1,0,3,2] row_mask:0xf bank_mask:0xf
    s_nop 0
    v_mov_b32 v136, v6
    v_add_f32_dpp v6, v11, v11 quad_perm:[1,0,3,2] row_mask:0xf bank_mask:0xf
    s_nop 0
    v_mov_b32 v11, v6
    v_add_f32_dpp v6, v137, v137 quad_perm:[1,0,3,2] row_mask:0xf bank_mask:0xf
    s_nop 0
    v_mov_b32 v137, v6
    v_add_f32_dpp v6, v12, v12 quad_perm:[1,0,3,2] row_mask:0xf bank_mask:0xf
    s_nop 0
    v_mov_b32 v12, v6
    v_add_f32_dpp v6, v138, v138 quad_perm:[1,0,3,2] row_mask:0xf bank_mask:0xf
    s_nop 0
    v_mov_b32 v138, v6
    v_add_f32_dpp v6, v13, v13 quad_perm:[1,0,3,2] row_mask:0xf bank_mask:0xf
    s_nop 0
    v_mov_b32 v13, v6
    s_nop 1
    v_add_f32_dpp v6, v10, v10 quad_perm:[2,3,0,1] row_mask:0xf bank_mask:0xf
    s_nop 0
    v_mov_b32 v10, v6
    v_add_f32_dpp v6, v136, v136 quad_perm:[2,3,0,1] row_mask:0xf bank_mask:0xf
    s_nop 0
    v_mov_b32 v136, v6
    v_add_f32_dpp v6, v11, v11 quad_perm:[2,3,0,1] row_mask:0xf bank_mask:0xf
    s_nop 0
    v_mov_b32 v11, v6
    v_add_f32_dpp v6, v137, v137 quad_perm:[2,3,0,1] row_mask:0xf bank_mask:0xf
    s_nop 0
    v_mov_b32 v137, v6
    v_add_f32_dpp v6, v12, v12 quad_perm:[2,3,0,1] row_mask:0xf bank_mask:0xf
    s_nop 0
    v_mov_b32 v12, v6
    v_add_f32_dpp v6, v138, v138 quad_perm:[2,3,0,1] row_mask:0xf bank_mask:0xf
    s_nop 0
    v_mov_b32 v138, v6
    v_add_f32_dpp v6, v13, v13 quad_perm:[2,3,0,1] row_mask:0xf bank_mask:0xf
    s_nop 0
    v_mov_b32 v13, v6
    s_nop 1
    v_add_f32_dpp v6, v10, v10 row_half_mirror row_mask:0xf bank_mask:0xf
    s_nop 0
    v_mov_b32 v10, v6
    v_add_f32_dpp v6, v136, v136 row_half_mirror row_mask:0xf bank_mask:0xf
    s_nop 0
    v_mov_b32 v136, v6
    v_add_f32_dpp v6, v11, v11 row_half_mirror row_mask:0xf bank_mask:0xf
    s_nop 0
    v_mov_b32 v11, v6
    v_add_f32_dpp v6, v137, v137 row_half_mirror row_mask:0xf bank_mask:0xf
    s_nop 0
    v_mov_b32 v137, v6
    v_add_f32_dpp v6, v12, v12 row_half_mirror row_mask:0xf bank_mask:0xf
    s_nop 0
    v_mov_b32 v12, v6
    v_add_f32_dpp v6, v138, v138 row_half_mirror row_mask:0xf bank_mask:0xf
    s_nop 0
    v_mov_b32 v138, v6
    v_add_f32_dpp v6, v13, v13 row_half_mirror row_mask:0xf bank_mask:0xf
    s_nop 0
    v_mov_b32 v13, v6
    s_nop 1
    v_cmp_eq_u32 vcc, 1, v15
    v_add_u32 v4, 8, v14
    s_nop 0
    v_cndmask_b32 v10, v10, v136, vcc
    v_cndmask_b32 v11, v11, v137, vcc
    v_cndmask_b32 v12, v12, v138, vcc
    v_cndmask_b32 v4, v14, v4, vcc
    v_mov_b32 v5, v15
    v_mul_f32 v10, 0x3acccccd, v10
    v_mul_f32 v11, 0x3acccccd, v11
    v_fma_f32 v11, -v10, v10, v11
    v_max_f32 v11, 0, v11
    v_add_f32 v11, 0x3727c5ac, v11
    v_rsq_f32 v11, v11
    v_fma_f32 v12, -v10, v13, v12
    v_mul_f32 v12, v12, v11
    v_ashrrev_i32 v6, 31, v12
    v_or_b32 v6, 0x80000000, v6
    v_xor_b32 v6, v6, v12
    v_and_b32 v6, 0xfffff800, v6
    v_or_b32 v6, v6, v4
    v_mov_b32 v14, v10
    v_mov_b32 v15, v11
    v_lshlrev_b32 v8, 3, v4
    v_lshlrev_b32 v9, 2, v4
    v_and_b32 v7, 127, v4
    v_lshlrev_b32 v7, 2, v7
    v_add_u32 v7, 51200, v7
    v_cmp_gt_u32 vcc, 2, v5
    s_mov_b32 s24, 10485760
    s_mov_b32 s25, 10502144
    s_and_saveexec_b64 s[44:45], vcc
    buffer_store_dwordx2 v[14:15], v8, s[16:19], s24 offen
    buffer_store_dword v12, v9, s[16:19], s25 offen
    ds_write_b32 v7, v6
    s_waitcnt lgkmcnt(0)
    s_mov_b64 exec, s[44:45]
    s_barrier
    s_cmp_lg_u32 s20, 0
    s_cbranch_scc1 L_k1_repack
    v_lshlrev_b32 v20, 2, v1
    ds_read_b32 v18, v20 offset:51200
    ds_read_b32 v19, v20 offset:51456
    s_waitcnt lgkmcnt(0)
    v_max_u32 v16, v18, v19
    v_min_u32 v17, v18, v19
    v_xor_b32 v20, 1, v1
    v_lshlrev_b32 v20, 2, v20
    ds_bpermute_b32 v18, v20, v16
    ds_bpermute_b32 v19, v20, v17
    s_waitcnt lgkmcnt(0)
    v_max_u32 v17, v17, v19
    v_min_u32 v19, v16, v18
    v_max_u32 v16, v16, v18
    v_max_u32 v17, v17, v19
    v_xor_b32 v20, 2, v1
    v_lshlrev_b32 v20, 2, v20
    ds_bpermute_b32 v18, v20, v16
    ds_bpermute_b32 v19, v20, v17
    s_waitcnt lgkmcnt(0)
    v_max_u32 v17, v17, v19
    v_min_u32 v19, v16, v18
    v_max_u32 v16, v16, v18
    v_max_u32 v17, v17, v19
    v_xor_b32 v20, 4, v1
    v_lshlrev_b32 v20, 2, v20
    ds_bpermute_b32 v18, v20, v16
    ds_bpermute_b32 v19, v20, v17
    s_waitcnt lgkmcnt(0)
    v_max_u32 v17, v17, v19
    v_min_u32 v19, v16, v18
    v_max_u32 v16, v16, v18
    v_max_u32 v17, v17, v19
    v_xor_b32 v20, 8, v1
    v_lshlrev_b32 v20, 2, v20
    ds_bpermute_b32 v18, v20, v16
    ds_bpermute_b32 v19, v20, v17
    s_waitcnt lgkmcnt(0)
    v_max_u32 v17, v17, v19
    v_min_u32 v19, v16, v18
    v_max_u32 v16, v16, v18
    v_max_u32 v17, v17, v19
    v_xor_b32 v20, 16, v1
    v_lshlrev_b32 v20, 2, v20
    ds_bpermute_b32 v18, v20, v16
    ds_bpermute_b32 v19, v20, v17
    s_waitcnt lgkmcnt(0)
    v_max_u32 v17, v17, v19
    v_min_u32 v19, v16, v18
    v_max_u32 v16, v16, v18
    v_max_u32 v17, v17, v19
    v_xor_b32 v20, 32, v1
    v_lshlrev_b32 v20, 2, v20
    ds_bpermute_b32 v18, v20, v16
    ds_bpermute_b32 v19, v20, v17
    s_waitcnt lgkmcnt(0)
    v_max_u32 v17, v17, v19
    v_min_u32 v19, v16, v18
    v_max_u32 v16, v16, v18
    v_max_u32 v17, v17, v19
    v_mov_b32 v18, v16
    v_mov_b32 v19, v17
    s_lshl_b32 s24, s21, 3
    s_add_u32 s24, s24, 10510336
    v_mov_b32 v20, 0
    v_cmp_eq_u32 vcc, 0, v1
    s_nop 1
    s_and_saveexec_b64 s[44:45], vcc
    buffer_store_dwordx2 v[18:19], v20, s[16:19], s24 offen
    s_mov_b64 exec, -1
    s_cmp_lg_u32 s21, 0
    s_cbranch_scc1 L_k1_repack
    v_lshlrev_b32 v20, 8, v1
    v_mov_b32 v18, 0
    s_mov_b32 s24, 11821312
    v_cmp_gt_u32 vcc, 33, v1
    s_nop 1
    s_mov_b64 exec, vcc
    buffer_store_dword v18, v20, s[16:19], s24 offen
    s_mov_b64 exec, -1
L_k1_repack:
    s_lshr_b32 s48, s21, 1
    s_and_b32 s49, s21, 1
    v_lshlrev_b32 v145, 4, v1
    v_add_u32 v4, 0, v145
    v_mul_u32_u24 v5, 52429, v4
    v_lshrrev_b32 v5, 23, v5
    v_mul_u32_u24 v6, 160, v5
    v_sub_u32 v6, v4, v6
    v_mul_u32_u24 v5, 1280, v5
    v_add_u32 v140, v5, v6
    v_add_u32 v4, 1024, v145
    v_mul_u32_u24 v5, 52429, v4
    v_lshrrev_b32 v5, 23, v5
    v_mul_u32_u24 v6, 160, v5
    v_sub_u32 v6, v4, v6
    v_mul_u32_u24 v5, 1280, v5
    v_add_u32 v141, v5, v6
    v_add_u32 v4, 2048, v145
    v_mul_u32_u24 v5, 52429, v4
    v_lshrrev_b32 v5, 23, v5
    v_mul_u32_u24 v6, 160, v5
    v_sub_u32 v6, v4, v6
    v_mul_u32_u24 v5, 1280, v5
    v_add_u32 v142, v5, v6
    v_add_u32 v4, 3072, v145
    v_mul_u32_u24 v5, 52429, v4
    v_lshrrev_b32 v5, 23, v5
    v_mul_u32_u24 v6, 160, v5
    v_sub_u32 v6, v4, v6
    v_mul_u32_u24 v5, 1280, v5
    v_add_u32 v143, v5, v6
    v_add_u32 v4, 4096, v145
    v_mul_u32_u24 v5, 52429, v4
    v_lshrrev_b32 v5, 23, v5
    v_mul_u32_u24 v6, 160, v5
    v_sub_u32 v6, v4, v6
    v_mul_u32_u24 v5, 1280, v5
    v_add_u32 v144, v5, v6
    s_mov_b32 s60, s6
    s_and_b32 s61, s7, 0xffff
    s_mov_b32 s62, 819200
    s_mov_b32 s63, 0x00020000
    s_mul_i32 s50, s49, 409600
    s_mul_i32 s51, s48, 160
    s_add_u32 s50, s50, s51
    s_add_u32 s51, s20, 0
    s_mul_i32 s27, s51, 40960
    s_add_u32 s27, s27, s50
    s_mul_i32 s28, s51, 5120
    s_add_u32 m0, s28, 0
    s_nop 0
    buffer_load_dwordx4 v140, s[60:63], s27 offen lds
    s_add_u32 m0, s28, 1024
    s_nop 0
    buffer_load_dwordx4 v141, s[60:63], s27 offen lds
    s_add_u32 m0, s28, 2048
    s_nop 0
    buffer_load_dwordx4 v142, s[60:63], s27 offen lds
    s_add_u32 m0, s28, 3072
    s_nop 0
    buffer_load_dwordx4 v143, s[60:63], s27 offen lds
    s_add_u32 m0, s28, 4096
    s_nop 0
    buffer_load_dwordx4 v144, s[60:63], s27 offen lds
    s_cmp_lt_u32 s20, 6
    s_cbranch_scc1 L_rep_loaded
    s_add_u32 s51, s20, 2
    s_mul_i32 s27, s51, 40960
    s_add_u32 s27, s27, s50
    s_mul_i32 s28, s51, 5120
    s_add_u32 m0, s28, 0
    s_nop 0
    buffer_load_dwordx4 v140, s[60:63], s27 offen lds
    s_add_u32 m0, s28, 1024
    s_nop 0
    buffer_load_dwordx4 v141, s[60:63], s27 offen lds
    s_add_u32 m0, s28, 2048
    s_nop 0
    buffer_load_dwordx4 v142, s[60:63], s27 offen lds
    s_add_u32 m0, s28, 3072
    s_nop 0
    buffer_load_dwordx4 v143, s[60:63], s27 offen lds
    s_add_u32 m0, s28, 4096
    s_nop 0
    buffer_load_dwordx4 v144, s[60:63], s27 offen lds
L_rep_loaded:
    v_lshrrev_b32 v2, 4, v1
    v_bfe_u32 v4, v1, 2, 2
    v_and_b32 v5, 3, v1
    v_lshrrev_b32 v6, 1, v2
    v_mul_u32_u24 v6, 20, v6
    v_and_b32 v7, 1, v2
    v_lshl_add_u32 v6, v7, 2, v6
    v_add_u32 v6, v6, v4
    v_mul_u32_u24 v117, 160, v6
    v_lshl_add_u32 v117, v5, 3, v117
    v_mul_u32_u24 v6, 20, v2
    v_add3_u32 v6, v6, v4, 16
    v_mul_u32_u24 v118, 160, v6
    v_lshl_add_u32 v118, v5, 3, v118
    s_lshl_b32 s24, s20, 5
    v_add_u32 v117, s24, v117
    v_add_u32 v118, s24, v118
    s_mul_i32 s24, s48, 20
    s_mul_i32 s25, s49, 10
    s_add_u32 s24, s24, s25
    s_mul_i32 s24, s24, 5
    s_add_u32 s24, s24, s20
    s_lshl_b32 s24, s24, 10
    s_add_u32 s29, s24, 11002112
    s_waitcnt vmcnt(0)
    s_barrier
    s_cmp_ge_u32 s20, 5
    s_cbranch_scc1 L_k1_exit
    ds_read_b64_tr_b16 v[16:17], v117 offset:0
    ds_read_b64_tr_b16 v[18:19], v117 offset:1280
    ds_read_b64_tr_b16 v[20:21], v117 offset:6400
    ds_read_b64_tr_b16 v[22:23], v117 offset:7680
    ds_read_b64_tr_b16 v[24:25], v117 offset:12800
    ds_read_b64_tr_b16 v[26:27], v117 offset:14080
    ds_read_b64_tr_b16 v[28:29], v117 offset:19200
    ds_read_b64_tr_b16 v[30:31], v117 offset:20480
    ds_read_b64_tr_b16 v[32:33], v118 offset:0
    ds_read_b64_tr_b16 v[34:35], v118 offset:12800
    ds_read_b64_tr_b16 v[36:37], v117 offset:25600
    ds_read_b64_tr_b16 v[38:39], v117 offset:26880
    ds_read_b64_tr_b16 v[40:41], v117 offset:32000
    ds_read_b64_tr_b16 v[42:43], v117 offset:33280
    ds_read_b64_tr_b16 v[44:45], v117 offset:38400
    ds_read_b64_tr_b16 v[46:47], v117 offset:39680
    ds_read_b64_tr_b16 v[48:49], v117 offset:44800
    ds_read_b64_tr_b16 v[50:51], v117 offset:46080
    ds_read_b64_tr_b16 v[52:53], v118 offset:25600
    ds_read_b64_tr_b16 v[54:55], v118 offset:38400
    s_waitcnt lgkmcnt(0)
    s_add_u32 s24, s29, 0
    buffer_store_dwordx4 v[16:19], v145, s[16:19], s24 offen
    s_add_u32 s24, s29, 5120
    buffer_store_dwordx4 v[20:23], v145, s[16:19], s24 offen
    s_add_u32 s24, s29, 10240
    buffer_store_dwordx4 v[24:27], v145, s[16:19], s24 offen
    s_add_u32 s24, s29, 15360
    buffer_store_dwordx4 v[28:31], v145, s[16:19], s24 offen
    s_add_u32 s24, s29, 20480
    buffer_store_dwordx4 v[32:35], v145, s[16:19], s24 offen
    s_add_u32 s24, s29, 25600
    buffer_store_dwordx4 v[36:39], v145, s[16:19], s24 offen
    s_add_u32 s24, s29, 30720
    buffer_store_dwordx4 v[40:43], v145, s[16:19], s24 offen
    s_add_u32 s24, s29, 35840
    buffer_store_dwordx4 v[44:47], v145, s[16:19], s24 offen
    s_add_u32 s24, s29, 40960
    buffer_store_dwordx4 v[48:51], v145, s[16:19], s24 offen
    s_add_u32 s24, s29, 46080
    buffer_store_dwordx4 v[52:55], v145, s[16:19], s24 offen
    s_endpgm
L_k1_exit:
    s_endpgm
L_k1_end:
.globl attn_proj_kernel
.p2align 8
.type attn_proj_kernel,@function
attn_proj_kernel:
    s_cmp_ge_u32 s2, 256
    s_cbranch_scc1 L_k2_exit
    s_load_dwordx2 s[4:5], s[0:1], 80
    v_lshrrev_b32 v2, 6, v0
    v_and_b32 v3, 63, v0
    v_readfirstlane_b32 s20, v2
    s_and_b32 s12, s2, 7
    s_lshl_b32 s12, s12, 2
    s_bfe_u32 s13, s2, 0x20003
    s_or_b32 s21, s12, s13
    s_lshr_b32 s32, s2, 5
    s_mul_i32 s22, s21, 163840
    s_add_u32 s22, s22, 2621440
    v_lshlrev_b32 v1, 4, v3
    s_cmp_ge_u32 s20, 8
    s_cbranch_scc1 L_k2_helper
    s_lshl_b32 s14, s32, 3
    s_add_u32 s14, s14, s20
    s_lshl_b32 s15, s21, 6
    s_add_u32 s15, s15, s14
    s_mul_i32 s23, s15, 1280
    s_mul_i32 s16, s20, 2560
    s_add_u32 s17, s22, s16
    s_mov_b32 s28, -1
    s_mov_b32 s29, 0
    v_and_b32 v2, 31, v3
    v_lshlrev_b32 v116, 3, v2
    v_mov_b32 v20, 0
    v_mov_b32 v21, 0
    v_mov_b32 v22, 0
    v_mov_b32 v23, 0
    s_waitcnt lgkmcnt(0)
    s_mov_b32 s8, s4
    s_and_b32 s9, s5, 0xffff
    s_mov_b32 s10, 11993088
    s_mov_b32 s11, 0x00020000
    s_mov_b32 m0, s16
    s_nop 0
    buffer_load_dwordx4 v1, s[8:11], s17 offen lds
    buffer_load_dwordx4 v1, s[8:11], s17 offen offset:1024 lds
    s_mov_b64 exec, s[28:29]
    buffer_load_dwordx4 v1, s[8:11], s17 offen offset:2048 lds
    buffer_load_dwordx2 v[20:21], v116, s[8:11], s23 offen offset:1024
    s_mov_b64 exec, -1
    buffer_load_dwordx4 v[10:13], v1, s[8:11], s23 offen
    s_mul_i32 s24, s14, 40960
    s_add_u32 s24, s24, 7864320
    s_lshr_b32 s15, s21, 3
    s_mul_i32 s15, s15, 5120
    s_add_u32 s24, s24, s15
    s_bfe_u32 s15, s21, 0x20001
    s_lshl_b32 s15, s15, 10
    s_and_b32 s16, s21, 1
    s_lshl_b32 s16, s16, 9
    s_add_u32 s15, s15, s16
    s_add_u32 s25, s24, s15
    s_and_b32 s15, s21, 3
    s_lshl_b32 s15, s15, 8
    s_bfe_u32 s16, s21, 0x10002
    s_lshl_b32 s16, s16, 3
    s_add_u32 s15, s15, s16
    s_add_u32 s24, s24, s15
    s_add_u32 s24, s24, 4096
    s_mov_b32 s26, 0x000fffff
    s_mov_b32 s27, 0x000fffff
    v_mov_b32 v4, v1
    v_add_u32 v5, 1024, v116
    v_lshrrev_b32 v117, 5, v3
    v_mul_u32_u24 v117, 320, v117
    v_lshl_add_u32 v117, v2, 4, v117
    v_add_u32 v6, 1280, v117
    v_mov_b32 v7, 143360
    v_mov_b32 v17, 1
    v_and_b32 v117, 27, v2
    v_cmp_eq_u32 vcc, 24, v117
    v_mov_b32 v118, 0x3f803f80
    s_nop 1
    v_cndmask_b32 v117, 0, v118, vcc
    v_mov_b32 v100, v117
    v_mov_b32 v101, v117
    v_mov_b32 v102, v117
    v_mov_b32 v103, v117
    v_mov_b32 v104, v117
    v_mov_b32 v105, v117
    v_mov_b32 v106, v117
    v_mov_b32 v107, v117
    v_mov_b32 v108, v117
    v_mov_b32 v109, v117
    v_mov_b32 v110, v117
    v_mov_b32 v111, v117
    v_mov_b32 v112, v117
    v_mov_b32 v113, v117
    v_mov_b32 v114, v117
    v_mov_b32 v115, v117
    v_mov_b32 v64, 0
    v_mov_b32 v65, 0
    v_mov_b32 v66, 0
    v_mov_b32 v67, 0
    v_mov_b32 v68, 0
    v_mov_b32 v69, 0
    v_mov_b32 v70, 0
    v_mov_b32 v71, 0
    v_mov_b32 v72, 0
    v_mov_b32 v73, 0
    v_mov_b32 v74, 0
    v_mov_b32 v75, 0
    v_mov_b32 v76, 0
    v_mov_b32 v77, 0
    v_mov_b32 v78, 0
    v_mov_b32 v79, 0
    v_cmp_le_u32 vcc, 32, v3
    v_mov_b32 v118, 0x3f80
    s_nop 1
    v_cndmask_b32 v24, 0, v118, vcc
    v_mov_b32 v25, 0
    v_mov_b32 v26, 0
    v_mov_b32 v27, 0
    v_cndmask_b32 v28, 0, v118, vcc
    v_mov_b32 v29, 0
    v_mov_b32 v30, 0
    v_mov_b32 v31, 0
    s_waitcnt vmcnt(0)
    s_barrier
    ds_read_b128 v[88:91], v4 offset:0
    ds_read_b128 v[92:95], v4 offset:2560
    s_mov_b64 exec, s[28:29]
    ds_read_b64 v[24:25], v5 offset:0
    ds_read_b64 v[28:29], v5 offset:2560
    s_mov_b64 exec, s[26:27]
    ds_read_b128 v[100:103], v6 offset:0
    ds_read_b128 v[104:107], v6 offset:640
    ds_read_b128 v[108:111], v6 offset:2560
    s_mov_b64 exec, -1
    s_waitcnt lgkmcnt(3)
    v_mfma_f32_32x32x16_bf16 v[32:47], v[88:91], v[10:13], 0
    s_nop 11
    v_mfma_f32_32x32x8bf16_1k v[32:47], v[24:25], v[20:21], v[32:47]
    s_nop 15
    s_nop 3
    v_max3_f32 v116, v32, v33, v34
    v_max3_f32 v116, v116, v35, v36
    v_max3_f32 v116, v116, v37, v38
    v_max3_f32 v116, v116, v39, v40
    v_max3_f32 v116, v116, v41, v42
    v_max3_f32 v116, v116, v43, v44
    v_max3_f32 v116, v116, v45, v46
    v_max_f32 v116, v116, v47
    v_mov_b32 v117, v116
    s_nop 1
    v_permlane32_swap_b32 v116, v117
    s_nop 1
    v_max_f32 v116, v116, v117
    v_sub_f32 v116, 0, v116
    v_cvt_pk_bf16_f32 v116, v116, 0
    v_cmp_le_u32 vcc, 32, v3
    s_nop 1
    v_cndmask_b32 v20, v20, v116, vcc
    ds_read_b128 v[88:91], v4 offset:5120
    s_mov_b64 exec, s[28:29]
    ds_read_b64 v[24:25], v5 offset:5120
    s_mov_b64 exec, -1
    v_lshlrev_b32 v116, 16, v116
    v_add_f32 v32, v32, v116
    v_add_f32 v33, v33, v116
    v_add_f32 v34, v34, v116
    v_add_f32 v35, v35, v116
    v_add_f32 v36, v36, v116
    v_add_f32 v37, v37, v116
    v_add_f32 v38, v38, v116
    v_add_f32 v39, v39, v116
    v_add_f32 v40, v40, v116
    v_add_f32 v41, v41, v116
    v_add_f32 v42, v42, v116
    v_add_f32 v43, v43, v116
    v_add_f32 v44, v44, v116
    v_add_f32 v45, v45, v116
    v_add_f32 v46, v46, v116
    v_add_f32 v47, v47, v116
    s_waitcnt lgkmcnt(2)
    v_exp_f32 v32, v32
    s_setprio 1
    v_exp_f32 v33, v33
    v_exp_f32 v34, v34
    v_exp_f32 v35, v35
    v_exp_f32 v36, v36
    v_exp_f32 v37, v37
    v_mfma_f32_32x32x16_bf16 v[48:63], v[92:95], v[10:13], 0
    v_exp_f32 v38, v38
    v_exp_f32 v39, v39
    v_cvt_pk_bf16_f32 v80, v32, v33
    v_cvt_pk_bf16_f32 v81, v34, v35
    v_cvt_pk_bf16_f32 v82, v36, v37
    v_cvt_pk_bf16_f32 v83, v38, v39
    v_mfma_f32_32x32x8bf16_1k v[48:63], v[28:29], v[20:21], v[48:63]
    v_exp_f32 v40, v40
    v_exp_f32 v41, v41
    v_exp_f32 v42, v42
    v_exp_f32 v43, v43
    v_mfma_f32_32x32x16_bf16 v[64:79], v[100:103], v[80:83], v[64:79]
    v_exp_f32 v44, v44
    v_exp_f32 v45, v45
    v_exp_f32 v46, v46
    v_exp_f32 v47, v47
    v_cvt_pk_bf16_f32 v84, v40, v41
    v_cvt_pk_bf16_f32 v85, v42, v43
    v_cvt_pk_bf16_f32 v86, v44, v45
    v_cvt_pk_bf16_f32 v87, v46, v47
    s_setprio 0
    s_waitcnt lgkmcnt(0)
    ds_read_b128 v[92:95], v4 offset:7680
    s_mov_b64 exec, s[28:29]
    ds_read_b64 v[28:29], v5 offset:7680
    s_mov_b64 exec, s[26:27]
    ds_read_b128 v[100:103], v6 offset:5120
    ds_read_b128 v[112:115], v6 offset:3200
    s_mov_b64 exec, -1
    v_exp_f32 v48, v48
    s_setprio 1
    v_exp_f32 v49, v49
    v_mfma_f32_32x32x16_bf16 v[64:79], v[104:107], v[84:87], v[64:79]
    v_exp_f32 v50, v50
    v_exp_f32 v51, v51
    v_exp_f32 v52, v52
    v_exp_f32 v53, v53
    v_mfma_f32_32x32x16_bf16 v[32:47], v[88:91], v[10:13], 0
    v_exp_f32 v54, v54
    v_exp_f32 v55, v55
    v_cvt_pk_bf16_f32 v80, v48, v49
    v_cvt_pk_bf16_f32 v81, v50, v51
    v_cvt_pk_bf16_f32 v82, v52, v53
    v_cvt_pk_bf16_f32 v83, v54, v55
    v_mfma_f32_32x32x8bf16_1k v[32:47], v[24:25], v[20:21], v[32:47]
    v_exp_f32 v56, v56
    v_exp_f32 v57, v57
    v_exp_f32 v58, v58
    v_exp_f32 v59, v59
    v_mfma_f32_32x32x16_bf16 v[64:79], v[108:111], v[80:83], v[64:79]
    v_exp_f32 v60, v60
    v_exp_f32 v61, v61
    v_exp_f32 v62, v62
    v_exp_f32 v63, v63
    v_cvt_pk_bf16_f32 v84, v56, v57
    v_cvt_pk_bf16_f32 v85, v58, v59
    v_cvt_pk_bf16_f32 v86, v60, v61
    v_cvt_pk_bf16_f32 v87, v62, v63
    s_setprio 0
    s_waitcnt lgkmcnt(0)
    ds_read_b128 v[88:91], v4 offset:10240
    s_mov_b64 exec, s[28:29]
    ds_read_b64 v[24:25], v5 offset:10240
    s_mov_b64 exec, s[26:27]
    ds_read_b128 v[108:111], v6 offset:7680
    ds_read_b128 v[104:107], v6 offset:5760
    s_mov_b64 exec, -1
    v_exp_f32 v32, v32
    s_setprio 1
    v_exp_f32 v33, v33
    v_mfma_f32_32x32x16_bf16 v[64:79], v[112:115], v[84:87], v[64:79]
    v_exp_f32 v34, v34
    v_exp_f32 v35, v35
    v_exp_f32 v36, v36
    v_exp_f32 v37, v37
    v_mfma_f32_32x32x16_bf16 v[48:63], v[92:95], v[10:13], 0
    v_exp_f32 v38, v38
    v_exp_f32 v39, v39
    v_cvt_pk_bf16_f32 v80, v32, v33
    v_cvt_pk_bf16_f32 v81, v34, v35
    v_cvt_pk_bf16_f32 v82, v36, v37
    v_cvt_pk_bf16_f32 v83, v38, v39
    v_mfma_f32_32x32x8bf16_1k v[48:63], v[28:29], v[20:21], v[48:63]
    v_exp_f32 v40, v40
    v_exp_f32 v41, v41
    v_exp_f32 v42, v42
    v_exp_f32 v43, v43
    v_mfma_f32_32x32x16_bf16 v[64:79], v[100:103], v[80:83], v[64:79]
    v_exp_f32 v44, v44
    v_exp_f32 v45, v45
    v_exp_f32 v46, v46
    v_exp_f32 v47, v47
    v_cvt_pk_bf16_f32 v84, v40, v41
    v_cvt_pk_bf16_f32 v85, v42, v43
    v_cvt_pk_bf16_f32 v86, v44, v45
    v_cvt_pk_bf16_f32 v87, v46, v47
    s_setprio 0
    s_waitcnt lgkmcnt(0)
    ds_read_b128 v[92:95], v4 offset:12800
    s_mov_b64 exec, s[28:29]
    ds_read_b64 v[28:29], v5 offset:12800
    s_mov_b64 exec, s[26:27]
    ds_read_b128 v[100:103], v6 offset:10240
    ds_read_b128 v[112:115], v6 offset:8320
    s_mov_b64 exec, -1
    v_exp_f32 v48, v48
    s_setprio 1
    v_exp_f32 v49, v49
    v_mfma_f32_32x32x16_bf16 v[64:79], v[104:107], v[84:87], v[64:79]
    v_exp_f32 v50, v50
    v_exp_f32 v51, v51
    v_exp_f32 v52, v52
    v_exp_f32 v53, v53
    v_mfma_f32_32x32x16_bf16 v[32:47], v[88:91], v[10:13], 0
    v_exp_f32 v54, v54
    v_exp_f32 v55, v55
    v_cvt_pk_bf16_f32 v80, v48, v49
    v_cvt_pk_bf16_f32 v81, v50, v51
    v_cvt_pk_bf16_f32 v82, v52, v53
    v_cvt_pk_bf16_f32 v83, v54, v55
    v_mfma_f32_32x32x8bf16_1k v[32:47], v[24:25], v[20:21], v[32:47]
    v_exp_f32 v56, v56
    v_exp_f32 v57, v57
    v_exp_f32 v58, v58
    v_exp_f32 v59, v59
    v_mfma_f32_32x32x16_bf16 v[64:79], v[108:111], v[80:83], v[64:79]
    v_exp_f32 v60, v60
    v_exp_f32 v61, v61
    v_exp_f32 v62, v62
    v_exp_f32 v63, v63
    v_cvt_pk_bf16_f32 v84, v56, v57
    v_cvt_pk_bf16_f32 v85, v58, v59
    v_cvt_pk_bf16_f32 v86, v60, v61
    v_cvt_pk_bf16_f32 v87, v62, v63
    s_setprio 0
    s_waitcnt lgkmcnt(0)
    ds_read_b128 v[88:91], v4 offset:15360
    s_mov_b64 exec, s[28:29]
    ds_read_b64 v[24:25], v5 offset:15360
    s_mov_b64 exec, s[26:27]
    ds_read_b128 v[108:111], v6 offset:12800
    ds_read_b128 v[104:107], v6 offset:10880
    s_mov_b64 exec, -1
    v_exp_f32 v32, v32
    s_setprio 1
    v_exp_f32 v33, v33
    v_mfma_f32_32x32x16_bf16 v[64:79], v[112:115], v[84:87], v[64:79]
    v_exp_f32 v34, v34
    v_exp_f32 v35, v35
    v_exp_f32 v36, v36
    v_exp_f32 v37, v37
    v_mfma_f32_32x32x16_bf16 v[48:63], v[92:95], v[10:13], 0
    v_exp_f32 v38, v38
    v_exp_f32 v39, v39
    v_cvt_pk_bf16_f32 v80, v32, v33
    v_cvt_pk_bf16_f32 v81, v34, v35
    v_cvt_pk_bf16_f32 v82, v36, v37
    v_cvt_pk_bf16_f32 v83, v38, v39
    v_mfma_f32_32x32x8bf16_1k v[48:63], v[28:29], v[20:21], v[48:63]
    v_exp_f32 v40, v40
    v_exp_f32 v41, v41
    v_exp_f32 v42, v42
    v_exp_f32 v43, v43
    v_mfma_f32_32x32x16_bf16 v[64:79], v[100:103], v[80:83], v[64:79]
    v_exp_f32 v44, v44
    v_exp_f32 v45, v45
    v_exp_f32 v46, v46
    v_exp_f32 v47, v47
    v_cvt_pk_bf16_f32 v84, v40, v41
    v_cvt_pk_bf16_f32 v85, v42, v43
    v_cvt_pk_bf16_f32 v86, v44, v45
    v_cvt_pk_bf16_f32 v87, v46, v47
    s_setprio 0
    s_waitcnt lgkmcnt(0)
    ds_read_b128 v[92:95], v4 offset:17920
    s_mov_b64 exec, s[28:29]
    ds_read_b64 v[28:29], v5 offset:17920
    s_mov_b64 exec, s[26:27]
    ds_read_b128 v[100:103], v6 offset:15360
    ds_read_b128 v[112:115], v6 offset:13440
    s_mov_b64 exec, -1
    ds_read_b32 v16, v7
    v_exp_f32 v48, v48
    s_setprio 1
    v_exp_f32 v49, v49
    v_mfma_f32_32x32x16_bf16 v[64:79], v[104:107], v[84:87], v[64:79]
    v_exp_f32 v50, v50
    v_exp_f32 v51, v51
    v_exp_f32 v52, v52
    v_exp_f32 v53, v53
    v_mfma_f32_32x32x16_bf16 v[32:47], v[88:91], v[10:13], 0
    v_exp_f32 v54, v54
    v_exp_f32 v55, v55
    v_cvt_pk_bf16_f32 v80, v48, v49
    v_cvt_pk_bf16_f32 v81, v50, v51
    v_cvt_pk_bf16_f32 v82, v52, v53
    v_cvt_pk_bf16_f32 v83, v54, v55
    v_mfma_f32_32x32x8bf16_1k v[32:47], v[24:25], v[20:21], v[32:47]
    v_exp_f32 v56, v56
    v_exp_f32 v57, v57
    v_exp_f32 v58, v58
    v_exp_f32 v59, v59
    v_mfma_f32_32x32x16_bf16 v[64:79], v[108:111], v[80:83], v[64:79]
    v_exp_f32 v60, v60
    v_exp_f32 v61, v61
    v_exp_f32 v62, v62
    v_exp_f32 v63, v63
    v_cvt_pk_bf16_f32 v84, v56, v57
    v_cvt_pk_bf16_f32 v85, v58, v59
    v_cvt_pk_bf16_f32 v86, v60, v61
    v_cvt_pk_bf16_f32 v87, v62, v63
    s_waitcnt lgkmcnt(0)
    v_readfirstlane_b32 s30, v16
    s_setprio 0
    s_nop 0
    s_cmp_ge_u32 s30, 1
    s_cbranch_scc1 L_land_1_skip
    s_mov_b32 s31, 1048576
L_land_1_loop:
    ds_read_b32 v16, v7
    s_waitcnt lgkmcnt(0)
    v_readfirstlane_b32 s30, v16
    s_sub_u32 s31, s31, 1
    s_cbranch_scc1 L_land_1_done
    s_cmp_ge_u32 s30, 1
    s_cbranch_scc1 L_land_1_done
    s_sleep 1
    s_branch L_land_1_loop
L_land_1_done:
L_land_1_skip:
    ds_read_b128 v[88:91], v4 offset:20480
    s_mov_b64 exec, s[28:29]
    ds_read_b64 v[24:25], v5 offset:20480
    s_mov_b64 exec, s[26:27]
    ds_read_b128 v[108:111], v6 offset:17920
    ds_read_b128 v[104:107], v6 offset:16000
    s_mov_b64 exec, -1
    v_exp_f32 v32, v32
    s_setprio 1
    v_exp_f32 v33, v33
    v_mfma_f32_32x32x16_bf16 v[64:79], v[112:115], v[84:87], v[64:79]
    v_exp_f32 v34, v34
    v_exp_f32 v35, v35
    v_exp_f32 v36, v36
    v_exp_f32 v37, v37
    v_mfma_f32_32x32x16_bf16 v[48:63], v[92:95], v[10:13], 0
    v_exp_f32 v38, v38
    v_exp_f32 v39, v39
    v_cvt_pk_bf16_f32 v80, v32, v33
    v_cvt_pk_bf16_f32 v81, v34, v35
    v_cvt_pk_bf16_f32 v82, v36, v37
    v_cvt_pk_bf16_f32 v83, v38, v39
    v_mfma_f32_32x32x8bf16_1k v[48:63], v[28:29], v[20:21], v[48:63]
    v_exp_f32 v40, v40
    v_exp_f32 v41, v41
    v_exp_f32 v42, v42
    v_exp_f32 v43, v43
    v_mfma_f32_32x32x16_bf16 v[64:79], v[100:103], v[80:83], v[64:79]
    v_exp_f32 v44, v44
    v_exp_f32 v45, v45
    v_exp_f32 v46, v46
    v_exp_f32 v47, v47
    v_cvt_pk_bf16_f32 v84, v40, v41
    v_cvt_pk_bf16_f32 v85, v42, v43
    v_cvt_pk_bf16_f32 v86, v44, v45
    v_cvt_pk_bf16_f32 v87, v46, v47
    s_setprio 0
    s_waitcnt lgkmcnt(0)
    ds_read_b128 v[92:95], v4 offset:23040
    s_mov_b64 exec, s[28:29]
    ds_read_b64 v[28:29], v5 offset:23040
    s_mov_b64 exec, s[26:27]
    ds_read_b128 v[100:103], v6 offset:20480
    ds_read_b128 v[112:115], v6 offset:18560
    s_mov_b64 exec, -1
    v_exp_f32 v48, v48
    s_setprio 1
    v_exp_f32 v49, v49
    v_mfma_f32_32x32x16_bf16 v[64:79], v[104:107], v[84:87], v[64:79]
    v_exp_f32 v50, v50
    v_exp_f32 v51, v51
    v_exp_f32 v52, v52
    v_exp_f32 v53, v53
    v_mfma_f32_32x32x16_bf16 v[32:47], v[88:91], v[10:13], 0
    v_exp_f32 v54, v54
    v_exp_f32 v55, v55
    v_cvt_pk_bf16_f32 v80, v48, v49
    v_cvt_pk_bf16_f32 v81, v50, v51
    v_cvt_pk_bf16_f32 v82, v52, v53
    v_cvt_pk_bf16_f32 v83, v54, v55
    v_mfma_f32_32x32x8bf16_1k v[32:47], v[24:25], v[20:21], v[32:47]
    v_exp_f32 v56, v56
    v_exp_f32 v57, v57
    v_exp_f32 v58, v58
    v_exp_f32 v59, v59
    v_mfma_f32_32x32x16_bf16 v[64:79], v[108:111], v[80:83], v[64:79]
    v_exp_f32 v60, v60
    v_exp_f32 v61, v61
    v_exp_f32 v62, v62
    v_exp_f32 v63, v63
    v_cvt_pk_bf16_f32 v84, v56, v57
    v_cvt_pk_bf16_f32 v85, v58, v59
    v_cvt_pk_bf16_f32 v86, v60, v61
    v_cvt_pk_bf16_f32 v87, v62, v63
    s_setprio 0
    s_waitcnt lgkmcnt(0)
    s_mov_b64 exec, 1
    ds_add_u32 v7, v17 offset:64
    s_mov_b64 exec, -1
    ds_read_b128 v[88:91], v4 offset:25600
    s_mov_b64 exec, s[28:29]
    ds_read_b64 v[24:25], v5 offset:25600
    s_mov_b64 exec, s[26:27]
    ds_read_b128 v[108:111], v6 offset:23040
    ds_read_b128 v[104:107], v6 offset:21120
    s_mov_b64 exec, -1
    v_exp_f32 v32, v32
    s_setprio 1
    v_exp_f32 v33, v33
    v_mfma_f32_32x32x16_bf16 v[64:79], v[112:115], v[84:87], v[64:79]
    v_exp_f32 v34, v34
    v_exp_f32 v35, v35
    v_exp_f32 v36, v36
    v_exp_f32 v37, v37
    v_mfma_f32_32x32x16_bf16 v[48:63], v[92:95], v[10:13], 0
    v_exp_f32 v38, v38
    v_exp_f32 v39, v39
    v_cvt_pk_bf16_f32 v80, v32, v33
    v_cvt_pk_bf16_f32 v81, v34, v35
    v_cvt_pk_bf16_f32 v82, v36, v37
    v_cvt_pk_bf16_f32 v83, v38, v39
    v_mfma_f32_32x32x8bf16_1k v[48:63], v[28:29], v[20:21], v[48:63]
    v_exp_f32 v40, v40
    v_exp_f32 v41, v41
    v_exp_f32 v42, v42
    v_exp_f32 v43, v43
    v_mfma_f32_32x32x16_bf16 v[64:79], v[100:103], v[80:83], v[64:79]
    v_exp_f32 v44, v44
    v_exp_f32 v45, v45
    v_exp_f32 v46, v46
    v_exp_f32 v47, v47
    v_cvt_pk_bf16_f32 v84, v40, v41
    v_cvt_pk_bf16_f32 v85, v42, v43
    v_cvt_pk_bf16_f32 v86, v44, v45
    v_cvt_pk_bf16_f32 v87, v46, v47
    s_setprio 0
    s_waitcnt lgkmcnt(0)
    ds_read_b128 v[92:95], v4 offset:28160
    s_mov_b64 exec, s[28:29]
    ds_read_b64 v[28:29], v5 offset:28160
    s_mov_b64 exec, s[26:27]
    ds_read_b128 v[100:103], v6 offset:25600
    ds_read_b128 v[112:115], v6 offset:23680
    s_mov_b64 exec, -1
    v_exp_f32 v48, v48
    s_setprio 1
    v_exp_f32 v49, v49
    v_mfma_f32_32x32x16_bf16 v[64:79], v[104:107], v[84:87], v[64:79]
    v_exp_f32 v50, v50
    v_exp_f32 v51, v51
    v_exp_f32 v52, v52
    v_exp_f32 v53, v53
    v_mfma_f32_32x32x16_bf16 v[32:47], v[88:91], v[10:13], 0
    v_exp_f32 v54, v54
    v_exp_f32 v55, v55
    v_cvt_pk_bf16_f32 v80, v48, v49
    v_cvt_pk_bf16_f32 v81, v50, v51
    v_cvt_pk_bf16_f32 v82, v52, v53
    v_cvt_pk_bf16_f32 v83, v54, v55
    v_mfma_f32_32x32x8bf16_1k v[32:47], v[24:25], v[20:21], v[32:47]
    v_exp_f32 v56, v56
    v_exp_f32 v57, v57
    v_exp_f32 v58, v58
    v_exp_f32 v59, v59
    v_mfma_f32_32x32x16_bf16 v[64:79], v[108:111], v[80:83], v[64:79]
    v_exp_f32 v60, v60
    v_exp_f32 v61, v61
    v_exp_f32 v62, v62
    v_exp_f32 v63, v63
    v_cvt_pk_bf16_f32 v84, v56, v57
    v_cvt_pk_bf16_f32 v85, v58, v59
    v_cvt_pk_bf16_f32 v86, v60, v61
    v_cvt_pk_bf16_f32 v87, v62, v63
    s_setprio 0
    s_waitcnt lgkmcnt(0)
    ds_read_b128 v[88:91], v4 offset:30720
    s_mov_b64 exec, s[28:29]
    ds_read_b64 v[24:25], v5 offset:30720
    s_mov_b64 exec, s[26:27]
    ds_read_b128 v[108:111], v6 offset:28160
    ds_read_b128 v[104:107], v6 offset:26240
    s_mov_b64 exec, -1
    v_exp_f32 v32, v32
    s_setprio 1
    v_exp_f32 v33, v33
    v_mfma_f32_32x32x16_bf16 v[64:79], v[112:115], v[84:87], v[64:79]
    v_exp_f32 v34, v34
    v_exp_f32 v35, v35
    v_exp_f32 v36, v36
    v_exp_f32 v37, v37
    v_mfma_f32_32x32x16_bf16 v[48:63], v[92:95], v[10:13], 0
    v_exp_f32 v38, v38
    v_exp_f32 v39, v39
    v_cvt_pk_bf16_f32 v80, v32, v33
    v_cvt_pk_bf16_f32 v81, v34, v35
    v_cvt_pk_bf16_f32 v82, v36, v37
    v_cvt_pk_bf16_f32 v83, v38, v39
    v_mfma_f32_32x32x8bf16_1k v[48:63], v[28:29], v[20:21], v[48:63]
    v_exp_f32 v40, v40
    v_exp_f32 v41, v41
    v_exp_f32 v42, v42
    v_exp_f32 v43, v43
    v_mfma_f32_32x32x16_bf16 v[64:79], v[100:103], v[80:83], v[64:79]
    v_exp_f32 v44, v44
    v_exp_f32 v45, v45
    v_exp_f32 v46, v46
    v_exp_f32 v47, v47
    v_cvt_pk_bf16_f32 v84, v40, v41
    v_cvt_pk_bf16_f32 v85, v42, v43
    v_cvt_pk_bf16_f32 v86, v44, v45
    v_cvt_pk_bf16_f32 v87, v46, v47
    s_setprio 0
    s_waitcnt lgkmcnt(0)
    ds_read_b128 v[92:95], v4 offset:33280
    s_mov_b64 exec, s[28:29]
    ds_read_b64 v[28:29], v5 offset:33280
    s_mov_b64 exec, s[26:27]
    ds_read_b128 v[100:103], v6 offset:30720
    ds_read_b128 v[112:115], v6 offset:28800
    s_mov_b64 exec, -1
    v_exp_f32 v48, v48
    s_setprio 1
    v_exp_f32 v49, v49
    v_mfma_f32_32x32x16_bf16 v[64:79], v[104:107], v[84:87], v[64:79]
    v_exp_f32 v50, v50
    v_exp_f32 v51, v51
    v_exp_f32 v52, v52
    v_exp_f32 v53, v53
    v_mfma_f32_32x32x16_bf16 v[32:47], v[88:91], v[10:13], 0
    v_exp_f32 v54, v54
    v_exp_f32 v55, v55
    v_cvt_pk_bf16_f32 v80, v48, v49
    v_cvt_pk_bf16_f32 v81, v50, v51
    v_cvt_pk_bf16_f32 v82, v52, v53
    v_cvt_pk_bf16_f32 v83, v54, v55
    v_mfma_f32_32x32x8bf16_1k v[32:47], v[24:25], v[20:21], v[32:47]
    v_exp_f32 v56, v56
    v_exp_f32 v57, v57
    v_exp_f32 v58, v58
    v_exp_f32 v59, v59
    v_mfma_f32_32x32x16_bf16 v[64:79], v[108:111], v[80:83], v[64:79]
    v_exp_f32 v60, v60
    v_exp_f32 v61, v61
    v_exp_f32 v62, v62
    v_exp_f32 v63, v63
    v_cvt_pk_bf16_f32 v84, v56, v57
    v_cvt_pk_bf16_f32 v85, v58, v59
    v_cvt_pk_bf16_f32 v86, v60, v61
    v_cvt_pk_bf16_f32 v87, v62, v63
    s_setprio 0
    s_waitcnt lgkmcnt(0)
    ds_read_b128 v[88:91], v4 offset:35840
    s_mov_b64 exec, s[28:29]
    ds_read_b64 v[24:25], v5 offset:35840
    s_mov_b64 exec, s[26:27]
    ds_read_b128 v[108:111], v6 offset:33280
    ds_read_b128 v[104:107], v6 offset:31360
    s_mov_b64 exec, -1
    v_exp_f32 v32, v32
    s_setprio 1
    v_exp_f32 v33, v33
    v_mfma_f32_32x32x16_bf16 v[64:79], v[112:115], v[84:87], v[64:79]
    v_exp_f32 v34, v34
    v_exp_f32 v35, v35
    v_exp_f32 v36, v36
    v_exp_f32 v37, v37
    v_mfma_f32_32x32x16_bf16 v[48:63], v[92:95], v[10:13], 0
    v_exp_f32 v38, v38
    v_exp_f32 v39, v39
    v_cvt_pk_bf16_f32 v80, v32, v33
    v_cvt_pk_bf16_f32 v81, v34, v35
    v_cvt_pk_bf16_f32 v82, v36, v37
    v_cvt_pk_bf16_f32 v83, v38, v39
    v_mfma_f32_32x32x8bf16_1k v[48:63], v[28:29], v[20:21], v[48:63]
    v_exp_f32 v40, v40
    v_exp_f32 v41, v41
    v_exp_f32 v42, v42
    v_exp_f32 v43, v43
    v_mfma_f32_32x32x16_bf16 v[64:79], v[100:103], v[80:83], v[64:79]
    v_exp_f32 v44, v44
    v_exp_f32 v45, v45
    v_exp_f32 v46, v46
    v_exp_f32 v47, v47
    v_cvt_pk_bf16_f32 v84, v40, v41
    v_cvt_pk_bf16_f32 v85, v42, v43
    v_cvt_pk_bf16_f32 v86, v44, v45
    v_cvt_pk_bf16_f32 v87, v46, v47
    s_setprio 0
    s_waitcnt lgkmcnt(0)
    ds_read_b128 v[92:95], v4 offset:38400
    s_mov_b64 exec, s[28:29]
    ds_read_b64 v[28:29], v5 offset:38400
    s_mov_b64 exec, s[26:27]
    ds_read_b128 v[100:103], v6 offset:35840
    ds_read_b128 v[112:115], v6 offset:33920
    s_mov_b64 exec, -1
    ds_read_b32 v16, v7
    v_exp_f32 v48, v48
    s_setprio 1
    v_exp_f32 v49, v49
    v_mfma_f32_32x32x16_bf16 v[64:79], v[104:107], v[84:87], v[64:79]
    v_exp_f32 v50, v50
    v_exp_f32 v51, v51
    v_exp_f32 v52, v52
    v_exp_f32 v53, v53
    v_mfma_f32_32x32x16_bf16 v[32:47], v[88:91], v[10:13], 0
    v_exp_f32 v54, v54
    v_exp_f32 v55, v55
    v_cvt_pk_bf16_f32 v80, v48, v49
    v_cvt_pk_bf16_f32 v81, v50, v51
    v_cvt_pk_bf16_f32 v82, v52, v53
    v_cvt_pk_bf16_f32 v83, v54, v55
    v_mfma_f32_32x32x8bf16_1k v[32:47], v[24:25], v[20:21], v[32:47]
    v_exp_f32 v56, v56
    v_exp_f32 v57, v57
    v_exp_f32 v58, v58
    v_exp_f32 v59, v59
    v_mfma_f32_32x32x16_bf16 v[64:79], v[108:111], v[80:83], v[64:79]
    v_exp_f32 v60, v60
    v_exp_f32 v61, v61
    v_exp_f32 v62, v62
    v_exp_f32 v63, v63
    v_cvt_pk_bf16_f32 v84, v56, v57
    v_cvt_pk_bf16_f32 v85, v58, v59
    v_cvt_pk_bf16_f32 v86, v60, v61
    v_cvt_pk_bf16_f32 v87, v62, v63
    s_waitcnt lgkmcnt(0)
    v_readfirstlane_b32 s30, v16
    s_setprio 0
    s_nop 0
    s_cmp_ge_u32 s30, 2
    s_cbranch_scc1 L_land_2_skip
    s_mov_b32 s31, 1048576
L_land_2_loop:
    ds_read_b32 v16, v7
    s_waitcnt lgkmcnt(0)
    v_readfirstlane_b32 s30, v16
    s_sub_u32 s31, s31, 1
    s_cbranch_scc1 L_land_2_done
    s_cmp_ge_u32 s30, 2
    s_cbranch_scc1 L_land_2_done
    s_sleep 1
    s_branch L_land_2_loop
L_land_2_done:
L_land_2_skip:
    ds_read_b128 v[88:91], v4 offset:40960
    s_mov_b64 exec, s[28:29]
    ds_read_b64 v[24:25], v5 offset:40960
    s_mov_b64 exec, s[26:27]
    ds_read_b128 v[108:111], v6 offset:38400
    ds_read_b128 v[104:107], v6 offset:36480
    s_mov_b64 exec, -1
    v_exp_f32 v32, v32
    s_setprio 1
    v_exp_f32 v33, v33
    v_mfma_f32_32x32x16_bf16 v[64:79], v[112:115], v[84:87], v[64:79]
    v_exp_f32 v34, v34
    v_exp_f32 v35, v35
    v_exp_f32 v36, v36
    v_exp_f32 v37, v37
    v_mfma_f32_32x32x16_bf16 v[48:63], v[92:95], v[10:13], 0
    v_exp_f32 v38, v38
    v_exp_f32 v39, v39
    v_cvt_pk_bf16_f32 v80, v32, v33
    v_cvt_pk_bf16_f32 v81, v34, v35
    v_cvt_pk_bf16_f32 v82, v36, v37
    v_cvt_pk_bf16_f32 v83, v38, v39
    v_mfma_f32_32x32x8bf16_1k v[48:63], v[28:29], v[20:21], v[48:63]
    v_exp_f32 v40, v40
    v_exp_f32 v41, v41
    v_exp_f32 v42, v42
    v_exp_f32 v43, v43
    v_mfma_f32_32x32x16_bf16 v[64:79], v[100:103], v[80:83], v[64:79]
    v_exp_f32 v44, v44
    v_exp_f32 v45, v45
    v_exp_f32 v46, v46
    v_exp_f32 v47, v47
    v_cvt_pk_bf16_f32 v84, v40, v41
    v_cvt_pk_bf16_f32 v85, v42, v43
    v_cvt_pk_bf16_f32 v86, v44, v45
    v_cvt_pk_bf16_f32 v87, v46, v47
    s_setprio 0
    s_waitcnt lgkmcnt(0)
    ds_read_b128 v[92:95], v4 offset:43520
    s_mov_b64 exec, s[28:29]
    ds_read_b64 v[28:29], v5 offset:43520
    s_mov_b64 exec, s[26:27]
    ds_read_b128 v[100:103], v6 offset:40960
    ds_read_b128 v[112:115], v6 offset:39040
    s_mov_b64 exec, -1
    v_exp_f32 v48, v48
    s_setprio 1
    v_exp_f32 v49, v49
    v_mfma_f32_32x32x16_bf16 v[64:79], v[104:107], v[84:87], v[64:79]
    v_exp_f32 v50, v50
    v_exp_f32 v51, v51
    v_exp_f32 v52, v52
    v_exp_f32 v53, v53
    v_mfma_f32_32x32x16_bf16 v[32:47], v[88:91], v[10:13], 0
    v_exp_f32 v54, v54
    v_exp_f32 v55, v55
    v_cvt_pk_bf16_f32 v80, v48, v49
    v_cvt_pk_bf16_f32 v81, v50, v51
    v_cvt_pk_bf16_f32 v82, v52, v53
    v_cvt_pk_bf16_f32 v83, v54, v55
    v_mfma_f32_32x32x8bf16_1k v[32:47], v[24:25], v[20:21], v[32:47]
    v_exp_f32 v56, v56
    v_exp_f32 v57, v57
    v_exp_f32 v58, v58
    v_exp_f32 v59, v59
    v_mfma_f32_32x32x16_bf16 v[64:79], v[108:111], v[80:83], v[64:79]
    v_exp_f32 v60, v60
    v_exp_f32 v61, v61
    v_exp_f32 v62, v62
    v_exp_f32 v63, v63
    v_cvt_pk_bf16_f32 v84, v56, v57
    v_cvt_pk_bf16_f32 v85, v58, v59
    v_cvt_pk_bf16_f32 v86, v60, v61
    v_cvt_pk_bf16_f32 v87, v62, v63
    s_setprio 0
    s_waitcnt lgkmcnt(0)
    s_mov_b64 exec, 1
    ds_add_u32 v7, v17 offset:68
    s_mov_b64 exec, -1
    ds_read_b128 v[88:91], v4 offset:46080
    s_mov_b64 exec, s[28:29]
    ds_read_b64 v[24:25], v5 offset:46080
    s_mov_b64 exec, s[26:27]
    ds_read_b128 v[108:111], v6 offset:43520
    ds_read_b128 v[104:107], v6 offset:41600
    s_mov_b64 exec, -1
    v_exp_f32 v32, v32
    s_setprio 1
    v_exp_f32 v33, v33
    v_mfma_f32_32x32x16_bf16 v[64:79], v[112:115], v[84:87], v[64:79]
    v_exp_f32 v34, v34
    v_exp_f32 v35, v35
    v_exp_f32 v36, v36
    v_exp_f32 v37, v37
    v_mfma_f32_32x32x16_bf16 v[48:63], v[92:95], v[10:13], 0
    v_exp_f32 v38, v38
    v_exp_f32 v39, v39
    v_cvt_pk_bf16_f32 v80, v32, v33
    v_cvt_pk_bf16_f32 v81, v34, v35
    v_cvt_pk_bf16_f32 v82, v36, v37
    v_cvt_pk_bf16_f32 v83, v38, v39
    v_mfma_f32_32x32x8bf16_1k v[48:63], v[28:29], v[20:21], v[48:63]
    v_exp_f32 v40, v40
    v_exp_f32 v41, v41
    v_exp_f32 v42, v42
    v_exp_f32 v43, v43
    v_mfma_f32_32x32x16_bf16 v[64:79], v[100:103], v[80:83], v[64:79]
    v_exp_f32 v44, v44
    v_exp_f32 v45, v45
    v_exp_f32 v46, v46
    v_exp_f32 v47, v47
    v_cvt_pk_bf16_f32 v84, v40, v41
    v_cvt_pk_bf16_f32 v85, v42, v43
    v_cvt_pk_bf16_f32 v86, v44, v45
    v_cvt_pk_bf16_f32 v87, v46, v47
    s_setprio 0
    s_waitcnt lgkmcnt(0)
    ds_read_b128 v[92:95], v4 offset:48640
    s_mov_b64 exec, s[28:29]
    ds_read_b64 v[28:29], v5 offset:48640
    s_mov_b64 exec, s[26:27]
    ds_read_b128 v[100:103], v6 offset:46080
    ds_read_b128 v[112:115], v6 offset:44160
    s_mov_b64 exec, -1
    v_exp_f32 v48, v48
    s_setprio 1
    v_exp_f32 v49, v49
    v_mfma_f32_32x32x16_bf16 v[64:79], v[104:107], v[84:87], v[64:79]
    v_exp_f32 v50, v50
    v_exp_f32 v51, v51
    v_exp_f32 v52, v52
    v_exp_f32 v53, v53
    v_mfma_f32_32x32x16_bf16 v[32:47], v[88:91], v[10:13], 0
    v_exp_f32 v54, v54
    v_exp_f32 v55, v55
    v_cvt_pk_bf16_f32 v80, v48, v49
    v_cvt_pk_bf16_f32 v81, v50, v51
    v_cvt_pk_bf16_f32 v82, v52, v53
    v_cvt_pk_bf16_f32 v83, v54, v55
    v_mfma_f32_32x32x8bf16_1k v[32:47], v[24:25], v[20:21], v[32:47]
    v_exp_f32 v56, v56
    v_exp_f32 v57, v57
    v_exp_f32 v58, v58
    v_exp_f32 v59, v59
    v_mfma_f32_32x32x16_bf16 v[64:79], v[108:111], v[80:83], v[64:79]
    v_exp_f32 v60, v60
    v_exp_f32 v61, v61
    v_exp_f32 v62, v62
    v_exp_f32 v63, v63
    v_cvt_pk_bf16_f32 v84, v56, v57
    v_cvt_pk_bf16_f32 v85, v58, v59
    v_cvt_pk_bf16_f32 v86, v60, v61
    v_cvt_pk_bf16_f32 v87, v62, v63
    s_setprio 0
    s_waitcnt lgkmcnt(0)
    ds_read_b128 v[88:91], v4 offset:51200
    s_mov_b64 exec, s[28:29]
    ds_read_b64 v[24:25], v5 offset:51200
    s_mov_b64 exec, s[26:27]
    ds_read_b128 v[108:111], v6 offset:48640
    ds_read_b128 v[104:107], v6 offset:46720
    s_mov_b64 exec, -1
    v_exp_f32 v32, v32
    s_setprio 1
    v_exp_f32 v33, v33
    v_mfma_f32_32x32x16_bf16 v[64:79], v[112:115], v[84:87], v[64:79]
    v_exp_f32 v34, v34
    v_exp_f32 v35, v35
    v_exp_f32 v36, v36
    v_exp_f32 v37, v37
    v_mfma_f32_32x32x16_bf16 v[48:63], v[92:95], v[10:13], 0
    v_exp_f32 v38, v38
    v_exp_f32 v39, v39
    v_cvt_pk_bf16_f32 v80, v32, v33
    v_cvt_pk_bf16_f32 v81, v34, v35
    v_cvt_pk_bf16_f32 v82, v36, v37
    v_cvt_pk_bf16_f32 v83, v38, v39
    v_mfma_f32_32x32x8bf16_1k v[48:63], v[28:29], v[20:21], v[48:63]
    v_exp_f32 v40, v40
    v_exp_f32 v41, v41
    v_exp_f32 v42, v42
    v_exp_f32 v43, v43
    v_mfma_f32_32x32x16_bf16 v[64:79], v[100:103], v[80:83], v[64:79]
    v_exp_f32 v44, v44
    v_exp_f32 v45, v45
    v_exp_f32 v46, v46
    v_exp_f32 v47, v47
    v_cvt_pk_bf16_f32 v84, v40, v41
    v_cvt_pk_bf16_f32 v85, v42, v43
    v_cvt_pk_bf16_f32 v86, v44, v45
    v_cvt_pk_bf16_f32 v87, v46, v47
    s_setprio 0
    s_waitcnt lgkmcnt(0)
    ds_read_b128 v[92:95], v4 offset:53760
    s_mov_b64 exec, s[28:29]
    ds_read_b64 v[28:29], v5 offset:53760
    s_mov_b64 exec, s[26:27]
    ds_read_b128 v[100:103], v6 offset:51200
    ds_read_b128 v[112:115], v6 offset:49280
    s_mov_b64 exec, -1
    v_exp_f32 v48, v48
    s_setprio 1
    v_exp_f32 v49, v49
    v_mfma_f32_32x32x16_bf16 v[64:79], v[104:107], v[84:87], v[64:79]
    v_exp_f32 v50, v50
    v_exp_f32 v51, v51
    v_exp_f32 v52, v52
    v_exp_f32 v53, v53
    v_mfma_f32_32x32x16_bf16 v[32:47], v[88:91], v[10:13], 0
    v_exp_f32 v54, v54
    v_exp_f32 v55, v55
    v_cvt_pk_bf16_f32 v80, v48, v49
    v_cvt_pk_bf16_f32 v81, v50, v51
    v_cvt_pk_bf16_f32 v82, v52, v53
    v_cvt_pk_bf16_f32 v83, v54, v55
    v_mfma_f32_32x32x8bf16_1k v[32:47], v[24:25], v[20:21], v[32:47]
    v_exp_f32 v56, v56
    v_exp_f32 v57, v57
    v_exp_f32 v58, v58
    v_exp_f32 v59, v59
    v_mfma_f32_32x32x16_bf16 v[64:79], v[108:111], v[80:83], v[64:79]
    v_exp_f32 v60, v60
    v_exp_f32 v61, v61
    v_exp_f32 v62, v62
    v_exp_f32 v63, v63
    v_cvt_pk_bf16_f32 v84, v56, v57
    v_cvt_pk_bf16_f32 v85, v58, v59
    v_cvt_pk_bf16_f32 v86, v60, v61
    v_cvt_pk_bf16_f32 v87, v62, v63
    s_setprio 0
    s_waitcnt lgkmcnt(0)
    ds_read_b128 v[88:91], v4 offset:56320
    s_mov_b64 exec, s[28:29]
    ds_read_b64 v[24:25], v5 offset:56320
    s_mov_b64 exec, s[26:27]
    ds_read_b128 v[108:111], v6 offset:53760
    ds_read_b128 v[104:107], v6 offset:51840
    s_mov_b64 exec, -1
    v_exp_f32 v32, v32
    s_setprio 1
    v_exp_f32 v33, v33
    v_mfma_f32_32x32x16_bf16 v[64:79], v[112:115], v[84:87], v[64:79]
    v_exp_f32 v34, v34
    v_exp_f32 v35, v35
    v_exp_f32 v36, v36
    v_exp_f32 v37, v37
    v_mfma_f32_32x32x16_bf16 v[48:63], v[92:95], v[10:13], 0
    v_exp_f32 v38, v38
    v_exp_f32 v39, v39
    v_cvt_pk_bf16_f32 v80, v32, v33
    v_cvt_pk_bf16_f32 v81, v34, v35
    v_cvt_pk_bf16_f32 v82, v36, v37
    v_cvt_pk_bf16_f32 v83, v38, v39
    v_mfma_f32_32x32x8bf16_1k v[48:63], v[28:29], v[20:21], v[48:63]
    v_exp_f32 v40, v40
    v_exp_f32 v41, v41
    v_exp_f32 v42, v42
    v_exp_f32 v43, v43
    v_mfma_f32_32x32x16_bf16 v[64:79], v[100:103], v[80:83], v[64:79]
    v_exp_f32 v44, v44
    v_exp_f32 v45, v45
    v_exp_f32 v46, v46
    v_exp_f32 v47, v47
    v_cvt_pk_bf16_f32 v84, v40, v41
    v_cvt_pk_bf16_f32 v85, v42, v43
    v_cvt_pk_bf16_f32 v86, v44, v45
    v_cvt_pk_bf16_f32 v87, v46, v47
    s_setprio 0
    s_waitcnt lgkmcnt(0)
    ds_read_b128 v[92:95], v4 offset:58880
    s_mov_b64 exec, s[28:29]
    ds_read_b64 v[28:29], v5 offset:58880
    s_mov_b64 exec, s[26:27]
    ds_read_b128 v[100:103], v6 offset:56320
    ds_read_b128 v[112:115], v6 offset:54400
    s_mov_b64 exec, -1
    ds_read_b32 v16, v7
    v_exp_f32 v48, v48
    s_setprio 1
    v_exp_f32 v49, v49
    v_mfma_f32_32x32x16_bf16 v[64:79], v[104:107], v[84:87], v[64:79]
    v_exp_f32 v50, v50
    v_exp_f32 v51, v51
    v_exp_f32 v52, v52
    v_exp_f32 v53, v53
    v_mfma_f32_32x32x16_bf16 v[32:47], v[88:91], v[10:13], 0
    v_exp_f32 v54, v54
    v_exp_f32 v55, v55
    v_cvt_pk_bf16_f32 v80, v48, v49
    v_cvt_pk_bf16_f32 v81, v50, v51
    v_cvt_pk_bf16_f32 v82, v52, v53
    v_cvt_pk_bf16_f32 v83, v54, v55
    v_mfma_f32_32x32x8bf16_1k v[32:47], v[24:25], v[20:21], v[32:47]
    v_exp_f32 v56, v56
    v_exp_f32 v57, v57
    v_exp_f32 v58, v58
    v_exp_f32 v59, v59
    v_mfma_f32_32x32x16_bf16 v[64:79], v[108:111], v[80:83], v[64:79]
    v_exp_f32 v60, v60
    v_exp_f32 v61, v61
    v_exp_f32 v62, v62
    v_exp_f32 v63, v63
    v_cvt_pk_bf16_f32 v84, v56, v57
    v_cvt_pk_bf16_f32 v85, v58, v59
    v_cvt_pk_bf16_f32 v86, v60, v61
    v_cvt_pk_bf16_f32 v87, v62, v63
    s_waitcnt lgkmcnt(0)
    v_readfirstlane_b32 s30, v16
    s_setprio 0
    s_nop 0
    s_cmp_ge_u32 s30, 3
    s_cbranch_scc1 L_land_3_skip
    s_mov_b32 s31, 1048576
L_land_3_loop:
    ds_read_b32 v16, v7
    s_waitcnt lgkmcnt(0)
    v_readfirstlane_b32 s30, v16
    s_sub_u32 s31, s31, 1
    s_cbranch_scc1 L_land_3_done
    s_cmp_ge_u32 s30, 3
    s_cbranch_scc1 L_land_3_done
    s_sleep 1
    s_branch L_land_3_loop
L_land_3_done:
L_land_3_skip:
    ds_read_b128 v[88:91], v4 offset:0
    s_mov_b64 exec, s[28:29]
    ds_read_b64 v[24:25], v5 offset:0
    s_mov_b64 exec, s[26:27]
    ds_read_b128 v[108:111], v6 offset:58880
    ds_read_b128 v[104:107], v6 offset:56960
    s_mov_b64 exec, -1
    v_exp_f32 v32, v32
    s_setprio 1
    v_exp_f32 v33, v33
    v_mfma_f32_32x32x16_bf16 v[64:79], v[112:115], v[84:87], v[64:79]
    v_exp_f32 v34, v34
    v_exp_f32 v35, v35
    v_exp_f32 v36, v36
    v_exp_f32 v37, v37
    v_mfma_f32_32x32x16_bf16 v[48:63], v[92:95], v[10:13], 0
    v_exp_f32 v38, v38
    v_exp_f32 v39, v39
    v_cvt_pk_bf16_f32 v80, v32, v33
    v_cvt_pk_bf16_f32 v81, v34, v35
    v_cvt_pk_bf16_f32 v82, v36, v37
    v_cvt_pk_bf16_f32 v83, v38, v39
    v_mfma_f32_32x32x8bf16_1k v[48:63], v[28:29], v[20:21], v[48:63]
    v_exp_f32 v40, v40
    v_exp_f32 v41, v41
    v_exp_f32 v42, v42
    v_exp_f32 v43, v43
    v_mfma_f32_32x32x16_bf16 v[64:79], v[100:103], v[80:83], v[64:79]
    v_exp_f32 v44, v44
    v_exp_f32 v45, v45
    v_exp_f32 v46, v46
    v_exp_f32 v47, v47
    v_cvt_pk_bf16_f32 v84, v40, v41
    v_cvt_pk_bf16_f32 v85, v42, v43
    v_cvt_pk_bf16_f32 v86, v44, v45
    v_cvt_pk_bf16_f32 v87, v46, v47
    s_setprio 0
    s_waitcnt lgkmcnt(0)
    ds_read_b128 v[92:95], v4 offset:2560
    s_mov_b64 exec, s[28:29]
    ds_read_b64 v[28:29], v5 offset:2560
    s_mov_b64 exec, s[26:27]
    ds_read_b128 v[100:103], v6 offset:0
    ds_read_b128 v[112:115], v6 offset:59520
    s_mov_b64 exec, -1
    v_exp_f32 v48, v48
    s_setprio 1
    v_exp_f32 v49, v49
    v_mfma_f32_32x32x16_bf16 v[64:79], v[104:107], v[84:87], v[64:79]
    v_exp_f32 v50, v50
    v_exp_f32 v51, v51
    v_exp_f32 v52, v52
    v_exp_f32 v53, v53
    v_mfma_f32_32x32x16_bf16 v[32:47], v[88:91], v[10:13], 0
    v_exp_f32 v54, v54
    v_exp_f32 v55, v55
    v_cvt_pk_bf16_f32 v80, v48, v49
    v_cvt_pk_bf16_f32 v81, v50, v51
    v_cvt_pk_bf16_f32 v82, v52, v53
    v_cvt_pk_bf16_f32 v83, v54, v55
    v_mfma_f32_32x32x8bf16_1k v[32:47], v[24:25], v[20:21], v[32:47]
    v_exp_f32 v56, v56
    v_exp_f32 v57, v57
    v_exp_f32 v58, v58
    v_exp_f32 v59, v59
    v_mfma_f32_32x32x16_bf16 v[64:79], v[108:111], v[80:83], v[64:79]
    v_exp_f32 v60, v60
    v_exp_f32 v61, v61
    v_exp_f32 v62, v62
    v_exp_f32 v63, v63
    v_cvt_pk_bf16_f32 v84, v56, v57
    v_cvt_pk_bf16_f32 v85, v58, v59
    v_cvt_pk_bf16_f32 v86, v60, v61
    v_cvt_pk_bf16_f32 v87, v62, v63
    s_setprio 0
    s_waitcnt lgkmcnt(0)
    s_mov_b64 exec, 1
    ds_add_u32 v7, v17 offset:72
    s_mov_b64 exec, -1
    ds_read_b128 v[88:91], v4 offset:5120
    s_mov_b64 exec, s[28:29]
    ds_read_b64 v[24:25], v5 offset:5120
    s_mov_b64 exec, s[26:27]
    ds_read_b128 v[108:111], v6 offset:2560
    ds_read_b128 v[104:107], v6 offset:640
    s_mov_b64 exec, -1
    v_exp_f32 v32, v32
    s_setprio 1
    v_exp_f32 v33, v33
    v_mfma_f32_32x32x16_bf16 v[64:79], v[112:115], v[84:87], v[64:79]
    v_exp_f32 v34, v34
    v_exp_f32 v35, v35
    v_exp_f32 v36, v36
    v_exp_f32 v37, v37
    v_mfma_f32_32x32x16_bf16 v[48:63], v[92:95], v[10:13], 0
    v_exp_f32 v38, v38
    v_exp_f32 v39, v39
    v_cvt_pk_bf16_f32 v80, v32, v33
    v_cvt_pk_bf16_f32 v81, v34, v35
    v_cvt_pk_bf16_f32 v82, v36, v37
    v_cvt_pk_bf16_f32 v83, v38, v39
    v_mfma_f32_32x32x8bf16_1k v[48:63], v[28:29], v[20:21], v[48:63]
    v_exp_f32 v40, v40
    v_exp_f32 v41, v41
    v_exp_f32 v42, v42
    v_exp_f32 v43, v43
    v_mfma_f32_32x32x16_bf16 v[64:79], v[100:103], v[80:83], v[64:79]
    v_exp_f32 v44, v44
    v_exp_f32 v45, v45
    v_exp_f32 v46, v46
    v_exp_f32 v47, v47
    v_cvt_pk_bf16_f32 v84, v40, v41
    v_cvt_pk_bf16_f32 v85, v42, v43
    v_cvt_pk_bf16_f32 v86, v44, v45
    v_cvt_pk_bf16_f32 v87, v46, v47
    s_setprio 0
    s_waitcnt lgkmcnt(0)
    ds_read_b128 v[92:95], v4 offset:7680
    s_mov_b64 exec, s[28:29]
    ds_read_b64 v[28:29], v5 offset:7680
    s_mov_b64 exec, s[26:27]
    ds_read_b128 v[100:103], v6 offset:5120
    ds_read_b128 v[112:115], v6 offset:3200
    s_mov_b64 exec, -1
    v_exp_f32 v48, v48
    s_setprio 1
    v_exp_f32 v49, v49
    v_mfma_f32_32x32x16_bf16 v[64:79], v[104:107], v[84:87], v[64:79]
    v_exp_f32 v50, v50
    v_exp_f32 v51, v51
    v_exp_f32 v52, v52
    v_exp_f32 v53, v53
    v_mfma_f32_32x32x16_bf16 v[32:47], v[88:91], v[10:13], 0
    v_exp_f32 v54, v54
    v_exp_f32 v55, v55
    v_cvt_pk_bf16_f32 v80, v48, v49
    v_cvt_pk_bf16_f32 v81, v50, v51
    v_cvt_pk_bf16_f32 v82, v52, v53
    v_cvt_pk_bf16_f32 v83, v54, v55
    v_mfma_f32_32x32x8bf16_1k v[32:47], v[24:25], v[20:21], v[32:47]
    v_exp_f32 v56, v56
    v_exp_f32 v57, v57
    v_exp_f32 v58, v58
    v_exp_f32 v59, v59
    v_mfma_f32_32x32x16_bf16 v[64:79], v[108:111], v[80:83], v[64:79]
    v_exp_f32 v60, v60
    v_exp_f32 v61, v61
    v_exp_f32 v62, v62
    v_exp_f32 v63, v63
    v_cvt_pk_bf16_f32 v84, v56, v57
    v_cvt_pk_bf16_f32 v85, v58, v59
    v_cvt_pk_bf16_f32 v86, v60, v61
    v_cvt_pk_bf16_f32 v87, v62, v63
    s_setprio 0
    s_waitcnt lgkmcnt(0)
    ds_read_b128 v[88:91], v4 offset:10240
    s_mov_b64 exec, s[28:29]
    ds_read_b64 v[24:25], v5 offset:10240
    s_mov_b64 exec, s[26:27]
    ds_read_b128 v[108:111], v6 offset:7680
    ds_read_b128 v[104:107], v6 offset:5760
    s_mov_b64 exec, -1
    v_exp_f32 v32, v32
    s_setprio 1
    v_exp_f32 v33, v33
    v_mfma_f32_32x32x16_bf16 v[64:79], v[112:115], v[84:87], v[64:79]
    v_exp_f32 v34, v34
    v_exp_f32 v35, v35
    v_exp_f32 v36, v36
    v_exp_f32 v37, v37
    v_mfma_f32_32x32x16_bf16 v[48:63], v[92:95], v[10:13], 0
    v_exp_f32 v38, v38
    v_exp_f32 v39, v39
    v_cvt_pk_bf16_f32 v80, v32, v33
    v_cvt_pk_bf16_f32 v81, v34, v35
    v_cvt_pk_bf16_f32 v82, v36, v37
    v_cvt_pk_bf16_f32 v83, v38, v39
    v_mfma_f32_32x32x8bf16_1k v[48:63], v[28:29], v[20:21], v[48:63]
    v_exp_f32 v40, v40
    v_exp_f32 v41, v41
    v_exp_f32 v42, v42
    v_exp_f32 v43, v43
    v_mfma_f32_32x32x16_bf16 v[64:79], v[100:103], v[80:83], v[64:79]
    v_exp_f32 v44, v44
    v_exp_f32 v45, v45
    v_exp_f32 v46, v46
    v_exp_f32 v47, v47
    v_cvt_pk_bf16_f32 v84, v40, v41
    v_cvt_pk_bf16_f32 v85, v42, v43
    v_cvt_pk_bf16_f32 v86, v44, v45
    v_cvt_pk_bf16_f32 v87, v46, v47
    s_setprio 0
    s_waitcnt lgkmcnt(0)
    ds_read_b128 v[92:95], v4 offset:12800
    s_mov_b64 exec, s[28:29]
    ds_read_b64 v[28:29], v5 offset:12800
    s_mov_b64 exec, s[26:27]
    ds_read_b128 v[100:103], v6 offset:10240
    ds_read_b128 v[112:115], v6 offset:8320
    s_mov_b64 exec, -1
    v_exp_f32 v48, v48
    s_setprio 1
    v_exp_f32 v49, v49
    v_mfma_f32_32x32x16_bf16 v[64:79], v[104:107], v[84:87], v[64:79]
    v_exp_f32 v50, v50
    v_exp_f32 v51, v51
    v_exp_f32 v52, v52
    v_exp_f32 v53, v53
    v_mfma_f32_32x32x16_bf16 v[32:47], v[88:91], v[10:13], 0
    v_exp_f32 v54, v54
    v_exp_f32 v55, v55
    v_cvt_pk_bf16_f32 v80, v48, v49
    v_cvt_pk_bf16_f32 v81, v50, v51
    v_cvt_pk_bf16_f32 v82, v52, v53
    v_cvt_pk_bf16_f32 v83, v54, v55
    v_mfma_f32_32x32x8bf16_1k v[32:47], v[24:25], v[20:21], v[32:47]
    v_exp_f32 v56, v56
    v_exp_f32 v57, v57
    v_exp_f32 v58, v58
    v_exp_f32 v59, v59
    v_mfma_f32_32x32x16_bf16 v[64:79], v[108:111], v[80:83], v[64:79]
    v_exp_f32 v60, v60
    v_exp_f32 v61, v61
    v_exp_f32 v62, v62
    v_exp_f32 v63, v63
    v_cvt_pk_bf16_f32 v84, v56, v57
    v_cvt_pk_bf16_f32 v85, v58, v59
    v_cvt_pk_bf16_f32 v86, v60, v61
    v_cvt_pk_bf16_f32 v87, v62, v63
    s_setprio 0
    s_waitcnt lgkmcnt(0)
    ds_read_b128 v[88:91], v4 offset:15360
    s_mov_b64 exec, s[28:29]
    ds_read_b64 v[24:25], v5 offset:15360
    s_mov_b64 exec, s[26:27]
    ds_read_b128 v[108:111], v6 offset:12800
    ds_read_b128 v[104:107], v6 offset:10880
    s_mov_b64 exec, -1
    v_exp_f32 v32, v32
    s_setprio 1
    v_exp_f32 v33, v33
    v_mfma_f32_32x32x16_bf16 v[64:79], v[112:115], v[84:87], v[64:79]
    v_exp_f32 v34, v34
    v_exp_f32 v35, v35
    v_exp_f32 v36, v36
    v_exp_f32 v37, v37
    v_mfma_f32_32x32x16_bf16 v[48:63], v[92:95], v[10:13], 0
    v_exp_f32 v38, v38
    v_exp_f32 v39, v39
    v_cvt_pk_bf16_f32 v80, v32, v33
    v_cvt_pk_bf16_f32 v81, v34, v35
    v_cvt_pk_bf16_f32 v82, v36, v37
    v_cvt_pk_bf16_f32 v83, v38, v39
    v_mfma_f32_32x32x8bf16_1k v[48:63], v[28:29], v[20:21], v[48:63]
    v_exp_f32 v40, v40
    v_exp_f32 v41, v41
    v_exp_f32 v42, v42
    v_exp_f32 v43, v43
    v_mfma_f32_32x32x16_bf16 v[64:79], v[100:103], v[80:83], v[64:79]
    v_exp_f32 v44, v44
    v_exp_f32 v45, v45
    v_exp_f32 v46, v46
    v_exp_f32 v47, v47
    v_cvt_pk_bf16_f32 v84, v40, v41
    v_cvt_pk_bf16_f32 v85, v42, v43
    v_cvt_pk_bf16_f32 v86, v44, v45
    v_cvt_pk_bf16_f32 v87, v46, v47
    s_setprio 0
    s_waitcnt lgkmcnt(0)
    ds_read_b128 v[92:95], v4 offset:17920
    s_mov_b64 exec, s[28:29]
    ds_read_b64 v[28:29], v5 offset:17920
    s_mov_b64 exec, s[26:27]
    ds_read_b128 v[100:103], v6 offset:15360
    ds_read_b128 v[112:115], v6 offset:13440
    s_mov_b64 exec, -1
    ds_read_b32 v16, v7
    v_exp_f32 v48, v48
    s_setprio 1
    v_exp_f32 v49, v49
    v_mfma_f32_32x32x16_bf16 v[64:79], v[104:107], v[84:87], v[64:79]
    v_exp_f32 v50, v50
    v_exp_f32 v51, v51
    v_exp_f32 v52, v52
    v_exp_f32 v53, v53
    v_mfma_f32_32x32x16_bf16 v[32:47], v[88:91], v[10:13], 0
    v_exp_f32 v54, v54
    v_exp_f32 v55, v55
    v_cvt_pk_bf16_f32 v80, v48, v49
    v_cvt_pk_bf16_f32 v81, v50, v51
    v_cvt_pk_bf16_f32 v82, v52, v53
    v_cvt_pk_bf16_f32 v83, v54, v55
    v_mfma_f32_32x32x8bf16_1k v[32:47], v[24:25], v[20:21], v[32:47]
    v_exp_f32 v56, v56
    v_exp_f32 v57, v57
    v_exp_f32 v58, v58
    v_exp_f32 v59, v59
    v_mfma_f32_32x32x16_bf16 v[64:79], v[108:111], v[80:83], v[64:79]
    v_exp_f32 v60, v60
    v_exp_f32 v61, v61
    v_exp_f32 v62, v62
    v_exp_f32 v63, v63
    v_cvt_pk_bf16_f32 v84, v56, v57
    v_cvt_pk_bf16_f32 v85, v58, v59
    v_cvt_pk_bf16_f32 v86, v60, v61
    v_cvt_pk_bf16_f32 v87, v62, v63
    s_waitcnt lgkmcnt(0)
    v_readfirstlane_b32 s30, v16
    s_setprio 0
    s_nop 0
    s_cmp_ge_u32 s30, 4
    s_cbranch_scc1 L_land_4_skip
    s_mov_b32 s31, 1048576
L_land_4_loop:
    ds_read_b32 v16, v7
    s_waitcnt lgkmcnt(0)
    v_readfirstlane_b32 s30, v16
    s_sub_u32 s31, s31, 1
    s_cbranch_scc1 L_land_4_done
    s_cmp_ge_u32 s30, 4
    s_cbranch_scc1 L_land_4_done
    s_sleep 1
    s_branch L_land_4_loop
L_land_4_done:
L_land_4_skip:
    ds_read_b128 v[88:91], v4 offset:20480
    s_mov_b64 exec, s[28:29]
    ds_read_b64 v[24:25], v5 offset:20480
    s_mov_b64 exec, s[26:27]
    ds_read_b128 v[108:111], v6 offset:17920
    ds_read_b128 v[104:107], v6 offset:16000
    s_mov_b64 exec, -1
    v_exp_f32 v32, v32
    s_setprio 1
    v_exp_f32 v33, v33
    v_mfma_f32_32x32x16_bf16 v[64:79], v[112:115], v[84:87], v[64:79]
    v_exp_f32 v34, v34
    v_exp_f32 v35, v35
    v_exp_f32 v36, v36
    v_exp_f32 v37, v37
    v_mfma_f32_32x32x16_bf16 v[48:63], v[92:95], v[10:13], 0
    v_exp_f32 v38, v38
    v_exp_f32 v39, v39
    v_cvt_pk_bf16_f32 v80, v32, v33
    v_cvt_pk_bf16_f32 v81, v34, v35
    v_cvt_pk_bf16_f32 v82, v36, v37
    v_cvt_pk_bf16_f32 v83, v38, v39
    v_mfma_f32_32x32x8bf16_1k v[48:63], v[28:29], v[20:21], v[48:63]
    v_exp_f32 v40, v40
    v_exp_f32 v41, v41
    v_exp_f32 v42, v42
    v_exp_f32 v43, v43
    v_mfma_f32_32x32x16_bf16 v[64:79], v[100:103], v[80:83], v[64:79]
    v_exp_f32 v44, v44
    v_exp_f32 v45, v45
    v_exp_f32 v46, v46
    v_exp_f32 v47, v47
    v_cvt_pk_bf16_f32 v84, v40, v41
    v_cvt_pk_bf16_f32 v85, v42, v43
    v_cvt_pk_bf16_f32 v86, v44, v45
    v_cvt_pk_bf16_f32 v87, v46, v47
    s_setprio 0
    s_waitcnt lgkmcnt(0)
    ds_read_b128 v[92:95], v4 offset:23040
    s_mov_b64 exec, s[28:29]
    ds_read_b64 v[28:29], v5 offset:23040
    s_mov_b64 exec, s[26:27]
    ds_read_b128 v[100:103], v6 offset:20480
    ds_read_b128 v[112:115], v6 offset:18560
    s_mov_b64 exec, -1
    v_exp_f32 v48, v48
    s_setprio 1
    v_exp_f32 v49, v49
    v_mfma_f32_32x32x16_bf16 v[64:79], v[104:107], v[84:87], v[64:79]
    v_exp_f32 v50, v50
    v_exp_f32 v51, v51
    v_exp_f32 v52, v52
    v_exp_f32 v53, v53
    v_mfma_f32_32x32x16_bf16 v[32:47], v[88:91], v[10:13], 0
    v_exp_f32 v54, v54
    v_exp_f32 v55, v55
    v_cvt_pk_bf16_f32 v80, v48, v49
    v_cvt_pk_bf16_f32 v81, v50, v51
    v_cvt_pk_bf16_f32 v82, v52, v53
    v_cvt_pk_bf16_f32 v83, v54, v55
    v_mfma_f32_32x32x8bf16_1k v[32:47], v[24:25], v[20:21], v[32:47]
    v_exp_f32 v56, v56
    v_exp_f32 v57, v57
    v_exp_f32 v58, v58
    v_exp_f32 v59, v59
    v_mfma_f32_32x32x16_bf16 v[64:79], v[108:111], v[80:83], v[64:79]
    v_exp_f32 v60, v60
    v_exp_f32 v61, v61
    v_exp_f32 v62, v62
    v_exp_f32 v63, v63
    v_cvt_pk_bf16_f32 v84, v56, v57
    v_cvt_pk_bf16_f32 v85, v58, v59
    v_cvt_pk_bf16_f32 v86, v60, v61
    v_cvt_pk_bf16_f32 v87, v62, v63
    s_setprio 0
    s_waitcnt lgkmcnt(0)
    s_mov_b64 exec, 1
    ds_add_u32 v7, v17 offset:76
    s_mov_b64 exec, -1
    ds_read_b128 v[88:91], v4 offset:25600
    s_mov_b64 exec, s[28:29]
    ds_read_b64 v[24:25], v5 offset:25600
    s_mov_b64 exec, s[26:27]
    ds_read_b128 v[108:111], v6 offset:23040
    ds_read_b128 v[104:107], v6 offset:21120
    s_mov_b64 exec, -1
    v_exp_f32 v32, v32
    s_setprio 1
    v_exp_f32 v33, v33
    v_mfma_f32_32x32x16_bf16 v[64:79], v[112:115], v[84:87], v[64:79]
    v_exp_f32 v34, v34
    v_exp_f32 v35, v35
    v_exp_f32 v36, v36
    v_exp_f32 v37, v37
    v_mfma_f32_32x32x16_bf16 v[48:63], v[92:95], v[10:13], 0
    v_exp_f32 v38, v38
    v_exp_f32 v39, v39
    v_cvt_pk_bf16_f32 v80, v32, v33
    v_cvt_pk_bf16_f32 v81, v34, v35
    v_cvt_pk_bf16_f32 v82, v36, v37
    v_cvt_pk_bf16_f32 v83, v38, v39
    v_mfma_f32_32x32x8bf16_1k v[48:63], v[28:29], v[20:21], v[48:63]
    v_exp_f32 v40, v40
    v_exp_f32 v41, v41
    v_exp_f32 v42, v42
    v_exp_f32 v43, v43
    v_mfma_f32_32x32x16_bf16 v[64:79], v[100:103], v[80:83], v[64:79]
    v_exp_f32 v44, v44
    v_exp_f32 v45, v45
    v_exp_f32 v46, v46
    v_exp_f32 v47, v47
    v_cvt_pk_bf16_f32 v84, v40, v41
    v_cvt_pk_bf16_f32 v85, v42, v43
    v_cvt_pk_bf16_f32 v86, v44, v45
    v_cvt_pk_bf16_f32 v87, v46, v47
    s_setprio 0
    s_waitcnt lgkmcnt(0)
    ds_read_b128 v[92:95], v4 offset:28160
    s_mov_b64 exec, s[28:29]
    ds_read_b64 v[28:29], v5 offset:28160
    s_mov_b64 exec, s[26:27]
    ds_read_b128 v[100:103], v6 offset:25600
    ds_read_b128 v[112:115], v6 offset:23680
    s_mov_b64 exec, -1
    v_exp_f32 v48, v48
    s_setprio 1
    v_exp_f32 v49, v49
    v_mfma_f32_32x32x16_bf16 v[64:79], v[104:107], v[84:87], v[64:79]
    v_exp_f32 v50, v50
    v_exp_f32 v51, v51
    v_exp_f32 v52, v52
    v_exp_f32 v53, v53
    v_mfma_f32_32x32x16_bf16 v[32:47], v[88:91], v[10:13], 0
    v_exp_f32 v54, v54
    v_exp_f32 v55, v55
    v_cvt_pk_bf16_f32 v80, v48, v49
    v_cvt_pk_bf16_f32 v81, v50, v51
    v_cvt_pk_bf16_f32 v82, v52, v53
    v_cvt_pk_bf16_f32 v83, v54, v55
    v_mfma_f32_32x32x8bf16_1k v[32:47], v[24:25], v[20:21], v[32:47]
    v_exp_f32 v56, v56
    v_exp_f32 v57, v57
    v_exp_f32 v58, v58
    v_exp_f32 v59, v59
    v_mfma_f32_32x32x16_bf16 v[64:79], v[108:111], v[80:83], v[64:79]
    v_exp_f32 v60, v60
    v_exp_f32 v61, v61
    v_exp_f32 v62, v62
    v_exp_f32 v63, v63
    v_cvt_pk_bf16_f32 v84, v56, v57
    v_cvt_pk_bf16_f32 v85, v58, v59
    v_cvt_pk_bf16_f32 v86, v60, v61
    v_cvt_pk_bf16_f32 v87, v62, v63
    s_setprio 0
    s_waitcnt lgkmcnt(0)
    ds_read_b128 v[88:91], v4 offset:30720
    s_mov_b64 exec, s[28:29]
    ds_read_b64 v[24:25], v5 offset:30720
    s_mov_b64 exec, s[26:27]
    ds_read_b128 v[108:111], v6 offset:28160
    ds_read_b128 v[104:107], v6 offset:26240
    s_mov_b64 exec, -1
    v_exp_f32 v32, v32
    s_setprio 1
    v_exp_f32 v33, v33
    v_mfma_f32_32x32x16_bf16 v[64:79], v[112:115], v[84:87], v[64:79]
    v_exp_f32 v34, v34
    v_exp_f32 v35, v35
    v_exp_f32 v36, v36
    v_exp_f32 v37, v37
    v_mfma_f32_32x32x16_bf16 v[48:63], v[92:95], v[10:13], 0
    v_exp_f32 v38, v38
    v_exp_f32 v39, v39
    v_cvt_pk_bf16_f32 v80, v32, v33
    v_cvt_pk_bf16_f32 v81, v34, v35
    v_cvt_pk_bf16_f32 v82, v36, v37
    v_cvt_pk_bf16_f32 v83, v38, v39
    v_mfma_f32_32x32x8bf16_1k v[48:63], v[28:29], v[20:21], v[48:63]
    v_exp_f32 v40, v40
    v_exp_f32 v41, v41
    v_exp_f32 v42, v42
    v_exp_f32 v43, v43
    v_mfma_f32_32x32x16_bf16 v[64:79], v[100:103], v[80:83], v[64:79]
    v_exp_f32 v44, v44
    v_exp_f32 v45, v45
    v_exp_f32 v46, v46
    v_exp_f32 v47, v47
    v_cvt_pk_bf16_f32 v84, v40, v41
    v_cvt_pk_bf16_f32 v85, v42, v43
    v_cvt_pk_bf16_f32 v86, v44, v45
    v_cvt_pk_bf16_f32 v87, v46, v47
    s_setprio 0
    s_waitcnt lgkmcnt(0)
    ds_read_b128 v[92:95], v4 offset:33280
    s_mov_b64 exec, s[28:29]
    ds_read_b64 v[28:29], v5 offset:33280
    s_mov_b64 exec, s[26:27]
    ds_read_b128 v[100:103], v6 offset:30720
    ds_read_b128 v[112:115], v6 offset:28800
    s_mov_b64 exec, -1
    v_exp_f32 v48, v48
    s_setprio 1
    v_exp_f32 v49, v49
    v_mfma_f32_32x32x16_bf16 v[64:79], v[104:107], v[84:87], v[64:79]
    v_exp_f32 v50, v50
    v_exp_f32 v51, v51
    v_exp_f32 v52, v52
    v_exp_f32 v53, v53
    v_mfma_f32_32x32x16_bf16 v[32:47], v[88:91], v[10:13], 0
    v_exp_f32 v54, v54
    v_exp_f32 v55, v55
    v_cvt_pk_bf16_f32 v80, v48, v49
    v_cvt_pk_bf16_f32 v81, v50, v51
    v_cvt_pk_bf16_f32 v82, v52, v53
    v_cvt_pk_bf16_f32 v83, v54, v55
    v_mfma_f32_32x32x8bf16_1k v[32:47], v[24:25], v[20:21], v[32:47]
    v_exp_f32 v56, v56
    v_exp_f32 v57, v57
    v_exp_f32 v58, v58
    v_exp_f32 v59, v59
    v_mfma_f32_32x32x16_bf16 v[64:79], v[108:111], v[80:83], v[64:79]
    v_exp_f32 v60, v60
    v_exp_f32 v61, v61
    v_exp_f32 v62, v62
    v_exp_f32 v63, v63
    v_cvt_pk_bf16_f32 v84, v56, v57
    v_cvt_pk_bf16_f32 v85, v58, v59
    v_cvt_pk_bf16_f32 v86, v60, v61
    v_cvt_pk_bf16_f32 v87, v62, v63
    s_setprio 0
    s_waitcnt lgkmcnt(0)
    ds_read_b128 v[88:91], v4 offset:35840
    s_mov_b64 exec, s[28:29]
    ds_read_b64 v[24:25], v5 offset:35840
    s_mov_b64 exec, s[26:27]
    ds_read_b128 v[108:111], v6 offset:33280
    ds_read_b128 v[104:107], v6 offset:31360
    s_mov_b64 exec, -1
    v_exp_f32 v32, v32
    s_setprio 1
    v_exp_f32 v33, v33
    v_mfma_f32_32x32x16_bf16 v[64:79], v[112:115], v[84:87], v[64:79]
    v_exp_f32 v34, v34
    v_exp_f32 v35, v35
    v_exp_f32 v36, v36
    v_exp_f32 v37, v37
    v_mfma_f32_32x32x16_bf16 v[48:63], v[92:95], v[10:13], 0
    v_exp_f32 v38, v38
    v_exp_f32 v39, v39
    v_cvt_pk_bf16_f32 v80, v32, v33
    v_cvt_pk_bf16_f32 v81, v34, v35
    v_cvt_pk_bf16_f32 v82, v36, v37
    v_cvt_pk_bf16_f32 v83, v38, v39
    v_mfma_f32_32x32x8bf16_1k v[48:63], v[28:29], v[20:21], v[48:63]
    v_exp_f32 v40, v40
    v_exp_f32 v41, v41
    v_exp_f32 v42, v42
    v_exp_f32 v43, v43
    v_mfma_f32_32x32x16_bf16 v[64:79], v[100:103], v[80:83], v[64:79]
    v_exp_f32 v44, v44
    v_exp_f32 v45, v45
    v_exp_f32 v46, v46
    v_exp_f32 v47, v47
    v_cvt_pk_bf16_f32 v84, v40, v41
    v_cvt_pk_bf16_f32 v85, v42, v43
    v_cvt_pk_bf16_f32 v86, v44, v45
    v_cvt_pk_bf16_f32 v87, v46, v47
    s_setprio 0
    s_waitcnt lgkmcnt(0)
    ds_read_b128 v[92:95], v4 offset:38400
    s_mov_b64 exec, s[28:29]
    ds_read_b64 v[28:29], v5 offset:38400
    s_mov_b64 exec, s[26:27]
    ds_read_b128 v[100:103], v6 offset:35840
    ds_read_b128 v[112:115], v6 offset:33920
    s_mov_b64 exec, -1
    ds_read_b32 v16, v7
    v_exp_f32 v48, v48
    s_setprio 1
    v_exp_f32 v49, v49
    v_mfma_f32_32x32x16_bf16 v[64:79], v[104:107], v[84:87], v[64:79]
    v_exp_f32 v50, v50
    v_exp_f32 v51, v51
    v_exp_f32 v52, v52
    v_exp_f32 v53, v53
    v_mfma_f32_32x32x16_bf16 v[32:47], v[88:91], v[10:13], 0
    v_exp_f32 v54, v54
    v_exp_f32 v55, v55
    v_cvt_pk_bf16_f32 v80, v48, v49
    v_cvt_pk_bf16_f32 v81, v50, v51
    v_cvt_pk_bf16_f32 v82, v52, v53
    v_cvt_pk_bf16_f32 v83, v54, v55
    v_mfma_f32_32x32x8bf16_1k v[32:47], v[24:25], v[20:21], v[32:47]
    v_exp_f32 v56, v56
    v_exp_f32 v57, v57
    v_exp_f32 v58, v58
    v_exp_f32 v59, v59
    v_mfma_f32_32x32x16_bf16 v[64:79], v[108:111], v[80:83], v[64:79]
    v_exp_f32 v60, v60
    v_exp_f32 v61, v61
    v_exp_f32 v62, v62
    v_exp_f32 v63, v63
    v_cvt_pk_bf16_f32 v84, v56, v57
    v_cvt_pk_bf16_f32 v85, v58, v59
    v_cvt_pk_bf16_f32 v86, v60, v61
    v_cvt_pk_bf16_f32 v87, v62, v63
    s_waitcnt lgkmcnt(0)
    v_readfirstlane_b32 s30, v16
    s_setprio 0
    s_nop 0
    s_cmp_ge_u32 s30, 5
    s_cbranch_scc1 L_land_5_skip
    s_mov_b32 s31, 1048576
L_land_5_loop:
    ds_read_b32 v16, v7
    s_waitcnt lgkmcnt(0)
    v_readfirstlane_b32 s30, v16
    s_sub_u32 s31, s31, 1
    s_cbranch_scc1 L_land_5_done
    s_cmp_ge_u32 s30, 5
    s_cbranch_scc1 L_land_5_done
    s_sleep 1
    s_branch L_land_5_loop
L_land_5_done:
L_land_5_skip:
    ds_read_b128 v[88:91], v4 offset:40960
    s_mov_b64 exec, s[28:29]
    ds_read_b64 v[24:25], v5 offset:40960
    s_mov_b64 exec, s[26:27]
    ds_read_b128 v[108:111], v6 offset:38400
    ds_read_b128 v[104:107], v6 offset:36480
    s_mov_b64 exec, -1
    v_exp_f32 v32, v32
    s_setprio 1
    v_exp_f32 v33, v33
    v_mfma_f32_32x32x16_bf16 v[64:79], v[112:115], v[84:87], v[64:79]
    v_exp_f32 v34, v34
    v_exp_f32 v35, v35
    v_exp_f32 v36, v36
    v_exp_f32 v37, v37
    v_mfma_f32_32x32x16_bf16 v[48:63], v[92:95], v[10:13], 0
    v_exp_f32 v38, v38
    v_exp_f32 v39, v39
    v_cvt_pk_bf16_f32 v80, v32, v33
    v_cvt_pk_bf16_f32 v81, v34, v35
    v_cvt_pk_bf16_f32 v82, v36, v37
    v_cvt_pk_bf16_f32 v83, v38, v39
    v_mfma_f32_32x32x8bf16_1k v[48:63], v[28:29], v[20:21], v[48:63]
    v_exp_f32 v40, v40
    v_exp_f32 v41, v41
    v_exp_f32 v42, v42
    v_exp_f32 v43, v43
    v_mfma_f32_32x32x16_bf16 v[64:79], v[100:103], v[80:83], v[64:79]
    v_exp_f32 v44, v44
    v_exp_f32 v45, v45
    v_exp_f32 v46, v46
    v_exp_f32 v47, v47
    v_cvt_pk_bf16_f32 v84, v40, v41
    v_cvt_pk_bf16_f32 v85, v42, v43
    v_cvt_pk_bf16_f32 v86, v44, v45
    v_cvt_pk_bf16_f32 v87, v46, v47
    s_setprio 0
    s_waitcnt lgkmcnt(0)
    ds_read_b128 v[92:95], v4 offset:43520
    s_mov_b64 exec, s[28:29]
    ds_read_b64 v[28:29], v5 offset:43520
    s_mov_b64 exec, s[26:27]
    ds_read_b128 v[100:103], v6 offset:40960
    ds_read_b128 v[112:115], v6 offset:39040
    s_mov_b64 exec, -1
    v_exp_f32 v48, v48
    s_setprio 1
    v_exp_f32 v49, v49
    v_mfma_f32_32x32x16_bf16 v[64:79], v[104:107], v[84:87], v[64:79]
    v_exp_f32 v50, v50
    v_exp_f32 v51, v51
    v_exp_f32 v52, v52
    v_exp_f32 v53, v53
    v_mfma_f32_32x32x16_bf16 v[32:47], v[88:91], v[10:13], 0
    v_exp_f32 v54, v54
    v_exp_f32 v55, v55
    v_cvt_pk_bf16_f32 v80, v48, v49
    v_cvt_pk_bf16_f32 v81, v50, v51
    v_cvt_pk_bf16_f32 v82, v52, v53
    v_cvt_pk_bf16_f32 v83, v54, v55
    v_mfma_f32_32x32x8bf16_1k v[32:47], v[24:25], v[20:21], v[32:47]
    v_exp_f32 v56, v56
    v_exp_f32 v57, v57
    v_exp_f32 v58, v58
    v_exp_f32 v59, v59
    v_mfma_f32_32x32x16_bf16 v[64:79], v[108:111], v[80:83], v[64:79]
    v_exp_f32 v60, v60
    v_exp_f32 v61, v61
    v_exp_f32 v62, v62
    v_exp_f32 v63, v63
    v_cvt_pk_bf16_f32 v84, v56, v57
    v_cvt_pk_bf16_f32 v85, v58, v59
    v_cvt_pk_bf16_f32 v86, v60, v61
    v_cvt_pk_bf16_f32 v87, v62, v63
    s_setprio 0
    s_waitcnt lgkmcnt(0)
    s_mov_b64 exec, 1
    ds_add_u32 v7, v17 offset:80
    s_mov_b64 exec, -1
    ds_read_b128 v[88:91], v4 offset:46080
    s_mov_b64 exec, s[28:29]
    ds_read_b64 v[24:25], v5 offset:46080
    s_mov_b64 exec, s[26:27]
    ds_read_b128 v[108:111], v6 offset:43520
    ds_read_b128 v[104:107], v6 offset:41600
    s_mov_b64 exec, -1
    v_exp_f32 v32, v32
    s_setprio 1
    v_exp_f32 v33, v33
    v_mfma_f32_32x32x16_bf16 v[64:79], v[112:115], v[84:87], v[64:79]
    v_exp_f32 v34, v34
    v_exp_f32 v35, v35
    v_exp_f32 v36, v36
    v_exp_f32 v37, v37
    v_mfma_f32_32x32x16_bf16 v[48:63], v[92:95], v[10:13], 0
    v_exp_f32 v38, v38
    v_exp_f32 v39, v39
    v_cvt_pk_bf16_f32 v80, v32, v33
    v_cvt_pk_bf16_f32 v81, v34, v35
    v_cvt_pk_bf16_f32 v82, v36, v37
    v_cvt_pk_bf16_f32 v83, v38, v39
    v_mfma_f32_32x32x8bf16_1k v[48:63], v[28:29], v[20:21], v[48:63]
    v_exp_f32 v40, v40
    v_exp_f32 v41, v41
    v_exp_f32 v42, v42
    v_exp_f32 v43, v43
    v_mfma_f32_32x32x16_bf16 v[64:79], v[100:103], v[80:83], v[64:79]
    v_exp_f32 v44, v44
    v_exp_f32 v45, v45
    v_exp_f32 v46, v46
    v_exp_f32 v47, v47
    v_cvt_pk_bf16_f32 v84, v40, v41
    v_cvt_pk_bf16_f32 v85, v42, v43
    v_cvt_pk_bf16_f32 v86, v44, v45
    v_cvt_pk_bf16_f32 v87, v46, v47
    s_setprio 0
    s_waitcnt lgkmcnt(0)
    ds_read_b128 v[92:95], v4 offset:48640
    s_mov_b64 exec, s[28:29]
    ds_read_b64 v[28:29], v5 offset:48640
    s_mov_b64 exec, s[26:27]
    ds_read_b128 v[100:103], v6 offset:46080
    ds_read_b128 v[112:115], v6 offset:44160
    s_mov_b64 exec, -1
    v_exp_f32 v48, v48
    s_setprio 1
    v_exp_f32 v49, v49
    v_mfma_f32_32x32x16_bf16 v[64:79], v[104:107], v[84:87], v[64:79]
    v_exp_f32 v50, v50
    v_exp_f32 v51, v51
    v_exp_f32 v52, v52
    v_exp_f32 v53, v53
    v_mfma_f32_32x32x16_bf16 v[32:47], v[88:91], v[10:13], 0
    v_exp_f32 v54, v54
    v_exp_f32 v55, v55
    v_cvt_pk_bf16_f32 v80, v48, v49
    v_cvt_pk_bf16_f32 v81, v50, v51
    v_cvt_pk_bf16_f32 v82, v52, v53
    v_cvt_pk_bf16_f32 v83, v54, v55
    v_mfma_f32_32x32x8bf16_1k v[32:47], v[24:25], v[20:21], v[32:47]
    v_exp_f32 v56, v56
    v_exp_f32 v57, v57
    v_exp_f32 v58, v58
    v_exp_f32 v59, v59
    v_mfma_f32_32x32x16_bf16 v[64:79], v[108:111], v[80:83], v[64:79]
    v_exp_f32 v60, v60
    v_exp_f32 v61, v61
    v_exp_f32 v62, v62
    v_exp_f32 v63, v63
    v_cvt_pk_bf16_f32 v84, v56, v57
    v_cvt_pk_bf16_f32 v85, v58, v59
    v_cvt_pk_bf16_f32 v86, v60, v61
    v_cvt_pk_bf16_f32 v87, v62, v63
    s_setprio 0
    s_waitcnt lgkmcnt(0)
    ds_read_b128 v[88:91], v4 offset:51200
    s_mov_b64 exec, s[28:29]
    ds_read_b64 v[24:25], v5 offset:51200
    s_mov_b64 exec, s[26:27]
    ds_read_b128 v[108:111], v6 offset:48640
    ds_read_b128 v[104:107], v6 offset:46720
    s_mov_b64 exec, -1
    v_exp_f32 v32, v32
    s_setprio 1
    v_exp_f32 v33, v33
    v_mfma_f32_32x32x16_bf16 v[64:79], v[112:115], v[84:87], v[64:79]
    v_exp_f32 v34, v34
    v_exp_f32 v35, v35
    v_exp_f32 v36, v36
    v_exp_f32 v37, v37
    v_mfma_f32_32x32x16_bf16 v[48:63], v[92:95], v[10:13], 0
    v_exp_f32 v38, v38
    v_exp_f32 v39, v39
    v_cvt_pk_bf16_f32 v80, v32, v33
    v_cvt_pk_bf16_f32 v81, v34, v35
    v_cvt_pk_bf16_f32 v82, v36, v37
    v_cvt_pk_bf16_f32 v83, v38, v39
    v_mfma_f32_32x32x8bf16_1k v[48:63], v[28:29], v[20:21], v[48:63]
    v_exp_f32 v40, v40
    v_exp_f32 v41, v41
    v_exp_f32 v42, v42
    v_exp_f32 v43, v43
    v_mfma_f32_32x32x16_bf16 v[64:79], v[100:103], v[80:83], v[64:79]
    v_exp_f32 v44, v44
    v_exp_f32 v45, v45
    v_exp_f32 v46, v46
    v_exp_f32 v47, v47
    v_cvt_pk_bf16_f32 v84, v40, v41
    v_cvt_pk_bf16_f32 v85, v42, v43
    v_cvt_pk_bf16_f32 v86, v44, v45
    v_cvt_pk_bf16_f32 v87, v46, v47
    s_setprio 0
    s_waitcnt lgkmcnt(0)
    ds_read_b128 v[92:95], v4 offset:53760
    s_mov_b64 exec, s[28:29]
    ds_read_b64 v[28:29], v5 offset:53760
    s_mov_b64 exec, s[26:27]
    ds_read_b128 v[100:103], v6 offset:51200
    ds_read_b128 v[112:115], v6 offset:49280
    s_mov_b64 exec, -1
    v_exp_f32 v48, v48
    s_setprio 1
    v_exp_f32 v49, v49
    v_mfma_f32_32x32x16_bf16 v[64:79], v[104:107], v[84:87], v[64:79]
    v_exp_f32 v50, v50
    v_exp_f32 v51, v51
    v_exp_f32 v52, v52
    v_exp_f32 v53, v53
    v_mfma_f32_32x32x16_bf16 v[32:47], v[88:91], v[10:13], 0
    v_exp_f32 v54, v54
    v_exp_f32 v55, v55
    v_cvt_pk_bf16_f32 v80, v48, v49
    v_cvt_pk_bf16_f32 v81, v50, v51
    v_cvt_pk_bf16_f32 v82, v52, v53
    v_cvt_pk_bf16_f32 v83, v54, v55
    v_mfma_f32_32x32x8bf16_1k v[32:47], v[24:25], v[20:21], v[32:47]
    v_exp_f32 v56, v56
    v_exp_f32 v57, v57
    v_exp_f32 v58, v58
    v_exp_f32 v59, v59
    v_mfma_f32_32x32x16_bf16 v[64:79], v[108:111], v[80:83], v[64:79]
    v_exp_f32 v60, v60
    v_exp_f32 v61, v61
    v_exp_f32 v62, v62
    v_exp_f32 v63, v63
    v_cvt_pk_bf16_f32 v84, v56, v57
    v_cvt_pk_bf16_f32 v85, v58, v59
    v_cvt_pk_bf16_f32 v86, v60, v61
    v_cvt_pk_bf16_f32 v87, v62, v63
    s_setprio 0
    s_waitcnt lgkmcnt(0)
    ds_read_b128 v[88:91], v4 offset:56320
    s_mov_b64 exec, s[28:29]
    ds_read_b64 v[24:25], v5 offset:56320
    s_mov_b64 exec, s[26:27]
    ds_read_b128 v[108:111], v6 offset:53760
    ds_read_b128 v[104:107], v6 offset:51840
    s_mov_b64 exec, -1
    v_exp_f32 v32, v32
    s_setprio 1
    v_exp_f32 v33, v33
    v_mfma_f32_32x32x16_bf16 v[64:79], v[112:115], v[84:87], v[64:79]
    v_exp_f32 v34, v34
    v_exp_f32 v35, v35
    v_exp_f32 v36, v36
    v_exp_f32 v37, v37
    v_mfma_f32_32x32x16_bf16 v[48:63], v[92:95], v[10:13], 0
    v_exp_f32 v38, v38
    v_exp_f32 v39, v39
    v_cvt_pk_bf16_f32 v80, v32, v33
    v_cvt_pk_bf16_f32 v81, v34, v35
    v_cvt_pk_bf16_f32 v82, v36, v37
    v_cvt_pk_bf16_f32 v83, v38, v39
    v_mfma_f32_32x32x8bf16_1k v[48:63], v[28:29], v[20:21], v[48:63]
    v_exp_f32 v40, v40
    v_exp_f32 v41, v41
    v_exp_f32 v42, v42
    v_exp_f32 v43, v43
    v_mfma_f32_32x32x16_bf16 v[64:79], v[100:103], v[80:83], v[64:79]
    v_exp_f32 v44, v44
    v_exp_f32 v45, v45
    v_exp_f32 v46, v46
    v_exp_f32 v47, v47
    v_cvt_pk_bf16_f32 v84, v40, v41
    v_cvt_pk_bf16_f32 v85, v42, v43
    v_cvt_pk_bf16_f32 v86, v44, v45
    v_cvt_pk_bf16_f32 v87, v46, v47
    s_setprio 0
    s_waitcnt lgkmcnt(0)
    ds_read_b128 v[92:95], v4 offset:58880
    s_mov_b64 exec, s[28:29]
    ds_read_b64 v[28:29], v5 offset:58880
    s_mov_b64 exec, s[26:27]
    ds_read_b128 v[100:103], v6 offset:56320
    ds_read_b128 v[112:115], v6 offset:54400
    s_mov_b64 exec, -1
    ds_read_b32 v16, v7
    v_exp_f32 v48, v48
    s_setprio 1
    v_exp_f32 v49, v49
    v_mfma_f32_32x32x16_bf16 v[64:79], v[104:107], v[84:87], v[64:79]
    v_exp_f32 v50, v50
    v_exp_f32 v51, v51
    v_exp_f32 v52, v52
    v_exp_f32 v53, v53
    v_mfma_f32_32x32x16_bf16 v[32:47], v[88:91], v[10:13], 0
    v_exp_f32 v54, v54
    v_exp_f32 v55, v55
    v_cvt_pk_bf16_f32 v80, v48, v49
    v_cvt_pk_bf16_f32 v81, v50, v51
    v_cvt_pk_bf16_f32 v82, v52, v53
    v_cvt_pk_bf16_f32 v83, v54, v55
    v_mfma_f32_32x32x8bf16_1k v[32:47], v[24:25], v[20:21], v[32:47]
    v_exp_f32 v56, v56
    v_exp_f32 v57, v57
    v_exp_f32 v58, v58
    v_exp_f32 v59, v59
    v_mfma_f32_32x32x16_bf16 v[64:79], v[108:111], v[80:83], v[64:79]
    v_exp_f32 v60, v60
    v_exp_f32 v61, v61
    v_exp_f32 v62, v62
    v_exp_f32 v63, v63
    v_cvt_pk_bf16_f32 v84, v56, v57
    v_cvt_pk_bf16_f32 v85, v58, v59
    v_cvt_pk_bf16_f32 v86, v60, v61
    v_cvt_pk_bf16_f32 v87, v62, v63
    s_waitcnt lgkmcnt(0)
    v_readfirstlane_b32 s30, v16
    s_setprio 0
    s_nop 0
    s_cmp_ge_u32 s30, 6
    s_cbranch_scc1 L_land_6_skip
    s_mov_b32 s31, 1048576
L_land_6_loop:
    ds_read_b32 v16, v7
    s_waitcnt lgkmcnt(0)
    v_readfirstlane_b32 s30, v16
    s_sub_u32 s31, s31, 1
    s_cbranch_scc1 L_land_6_done
    s_cmp_ge_u32 s30, 6
    s_cbranch_scc1 L_land_6_done
    s_sleep 1
    s_branch L_land_6_loop
L_land_6_done:
L_land_6_skip:
    ds_read_b128 v[88:91], v4 offset:0
    s_mov_b64 exec, s[28:29]
    ds_read_b64 v[24:25], v5 offset:0
    s_mov_b64 exec, s[26:27]
    ds_read_b128 v[108:111], v6 offset:58880
    ds_read_b128 v[104:107], v6 offset:56960
    s_mov_b64 exec, -1
    v_exp_f32 v32, v32
    s_setprio 1
    v_exp_f32 v33, v33
    v_mfma_f32_32x32x16_bf16 v[64:79], v[112:115], v[84:87], v[64:79]
    v_exp_f32 v34, v34
    v_exp_f32 v35, v35
    v_exp_f32 v36, v36
    v_exp_f32 v37, v37
    v_mfma_f32_32x32x16_bf16 v[48:63], v[92:95], v[10:13], 0
    v_exp_f32 v38, v38
    v_exp_f32 v39, v39
    v_cvt_pk_bf16_f32 v80, v32, v33
    v_cvt_pk_bf16_f32 v81, v34, v35
    v_cvt_pk_bf16_f32 v82, v36, v37
    v_cvt_pk_bf16_f32 v83, v38, v39
    v_mfma_f32_32x32x8bf16_1k v[48:63], v[28:29], v[20:21], v[48:63]
    v_exp_f32 v40, v40
    v_exp_f32 v41, v41
    v_exp_f32 v42, v42
    v_exp_f32 v43, v43
    v_mfma_f32_32x32x16_bf16 v[64:79], v[100:103], v[80:83], v[64:79]
    v_exp_f32 v44, v44
    v_exp_f32 v45, v45
    v_exp_f32 v46, v46
    v_exp_f32 v47, v47
    v_cvt_pk_bf16_f32 v84, v40, v41
    v_cvt_pk_bf16_f32 v85, v42, v43
    v_cvt_pk_bf16_f32 v86, v44, v45
    v_cvt_pk_bf16_f32 v87, v46, v47
    s_setprio 0
    s_waitcnt lgkmcnt(0)
    ds_read_b128 v[92:95], v4 offset:2560
    s_mov_b64 exec, s[28:29]
    ds_read_b64 v[28:29], v5 offset:2560
    s_mov_b64 exec, s[26:27]
    ds_read_b128 v[100:103], v6 offset:0
    ds_read_b128 v[112:115], v6 offset:59520
    s_mov_b64 exec, -1
    v_exp_f32 v48, v48
    s_setprio 1
    v_exp_f32 v49, v49
    v_mfma_f32_32x32x16_bf16 v[64:79], v[104:107], v[84:87], v[64:79]
    v_exp_f32 v50, v50
    v_exp_f32 v51, v51
    v_exp_f32 v52, v52
    v_exp_f32 v53, v53
    v_mfma_f32_32x32x16_bf16 v[32:47], v[88:91], v[10:13], 0
    v_exp_f32 v54, v54
    v_exp_f32 v55, v55
    v_cvt_pk_bf16_f32 v80, v48, v49
    v_cvt_pk_bf16_f32 v81, v50, v51
    v_cvt_pk_bf16_f32 v82, v52, v53
    v_cvt_pk_bf16_f32 v83, v54, v55
    v_mfma_f32_32x32x8bf16_1k v[32:47], v[24:25], v[20:21], v[32:47]
    v_exp_f32 v56, v56
    v_exp_f32 v57, v57
    v_exp_f32 v58, v58
    v_exp_f32 v59, v59
    v_mfma_f32_32x32x16_bf16 v[64:79], v[108:111], v[80:83], v[64:79]
    v_exp_f32 v60, v60
    v_exp_f32 v61, v61
    v_exp_f32 v62, v62
    v_exp_f32 v63, v63
    v_cvt_pk_bf16_f32 v84, v56, v57
    v_cvt_pk_bf16_f32 v85, v58, v59
    v_cvt_pk_bf16_f32 v86, v60, v61
    v_cvt_pk_bf16_f32 v87, v62, v63
    s_setprio 0
    s_waitcnt lgkmcnt(0)
    ds_read_b128 v[88:91], v4 offset:5120
    s_mov_b64 exec, s[28:29]
    ds_read_b64 v[24:25], v5 offset:5120
    s_mov_b64 exec, s[26:27]
    ds_read_b128 v[108:111], v6 offset:2560
    ds_read_b128 v[104:107], v6 offset:640
    s_mov_b64 exec, -1
    v_exp_f32 v32, v32
    s_setprio 1
    v_exp_f32 v33, v33
    v_mfma_f32_32x32x16_bf16 v[64:79], v[112:115], v[84:87], v[64:79]
    v_exp_f32 v34, v34
    v_exp_f32 v35, v35
    v_exp_f32 v36, v36
    v_exp_f32 v37, v37
    v_mfma_f32_32x32x16_bf16 v[48:63], v[92:95], v[10:13], 0
    v_exp_f32 v38, v38
    v_exp_f32 v39, v39
    v_cvt_pk_bf16_f32 v80, v32, v33
    v_cvt_pk_bf16_f32 v81, v34, v35
    v_cvt_pk_bf16_f32 v82, v36, v37
    v_cvt_pk_bf16_f32 v83, v38, v39
    v_mfma_f32_32x32x8bf16_1k v[48:63], v[28:29], v[20:21], v[48:63]
    v_exp_f32 v40, v40
    v_exp_f32 v41, v41
    v_exp_f32 v42, v42
    v_exp_f32 v43, v43
    v_mfma_f32_32x32x16_bf16 v[64:79], v[100:103], v[80:83], v[64:79]
    v_exp_f32 v44, v44
    v_exp_f32 v45, v45
    v_exp_f32 v46, v46
    v_exp_f32 v47, v47
    v_cvt_pk_bf16_f32 v84, v40, v41
    v_cvt_pk_bf16_f32 v85, v42, v43
    v_cvt_pk_bf16_f32 v86, v44, v45
    v_cvt_pk_bf16_f32 v87, v46, v47
    s_setprio 0
    s_waitcnt lgkmcnt(0)
    ds_read_b128 v[92:95], v4 offset:7680
    s_mov_b64 exec, s[28:29]
    ds_read_b64 v[28:29], v5 offset:7680
    s_mov_b64 exec, s[26:27]
    ds_read_b128 v[100:103], v6 offset:5120
    ds_read_b128 v[112:115], v6 offset:3200
    s_mov_b64 exec, -1
    v_exp_f32 v48, v48
    s_setprio 1
    v_exp_f32 v49, v49
    v_mfma_f32_32x32x16_bf16 v[64:79], v[104:107], v[84:87], v[64:79]
    v_exp_f32 v50, v50
    v_exp_f32 v51, v51
    v_exp_f32 v52, v52
    v_exp_f32 v53, v53
    v_mfma_f32_32x32x16_bf16 v[32:47], v[88:91], v[10:13], 0
    v_exp_f32 v54, v54
    v_exp_f32 v55, v55
    v_cvt_pk_bf16_f32 v80, v48, v49
    v_cvt_pk_bf16_f32 v81, v50, v51
    v_cvt_pk_bf16_f32 v82, v52, v53
    v_cvt_pk_bf16_f32 v83, v54, v55
    v_mfma_f32_32x32x8bf16_1k v[32:47], v[24:25], v[20:21], v[32:47]
    v_exp_f32 v56, v56
    v_exp_f32 v57, v57
    v_exp_f32 v58, v58
    v_exp_f32 v59, v59
    v_mfma_f32_32x32x16_bf16 v[64:79], v[108:111], v[80:83], v[64:79]
    v_exp_f32 v60, v60
    v_exp_f32 v61, v61
    v_exp_f32 v62, v62
    v_exp_f32 v63, v63
    v_cvt_pk_bf16_f32 v84, v56, v57
    v_cvt_pk_bf16_f32 v85, v58, v59
    v_cvt_pk_bf16_f32 v86, v60, v61
    v_cvt_pk_bf16_f32 v87, v62, v63
    s_setprio 0
    s_waitcnt lgkmcnt(0)
    ds_read_b128 v[88:91], v4 offset:10240
    s_mov_b64 exec, s[28:29]
    ds_read_b64 v[24:25], v5 offset:10240
    s_mov_b64 exec, s[26:27]
    ds_read_b128 v[108:111], v6 offset:7680
    ds_read_b128 v[104:107], v6 offset:5760
    s_mov_b64 exec, -1
    v_exp_f32 v32, v32
    s_setprio 1
    v_exp_f32 v33, v33
    v_mfma_f32_32x32x16_bf16 v[64:79], v[112:115], v[84:87], v[64:79]
    v_exp_f32 v34, v34
    v_exp_f32 v35, v35
    v_exp_f32 v36, v36
    v_exp_f32 v37, v37
    v_mfma_f32_32x32x16_bf16 v[48:63], v[92:95], v[10:13], 0
    v_exp_f32 v38, v38
    v_exp_f32 v39, v39
    v_cvt_pk_bf16_f32 v80, v32, v33
    v_cvt_pk_bf16_f32 v81, v34, v35
    v_cvt_pk_bf16_f32 v82, v36, v37
    v_cvt_pk_bf16_f32 v83, v38, v39
    v_mfma_f32_32x32x8bf16_1k v[48:63], v[28:29], v[20:21], v[48:63]
    v_exp_f32 v40, v40
    v_exp_f32 v41, v41
    v_exp_f32 v42, v42
    v_exp_f32 v43, v43
    v_mfma_f32_32x32x16_bf16 v[64:79], v[100:103], v[80:83], v[64:79]
    v_exp_f32 v44, v44
    v_exp_f32 v45, v45
    v_exp_f32 v46, v46
    v_exp_f32 v47, v47
    v_cvt_pk_bf16_f32 v84, v40, v41
    v_cvt_pk_bf16_f32 v85, v42, v43
    v_cvt_pk_bf16_f32 v86, v44, v45
    v_cvt_pk_bf16_f32 v87, v46, v47
    s_setprio 0
    s_waitcnt lgkmcnt(0)
    ds_read_b128 v[92:95], v4 offset:12800
    s_mov_b64 exec, s[28:29]
    ds_read_b64 v[28:29], v5 offset:12800
    s_mov_b64 exec, s[26:27]
    ds_read_b128 v[100:103], v6 offset:10240
    ds_read_b128 v[112:115], v6 offset:8320
    s_mov_b64 exec, -1
    v_exp_f32 v48, v48
    s_setprio 1
    v_exp_f32 v49, v49
    v_mfma_f32_32x32x16_bf16 v[64:79], v[104:107], v[84:87], v[64:79]
    v_exp_f32 v50, v50
    v_exp_f32 v51, v51
    v_exp_f32 v52, v52
    v_exp_f32 v53, v53
    v_mfma_f32_32x32x16_bf16 v[32:47], v[88:91], v[10:13], 0
    v_exp_f32 v54, v54
    v_exp_f32 v55, v55
    v_cvt_pk_bf16_f32 v80, v48, v49
    v_cvt_pk_bf16_f32 v81, v50, v51
    v_cvt_pk_bf16_f32 v82, v52, v53
    v_cvt_pk_bf16_f32 v83, v54, v55
    v_mfma_f32_32x32x8bf16_1k v[32:47], v[24:25], v[20:21], v[32:47]
    v_exp_f32 v56, v56
    v_exp_f32 v57, v57
    v_exp_f32 v58, v58
    v_exp_f32 v59, v59
    v_mfma_f32_32x32x16_bf16 v[64:79], v[108:111], v[80:83], v[64:79]
    v_exp_f32 v60, v60
    v_exp_f32 v61, v61
    v_exp_f32 v62, v62
    v_exp_f32 v63, v63
    v_cvt_pk_bf16_f32 v84, v56, v57
    v_cvt_pk_bf16_f32 v85, v58, v59
    v_cvt_pk_bf16_f32 v86, v60, v61
    v_cvt_pk_bf16_f32 v87, v62, v63
    s_setprio 0
    s_waitcnt lgkmcnt(0)
    ds_read_b128 v[88:91], v4 offset:15360
    s_mov_b64 exec, s[28:29]
    ds_read_b64 v[24:25], v5 offset:15360
    s_mov_b64 exec, s[26:27]
    ds_read_b128 v[108:111], v6 offset:12800
    ds_read_b128 v[104:107], v6 offset:10880
    s_mov_b64 exec, -1
    v_exp_f32 v32, v32
    s_setprio 1
    v_exp_f32 v33, v33
    v_mfma_f32_32x32x16_bf16 v[64:79], v[112:115], v[84:87], v[64:79]
    v_exp_f32 v34, v34
    v_exp_f32 v35, v35
    v_exp_f32 v36, v36
    v_exp_f32 v37, v37
    v_mfma_f32_32x32x16_bf16 v[48:63], v[92:95], v[10:13], 0
    v_exp_f32 v38, v38
    v_exp_f32 v39, v39
    v_cvt_pk_bf16_f32 v80, v32, v33
    v_cvt_pk_bf16_f32 v81, v34, v35
    v_cvt_pk_bf16_f32 v82, v36, v37
    v_cvt_pk_bf16_f32 v83, v38, v39
    v_mfma_f32_32x32x8bf16_1k v[48:63], v[28:29], v[20:21], v[48:63]
    v_exp_f32 v40, v40
    v_exp_f32 v41, v41
    v_exp_f32 v42, v42
    v_exp_f32 v43, v43
    v_mfma_f32_32x32x16_bf16 v[64:79], v[100:103], v[80:83], v[64:79]
    v_exp_f32 v44, v44
    v_exp_f32 v45, v45
    v_exp_f32 v46, v46
    v_exp_f32 v47, v47
    v_cvt_pk_bf16_f32 v84, v40, v41
    v_cvt_pk_bf16_f32 v85, v42, v43
    v_cvt_pk_bf16_f32 v86, v44, v45
    v_cvt_pk_bf16_f32 v87, v46, v47
    s_setprio 0
    s_waitcnt lgkmcnt(0)
    ds_read_b128 v[92:95], v4 offset:17920
    s_mov_b64 exec, s[28:29]
    ds_read_b64 v[28:29], v5 offset:17920
    s_mov_b64 exec, s[26:27]
    ds_read_b128 v[100:103], v6 offset:15360
    ds_read_b128 v[112:115], v6 offset:13440
    s_mov_b64 exec, -1
    ds_read_b32 v16, v7
    v_exp_f32 v48, v48
    s_setprio 1
    v_exp_f32 v49, v49
    v_mfma_f32_32x32x16_bf16 v[64:79], v[104:107], v[84:87], v[64:79]
    v_exp_f32 v50, v50
    v_exp_f32 v51, v51
    v_exp_f32 v52, v52
    v_exp_f32 v53, v53
    v_mfma_f32_32x32x16_bf16 v[32:47], v[88:91], v[10:13], 0
    v_exp_f32 v54, v54
    v_exp_f32 v55, v55
    v_cvt_pk_bf16_f32 v80, v48, v49
    v_cvt_pk_bf16_f32 v81, v50, v51
    v_cvt_pk_bf16_f32 v82, v52, v53
    v_cvt_pk_bf16_f32 v83, v54, v55
    v_mfma_f32_32x32x8bf16_1k v[32:47], v[24:25], v[20:21], v[32:47]
    v_exp_f32 v56, v56
    v_exp_f32 v57, v57
    v_exp_f32 v58, v58
    v_exp_f32 v59, v59
    v_mfma_f32_32x32x16_bf16 v[64:79], v[108:111], v[80:83], v[64:79]
    v_exp_f32 v60, v60
    v_exp_f32 v61, v61
    v_exp_f32 v62, v62
    v_exp_f32 v63, v63
    v_cvt_pk_bf16_f32 v84, v56, v57
    v_cvt_pk_bf16_f32 v85, v58, v59
    v_cvt_pk_bf16_f32 v86, v60, v61
    v_cvt_pk_bf16_f32 v87, v62, v63
    s_waitcnt lgkmcnt(0)
    v_readfirstlane_b32 s30, v16
    s_setprio 0
    s_nop 0
    s_cmp_ge_u32 s30, 7
    s_cbranch_scc1 L_land_7_skip
    s_mov_b32 s31, 1048576
L_land_7_loop:
    ds_read_b32 v16, v7
    s_waitcnt lgkmcnt(0)
    v_readfirstlane_b32 s30, v16
    s_sub_u32 s31, s31, 1
    s_cbranch_scc1 L_land_7_done
    s_cmp_ge_u32 s30, 7
    s_cbranch_scc1 L_land_7_done
    s_sleep 1
    s_branch L_land_7_loop
L_land_7_done:
L_land_7_skip:
    ds_read_b128 v[88:91], v4 offset:20480
    s_mov_b64 exec, s[28:29]
    ds_read_b64 v[24:25], v5 offset:20480
    s_mov_b64 exec, s[26:27]
    ds_read_b128 v[108:111], v6 offset:17920
    ds_read_b128 v[104:107], v6 offset:16000
    s_mov_b64 exec, -1
    v_exp_f32 v32, v32
    s_setprio 1
    v_exp_f32 v33, v33
    v_mfma_f32_32x32x16_bf16 v[64:79], v[112:115], v[84:87], v[64:79]
    v_exp_f32 v34, v34
    v_exp_f32 v35, v35
    v_exp_f32 v36, v36
    v_exp_f32 v37, v37
    v_mfma_f32_32x32x16_bf16 v[48:63], v[92:95], v[10:13], 0
    v_exp_f32 v38, v38
    v_exp_f32 v39, v39
    v_cvt_pk_bf16_f32 v80, v32, v33
    v_cvt_pk_bf16_f32 v81, v34, v35
    v_cvt_pk_bf16_f32 v82, v36, v37
    v_cvt_pk_bf16_f32 v83, v38, v39
    v_mfma_f32_32x32x8bf16_1k v[48:63], v[28:29], v[20:21], v[48:63]
    v_exp_f32 v40, v40
    v_exp_f32 v41, v41
    v_exp_f32 v42, v42
    v_exp_f32 v43, v43
    v_mfma_f32_32x32x16_bf16 v[64:79], v[100:103], v[80:83], v[64:79]
    v_exp_f32 v44, v44
    v_exp_f32 v45, v45
    v_exp_f32 v46, v46
    v_exp_f32 v47, v47
    v_cvt_pk_bf16_f32 v84, v40, v41
    v_cvt_pk_bf16_f32 v85, v42, v43
    v_cvt_pk_bf16_f32 v86, v44, v45
    v_cvt_pk_bf16_f32 v87, v46, v47
    s_setprio 0
    s_waitcnt lgkmcnt(0)
    ds_read_b128 v[92:95], v4 offset:23040
    s_mov_b64 exec, s[28:29]
    ds_read_b64 v[28:29], v5 offset:23040
    s_mov_b64 exec, s[26:27]
    ds_read_b128 v[100:103], v6 offset:20480
    ds_read_b128 v[112:115], v6 offset:18560
    s_mov_b64 exec, -1
    v_exp_f32 v48, v48
    s_setprio 1
    v_exp_f32 v49, v49
    v_mfma_f32_32x32x16_bf16 v[64:79], v[104:107], v[84:87], v[64:79]
    v_exp_f32 v50, v50
    v_exp_f32 v51, v51
    v_exp_f32 v52, v52
    v_exp_f32 v53, v53
    v_mfma_f32_32x32x16_bf16 v[32:47], v[88:91], v[10:13], 0
    v_exp_f32 v54, v54
    v_exp_f32 v55, v55
    v_cvt_pk_bf16_f32 v80, v48, v49
    v_cvt_pk_bf16_f32 v81, v50, v51
    v_cvt_pk_bf16_f32 v82, v52, v53
    v_cvt_pk_bf16_f32 v83, v54, v55
    v_mfma_f32_32x32x8bf16_1k v[32:47], v[24:25], v[20:21], v[32:47]
    v_exp_f32 v56, v56
    v_exp_f32 v57, v57
    v_exp_f32 v58, v58
    v_exp_f32 v59, v59
    v_mfma_f32_32x32x16_bf16 v[64:79], v[108:111], v[80:83], v[64:79]
    v_exp_f32 v60, v60
    v_exp_f32 v61, v61
    v_exp_f32 v62, v62
    v_exp_f32 v63, v63
    v_cvt_pk_bf16_f32 v84, v56, v57
    v_cvt_pk_bf16_f32 v85, v58, v59
    v_cvt_pk_bf16_f32 v86, v60, v61
    v_cvt_pk_bf16_f32 v87, v62, v63
    s_setprio 0
    s_waitcnt lgkmcnt(0)
    ds_read_b128 v[88:91], v4 offset:25600
    s_mov_b64 exec, s[28:29]
    ds_read_b64 v[24:25], v5 offset:25600
    s_mov_b64 exec, s[26:27]
    ds_read_b128 v[108:111], v6 offset:23040
    ds_read_b128 v[104:107], v6 offset:21120
    s_mov_b64 exec, -1
    v_exp_f32 v32, v32
    s_setprio 1
    v_exp_f32 v33, v33
    v_mfma_f32_32x32x16_bf16 v[64:79], v[112:115], v[84:87], v[64:79]
    v_exp_f32 v34, v34
    v_exp_f32 v35, v35
    v_exp_f32 v36, v36
    v_exp_f32 v37, v37
    v_mfma_f32_32x32x16_bf16 v[48:63], v[92:95], v[10:13], 0
    v_exp_f32 v38, v38
    v_exp_f32 v39, v39
    v_cvt_pk_bf16_f32 v80, v32, v33
    v_cvt_pk_bf16_f32 v81, v34, v35
    v_cvt_pk_bf16_f32 v82, v36, v37
    v_cvt_pk_bf16_f32 v83, v38, v39
    v_mfma_f32_32x32x8bf16_1k v[48:63], v[28:29], v[20:21], v[48:63]
    v_exp_f32 v40, v40
    v_exp_f32 v41, v41
    v_exp_f32 v42, v42
    v_exp_f32 v43, v43
    v_mfma_f32_32x32x16_bf16 v[64:79], v[100:103], v[80:83], v[64:79]
    v_exp_f32 v44, v44
    v_exp_f32 v45, v45
    v_exp_f32 v46, v46
    v_exp_f32 v47, v47
    v_cvt_pk_bf16_f32 v84, v40, v41
    v_cvt_pk_bf16_f32 v85, v42, v43
    v_cvt_pk_bf16_f32 v86, v44, v45
    v_cvt_pk_bf16_f32 v87, v46, v47
    s_setprio 0
    s_waitcnt lgkmcnt(0)
    ds_read_b128 v[92:95], v4 offset:28160
    s_mov_b64 exec, s[28:29]
    ds_read_b64 v[28:29], v5 offset:28160
    s_mov_b64 exec, s[26:27]
    ds_read_b128 v[100:103], v6 offset:25600
    ds_read_b128 v[112:115], v6 offset:23680
    s_mov_b64 exec, -1
    v_exp_f32 v48, v48
    s_setprio 1
    v_exp_f32 v49, v49
    v_mfma_f32_32x32x16_bf16 v[64:79], v[104:107], v[84:87], v[64:79]
    v_exp_f32 v50, v50
    v_exp_f32 v51, v51
    v_exp_f32 v52, v52
    v_exp_f32 v53, v53
    v_mfma_f32_32x32x16_bf16 v[32:47], v[88:91], v[10:13], 0
    v_exp_f32 v54, v54
    v_exp_f32 v55, v55
    v_cvt_pk_bf16_f32 v80, v48, v49
    v_cvt_pk_bf16_f32 v81, v50, v51
    v_cvt_pk_bf16_f32 v82, v52, v53
    v_cvt_pk_bf16_f32 v83, v54, v55
    v_mfma_f32_32x32x8bf16_1k v[32:47], v[24:25], v[20:21], v[32:47]
    v_exp_f32 v56, v56
    v_exp_f32 v57, v57
    v_exp_f32 v58, v58
    v_exp_f32 v59, v59
    v_mfma_f32_32x32x16_bf16 v[64:79], v[108:111], v[80:83], v[64:79]
    v_exp_f32 v60, v60
    v_exp_f32 v61, v61
    v_exp_f32 v62, v62
    v_exp_f32 v63, v63
    v_cvt_pk_bf16_f32 v84, v56, v57
    v_cvt_pk_bf16_f32 v85, v58, v59
    v_cvt_pk_bf16_f32 v86, v60, v61
    v_cvt_pk_bf16_f32 v87, v62, v63
    s_setprio 0
    s_waitcnt lgkmcnt(0)
    ds_read_b128 v[88:91], v4 offset:30720
    s_mov_b64 exec, s[28:29]
    ds_read_b64 v[24:25], v5 offset:30720
    s_mov_b64 exec, s[26:27]
    ds_read_b128 v[108:111], v6 offset:28160
    ds_read_b128 v[104:107], v6 offset:26240
    s_mov_b64 exec, -1
    v_exp_f32 v32, v32
    s_setprio 1
    v_exp_f32 v33, v33
    v_mfma_f32_32x32x16_bf16 v[64:79], v[112:115], v[84:87], v[64:79]
    v_exp_f32 v34, v34
    v_exp_f32 v35, v35
    v_exp_f32 v36, v36
    v_exp_f32 v37, v37
    v_mfma_f32_32x32x16_bf16 v[48:63], v[92:95], v[10:13], 0
    v_exp_f32 v38, v38
    v_exp_f32 v39, v39
    v_cvt_pk_bf16_f32 v80, v32, v33
    v_cvt_pk_bf16_f32 v81, v34, v35
    v_cvt_pk_bf16_f32 v82, v36, v37
    v_cvt_pk_bf16_f32 v83, v38, v39
    v_mfma_f32_32x32x8bf16_1k v[48:63], v[28:29], v[20:21], v[48:63]
    v_exp_f32 v40, v40
    v_exp_f32 v41, v41
    v_exp_f32 v42, v42
    v_exp_f32 v43, v43
    v_mfma_f32_32x32x16_bf16 v[64:79], v[100:103], v[80:83], v[64:79]
    v_exp_f32 v44, v44
    v_exp_f32 v45, v45
    v_exp_f32 v46, v46
    v_exp_f32 v47, v47
    v_cvt_pk_bf16_f32 v84, v40, v41
    v_cvt_pk_bf16_f32 v85, v42, v43
    v_cvt_pk_bf16_f32 v86, v44, v45
    v_cvt_pk_bf16_f32 v87, v46, v47
    s_setprio 0
    s_waitcnt lgkmcnt(0)
    ds_read_b128 v[92:95], v4 offset:33280
    s_mov_b64 exec, s[28:29]
    ds_read_b64 v[28:29], v5 offset:33280
    s_mov_b64 exec, s[26:27]
    ds_read_b128 v[100:103], v6 offset:30720
    ds_read_b128 v[112:115], v6 offset:28800
    s_mov_b64 exec, -1
    v_exp_f32 v48, v48
    s_setprio 1
    v_exp_f32 v49, v49
    v_mfma_f32_32x32x16_bf16 v[64:79], v[104:107], v[84:87], v[64:79]
    v_exp_f32 v50, v50
    v_exp_f32 v51, v51
    v_exp_f32 v52, v52
    v_exp_f32 v53, v53
    v_mfma_f32_32x32x16_bf16 v[32:47], v[88:91], v[10:13], 0
    v_exp_f32 v54, v54
    v_exp_f32 v55, v55
    v_cvt_pk_bf16_f32 v80, v48, v49
    v_cvt_pk_bf16_f32 v81, v50, v51
    v_cvt_pk_bf16_f32 v82, v52, v53
    v_cvt_pk_bf16_f32 v83, v54, v55
    v_mfma_f32_32x32x8bf16_1k v[32:47], v[24:25], v[20:21], v[32:47]
    v_exp_f32 v56, v56
    v_exp_f32 v57, v57
    v_exp_f32 v58, v58
    v_exp_f32 v59, v59
    v_mfma_f32_32x32x16_bf16 v[64:79], v[108:111], v[80:83], v[64:79]
    v_exp_f32 v60, v60
    v_exp_f32 v61, v61
    v_exp_f32 v62, v62
    v_exp_f32 v63, v63
    v_cvt_pk_bf16_f32 v84, v56, v57
    v_cvt_pk_bf16_f32 v85, v58, v59
    v_cvt_pk_bf16_f32 v86, v60, v61
    v_cvt_pk_bf16_f32 v87, v62, v63
    s_setprio 0
    s_waitcnt lgkmcnt(0)
    ds_read_b128 v[88:91], v4 offset:35840
    s_mov_b64 exec, s[28:29]
    ds_read_b64 v[24:25], v5 offset:35840
    s_mov_b64 exec, s[26:27]
    ds_read_b128 v[108:111], v6 offset:33280
    ds_read_b128 v[104:107], v6 offset:31360
    s_mov_b64 exec, -1
    v_exp_f32 v32, v32
    s_setprio 1
    v_exp_f32 v33, v33
    v_mfma_f32_32x32x16_bf16 v[64:79], v[112:115], v[84:87], v[64:79]
    v_exp_f32 v34, v34
    v_exp_f32 v35, v35
    v_exp_f32 v36, v36
    v_exp_f32 v37, v37
    v_mfma_f32_32x32x16_bf16 v[48:63], v[92:95], v[10:13], 0
    v_exp_f32 v38, v38
    v_exp_f32 v39, v39
    v_cvt_pk_bf16_f32 v80, v32, v33
    v_cvt_pk_bf16_f32 v81, v34, v35
    v_cvt_pk_bf16_f32 v82, v36, v37
    v_cvt_pk_bf16_f32 v83, v38, v39
    v_mfma_f32_32x32x8bf16_1k v[48:63], v[28:29], v[20:21], v[48:63]
    v_exp_f32 v40, v40
    v_exp_f32 v41, v41
    v_exp_f32 v42, v42
    v_exp_f32 v43, v43
    v_mfma_f32_32x32x16_bf16 v[64:79], v[100:103], v[80:83], v[64:79]
    v_exp_f32 v44, v44
    v_exp_f32 v45, v45
    v_exp_f32 v46, v46
    v_exp_f32 v47, v47
    v_cvt_pk_bf16_f32 v84, v40, v41
    v_cvt_pk_bf16_f32 v85, v42, v43
    v_cvt_pk_bf16_f32 v86, v44, v45
    v_cvt_pk_bf16_f32 v87, v46, v47
    s_setprio 0
    s_waitcnt lgkmcnt(0)
    ds_read_b128 v[92:95], v4 offset:38400
    s_mov_b64 exec, s[28:29]
    ds_read_b64 v[28:29], v5 offset:38400
    s_mov_b64 exec, s[26:27]
    ds_read_b128 v[100:103], v6 offset:35840
    ds_read_b128 v[112:115], v6 offset:33920
    s_mov_b64 exec, -1
    v_exp_f32 v48, v48
    s_setprio 1
    v_exp_f32 v49, v49
    v_mfma_f32_32x32x16_bf16 v[64:79], v[104:107], v[84:87], v[64:79]
    v_exp_f32 v50, v50
    v_exp_f32 v51, v51
    v_exp_f32 v52, v52
    v_exp_f32 v53, v53
    v_mfma_f32_32x32x16_bf16 v[32:47], v[88:91], v[10:13], 0
    v_exp_f32 v54, v54
    v_exp_f32 v55, v55
    v_cvt_pk_bf16_f32 v80, v48, v49
    v_cvt_pk_bf16_f32 v81, v50, v51
    v_cvt_pk_bf16_f32 v82, v52, v53
    v_cvt_pk_bf16_f32 v83, v54, v55
    v_mfma_f32_32x32x8bf16_1k v[32:47], v[24:25], v[20:21], v[32:47]
    v_exp_f32 v56, v56
    v_exp_f32 v57, v57
    v_exp_f32 v58, v58
    v_exp_f32 v59, v59
    v_mfma_f32_32x32x16_bf16 v[64:79], v[108:111], v[80:83], v[64:79]
    v_exp_f32 v60, v60
    v_exp_f32 v61, v61
    v_exp_f32 v62, v62
    v_exp_f32 v63, v63
    v_cvt_pk_bf16_f32 v84, v56, v57
    v_cvt_pk_bf16_f32 v85, v58, v59
    v_cvt_pk_bf16_f32 v86, v60, v61
    v_cvt_pk_bf16_f32 v87, v62, v63
    s_setprio 0
    s_waitcnt lgkmcnt(0)
    s_mov_b64 exec, s[26:27]
    ds_read_b128 v[108:111], v6 offset:38400
    ds_read_b128 v[104:107], v6 offset:36480
    s_mov_b64 exec, -1
    v_exp_f32 v32, v32
    s_setprio 1
    v_exp_f32 v33, v33
    v_mfma_f32_32x32x16_bf16 v[64:79], v[112:115], v[84:87], v[64:79]
    v_exp_f32 v34, v34
    v_exp_f32 v35, v35
    v_exp_f32 v36, v36
    v_exp_f32 v37, v37
    v_mfma_f32_32x32x16_bf16 v[48:63], v[92:95], v[10:13], 0
    v_exp_f32 v38, v38
    v_exp_f32 v39, v39
    v_cvt_pk_bf16_f32 v80, v32, v33
    v_cvt_pk_bf16_f32 v81, v34, v35
    v_cvt_pk_bf16_f32 v82, v36, v37
    v_cvt_pk_bf16_f32 v83, v38, v39
    v_mfma_f32_32x32x8bf16_1k v[48:63], v[28:29], v[20:21], v[48:63]
    v_exp_f32 v40, v40
    v_exp_f32 v41, v41
    v_exp_f32 v42, v42
    v_exp_f32 v43, v43
    v_mfma_f32_32x32x16_bf16 v[64:79], v[100:103], v[80:83], v[64:79]
    v_exp_f32 v44, v44
    v_exp_f32 v45, v45
    v_exp_f32 v46, v46
    v_exp_f32 v47, v47
    v_cvt_pk_bf16_f32 v84, v40, v41
    v_cvt_pk_bf16_f32 v85, v42, v43
    v_cvt_pk_bf16_f32 v86, v44, v45
    v_cvt_pk_bf16_f32 v87, v46, v47
    s_setprio 0
    s_waitcnt lgkmcnt(0)
    s_mov_b64 exec, s[26:27]
    ds_read_b128 v[112:115], v6 offset:39040
    s_mov_b64 exec, -1
    s_nop 1
    v_exp_f32 v48, v48
    s_setprio 1
    v_exp_f32 v49, v49
    v_mfma_f32_32x32x16_bf16 v[64:79], v[104:107], v[84:87], v[64:79]
    v_exp_f32 v50, v50
    v_exp_f32 v51, v51
    v_exp_f32 v52, v52
    v_exp_f32 v53, v53
    v_exp_f32 v54, v54
    v_exp_f32 v55, v55
    v_cvt_pk_bf16_f32 v80, v48, v49
    v_cvt_pk_bf16_f32 v81, v50, v51
    v_cvt_pk_bf16_f32 v82, v52, v53
    v_cvt_pk_bf16_f32 v83, v54, v55
    v_exp_f32 v56, v56
    v_exp_f32 v57, v57
    v_exp_f32 v58, v58
    v_exp_f32 v59, v59
    v_mfma_f32_32x32x16_bf16 v[64:79], v[108:111], v[80:83], v[64:79]
    v_exp_f32 v60, v60
    v_exp_f32 v61, v61
    v_exp_f32 v62, v62
    v_exp_f32 v63, v63
    v_cvt_pk_bf16_f32 v84, v56, v57
    v_cvt_pk_bf16_f32 v85, v58, v59
    v_cvt_pk_bf16_f32 v86, v60, v61
    v_cvt_pk_bf16_f32 v87, v62, v63
    s_setprio 0
    s_waitcnt lgkmcnt(0)
    s_nop 1
    v_mfma_f32_32x32x16_bf16 v[64:79], v[112:115], v[84:87], v[64:79]
    s_nop 15
    s_nop 3
    v_mov_b32 v116, v76
    v_fma_f32 v116, v64, 0, v116
    v_fma_f32 v116, v65, 0, v116
    v_fma_f32 v116, v66, 0, v116
    v_fma_f32 v116, v67, 0, v116
    v_fma_f32 v116, v68, 0, v116
    v_fma_f32 v116, v69, 0, v116
    v_fma_f32 v116, v70, 0, v116
    v_fma_f32 v116, v71, 0, v116
    v_fma_f32 v116, v72, 0, v116
    v_fma_f32 v116, v73, 0, v116
    v_fma_f32 v116, v74, 0, v116
    v_fma_f32 v116, v75, 0, v116
    v_mov_b32 v117, 0x71800000
    v_mov_b32 v118, 0x21800000
    v_cmp_nlt_f32 vcc, v116, v117
    v_cmp_nge_f32 s[12:13], v116, v118
    s_nop 1
    s_or_b64 vcc, vcc, s[12:13]
    s_nop 4
    s_cbranch_vccz L_attn_store
    v_and_b32 v121, 31, v0
    v_lshlrev_b32 v121, 3, v121
    v_mov_b32 v122, v6
    v_mov_b32 v116, 0xff7fffff
    v_and_b32 v118, 63, v0
    v_cmp_gt_u32 vcc, 32, v118
    s_nop 1
    v_cndmask_b32 v20, 0, v20, vcc
    v_mov_b32 v64, 0
    v_mov_b32 v65, 0
    v_mov_b32 v66, 0
    v_mov_b32 v67, 0
    v_mov_b32 v68, 0
    v_mov_b32 v69, 0
    v_mov_b32 v70, 0
    v_mov_b32 v71, 0
    v_mov_b32 v72, 0
    v_mov_b32 v73, 0
    v_mov_b32 v74, 0
    v_mov_b32 v75, 0
    v_mov_b32 v76, 0
    v_mov_b32 v77, 0
    v_mov_b32 v78, 0
    v_mov_b32 v79, 0
    s_mov_b32 s30, s22
    s_mov_b32 s15, 64
L_safe_loop:
    buffer_load_dwordx4 v[88:91], v1, s[8:11], s30 offen
    s_mov_b64 exec, s[28:29]
    buffer_load_dwordx2 v[24:25], v121, s[8:11], s30 offen offset:1024
    s_mov_b64 exec, s[26:27]
    buffer_load_dwordx4 v[100:103], v122, s[8:11], s30 offen
    buffer_load_dwordx4 v[104:107], v122, s[8:11], s30 offen offset:640
    s_mov_b64 exec, -1
    s_waitcnt vmcnt(0)
    v_mfma_f32_32x32x16_bf16 v[32:47], v[88:91], v[10:13], 0
    s_nop 11
    v_mfma_f32_32x32x8bf16_1k v[32:47], v[24:25], v[20:21], v[32:47]
    s_nop 15
    s_nop 3
    v_max3_f32 v117, v32, v33, v34
    v_max3_f32 v117, v117, v35, v36
    v_max3_f32 v117, v117, v37, v38
    v_max3_f32 v117, v117, v39, v40
    v_max3_f32 v117, v117, v41, v42
    v_max3_f32 v117, v117, v43, v44
    v_max3_f32 v117, v117, v45, v46
    v_max_f32 v117, v117, v47
    v_mov_b32 v118, v117
    s_nop 1
    v_permlane32_swap_b32 v117, v118
    s_nop 1
    v_max_f32 v117, v117, v118
    v_max_f32 v117, v117, v116
    v_sub_f32 v118, v116, v117
    v_exp_f32 v118, v118
    v_mov_b32 v116, v117
    v_sub_f32 v32, v32, v117
    v_sub_f32 v33, v33, v117
    v_sub_f32 v34, v34, v117
    v_sub_f32 v35, v35, v117
    v_sub_f32 v36, v36, v117
    v_sub_f32 v37, v37, v117
    v_sub_f32 v38, v38, v117
    v_sub_f32 v39, v39, v117
    v_sub_f32 v40, v40, v117
    v_sub_f32 v41, v41, v117
    v_sub_f32 v42, v42, v117
    v_sub_f32 v43, v43, v117
    v_sub_f32 v44, v44, v117
    v_sub_f32 v45, v45, v117
    v_sub_f32 v46, v46, v117
    v_sub_f32 v47, v47, v117
    v_exp_f32 v32, v32
    v_exp_f32 v33, v33
    v_exp_f32 v34, v34
    v_exp_f32 v35, v35
    v_exp_f32 v36, v36
    v_exp_f32 v37, v37
    v_exp_f32 v38, v38
    v_exp_f32 v39, v39
    v_exp_f32 v40, v40
    v_exp_f32 v41, v41
    v_exp_f32 v42, v42
    v_exp_f32 v43, v43
    v_exp_f32 v44, v44
    v_exp_f32 v45, v45
    v_exp_f32 v46, v46
    v_exp_f32 v47, v47
    v_mul_f32 v64, v64, v118
    v_mul_f32 v65, v65, v118
    v_mul_f32 v66, v66, v118
    v_mul_f32 v67, v67, v118
    v_mul_f32 v68, v68, v118
    v_mul_f32 v69, v69, v118
    v_mul_f32 v70, v70, v118
    v_mul_f32 v71, v71, v118
    v_mul_f32 v72, v72, v118
    v_mul_f32 v73, v73, v118
    v_mul_f32 v74, v74, v118
    v_mul_f32 v75, v75, v118
    v_mul_f32 v76, v76, v118
    v_mul_f32 v77, v77, v118
    v_mul_f32 v78, v78, v118
    v_mul_f32 v79, v79, v118
    v_cvt_pk_bf16_f32 v80, v32, v33
    v_cvt_pk_bf16_f32 v81, v34, v35
    v_cvt_pk_bf16_f32 v82, v36, v37
    v_cvt_pk_bf16_f32 v83, v38, v39
    v_cvt_pk_bf16_f32 v84, v40, v41
    v_cvt_pk_bf16_f32 v85, v42, v43
    v_cvt_pk_bf16_f32 v86, v44, v45
    v_cvt_pk_bf16_f32 v87, v46, v47
    s_nop 1
    v_mfma_f32_32x32x16_bf16 v[64:79], v[100:103], v[80:83], v[64:79]
    v_mfma_f32_32x32x16_bf16 v[64:79], v[104:107], v[84:87], v[64:79]
    s_add_u32 s30, s30, 2560
    s_sub_u32 s15, s15, 1
    s_nop 15
    s_nop 3
    s_cmp_lg_u32 s15, 0
    s_cbranch_scc1 L_safe_loop
L_attn_store:
    v_rcp_f32 v116, v76
    s_nop 1
    v_mul_f32 v64, v64, v116
    v_mul_f32 v65, v65, v116
    v_mul_f32 v66, v66, v116
    v_mul_f32 v67, v67, v116
    v_mul_f32 v68, v68, v116
    v_mul_f32 v69, v69, v116
    v_mul_f32 v70, v70, v116
    v_mul_f32 v71, v71, v116
    v_mul_f32 v72, v72, v116
    v_mul_f32 v73, v73, v116
    v_mul_f32 v74, v74, v116
    v_mul_f32 v75, v75, v116
    v_cvt_pk_bf16_f32 v80, v64, v65
    v_cvt_pk_bf16_f32 v81, v66, v67
    v_cvt_pk_bf16_f32 v82, v68, v69
    v_cvt_pk_bf16_f32 v83, v70, v71
    v_cvt_pk_bf16_f32 v84, v72, v73
    v_cvt_pk_bf16_f32 v85, v74, v75
    v_and_b32 v117, 15, v0
    v_lshlrev_b32 v117, 4, v117
    v_bfe_u32 v118, v0, 4, 1
    v_mul_u32_u24 v118, 20480, v118
    v_add_u32 v117, v117, v118
    v_bfe_u32 v118, v0, 5, 1
    v_lshl_add_u32 v118, v118, 8, v117
    buffer_store_dwordx4 v[80:83], v118, s[8:11], s25 offen sc1
    s_mov_b64 exec, s[28:29]
    buffer_store_dwordx2 v[84:85], v117, s[8:11], s24 offen sc1
    s_mov_b64 exec, -1
    s_branch L_k2_join
L_k2_helper:
    s_setprio 3
    s_cmp_lg_u32 s20, 8
    s_cbranch_scc1 L_k2_ffn
    v_lshlrev_b32 v4, 2, v3
    v_add_u32 v4, 143360, v4
    v_mov_b32 v5, 0
    ds_write_b32 v4, v5
    v_mov_b32 v4, 143360
    s_waitcnt lgkmcnt(0)
    s_mov_b32 s8, s4
    s_and_b32 s9, s5, 0xffff
    s_mov_b32 s10, 11993088
    s_mov_b32 s11, 0x00020000
    s_barrier
    s_mov_b32 m0, 20480
    s_add_u32 s30, s22, 20480
    buffer_load_dwordx4 v1, s[8:11], s30 offen offset:0 lds
    buffer_load_dwordx4 v1, s[8:11], s30 offen offset:1024 lds
    buffer_load_dwordx4 v1, s[8:11], s30 offen offset:2048 lds
    buffer_load_dwordx4 v1, s[8:11], s30 offen offset:3072 lds
    s_mov_b32 m0, 24576
    s_add_u32 s30, s22, 24576
    buffer_load_dwordx4 v1, s[8:11], s30 offen offset:0 lds
    buffer_load_dwordx4 v1, s[8:11], s30 offen offset:1024 lds
    buffer_load_dwordx4 v1, s[8:11], s30 offen offset:2048 lds
    buffer_load_dwordx4 v1, s[8:11], s30 offen offset:3072 lds
    s_mov_b32 m0, 28672
    s_add_u32 s30, s22, 28672
    buffer_load_dwordx4 v1, s[8:11], s30 offen offset:0 lds
    buffer_load_dwordx4 v1, s[8:11], s30 offen offset:1024 lds
    buffer_load_dwordx4 v1, s[8:11], s30 offen offset:2048 lds
    buffer_load_dwordx4 v1, s[8:11], s30 offen offset:3072 lds
    s_mov_b32 m0, 32768
    s_add_u32 s30, s22, 32768
    buffer_load_dwordx4 v1, s[8:11], s30 offen offset:0 lds
    buffer_load_dwordx4 v1, s[8:11], s30 offen offset:1024 lds
    buffer_load_dwordx4 v1, s[8:11], s30 offen offset:2048 lds
    buffer_load_dwordx4 v1, s[8:11], s30 offen offset:3072 lds
    s_mov_b32 m0, 36864
    s_add_u32 s30, s22, 36864
    buffer_load_dwordx4 v1, s[8:11], s30 offen offset:0 lds
    buffer_load_dwordx4 v1, s[8:11], s30 offen offset:1024 lds
    buffer_load_dwordx4 v1, s[8:11], s30 offen offset:2048 lds
    buffer_load_dwordx4 v1, s[8:11], s30 offen offset:3072 lds
    s_mov_b32 m0, 40960
    s_add_u32 s30, s22, 40960
    buffer_load_dwordx4 v1, s[8:11], s30 offen offset:0 lds
    buffer_load_dwordx4 v1, s[8:11], s30 offen offset:1024 lds
    buffer_load_dwordx4 v1, s[8:11], s30 offen offset:2048 lds
    buffer_load_dwordx4 v1, s[8:11], s30 offen offset:3072 lds
    s_mov_b32 m0, 45056
    s_add_u32 s30, s22, 45056
    buffer_load_dwordx4 v1, s[8:11], s30 offen offset:0 lds
    buffer_load_dwordx4 v1, s[8:11], s30 offen offset:1024 lds
    buffer_load_dwordx4 v1, s[8:11], s30 offen offset:2048 lds
    buffer_load_dwordx4 v1, s[8:11], s30 offen offset:3072 lds
    s_mov_b32 m0, 49152
    s_add_u32 s30, s22, 49152
    buffer_load_dwordx4 v1, s[8:11], s30 offen offset:0 lds
    buffer_load_dwordx4 v1, s[8:11], s30 offen offset:1024 lds
    buffer_load_dwordx4 v1, s[8:11], s30 offen offset:2048 lds
    buffer_load_dwordx4 v1, s[8:11], s30 offen offset:3072 lds
    s_mov_b32 m0, 53248
    s_add_u32 s30, s22, 53248
    buffer_load_dwordx4 v1, s[8:11], s30 offen offset:0 lds
    buffer_load_dwordx4 v1, s[8:11], s30 offen offset:1024 lds
    buffer_load_dwordx4 v1, s[8:11], s30 offen offset:2048 lds
    buffer_load_dwordx4 v1, s[8:11], s30 offen offset:3072 lds
    s_mov_b32 m0, 57344
    s_add_u32 s30, s22, 57344
    buffer_load_dwordx4 v1, s[8:11], s30 offen offset:0 lds
    buffer_load_dwordx4 v1, s[8:11], s30 offen offset:1024 lds
    buffer_load_dwordx4 v1, s[8:11], s30 offen offset:2048 lds
    buffer_load_dwordx4 v1, s[8:11], s30 offen offset:3072 lds
    s_waitcnt vmcnt(20)
    v_mov_b32 v5, 1
    ds_write_b32 v4, v5
    s_waitcnt vmcnt(0)
    v_mov_b32 v5, 2
    ds_write_b32 v4, v5
    v_mov_b32 v6, 143424
    s_mov_b32 s31, 1048576
L_free_3_loop:
    ds_read_b32 v7, v6
    s_waitcnt lgkmcnt(0)
    v_readfirstlane_b32 s30, v7
    s_sub_u32 s31, s31, 1
    s_cbranch_scc1 L_free_3_done
    s_cmp_ge_u32 s30, 8
    s_cbranch_scc1 L_free_3_done
    s_sleep 6
    s_branch L_free_3_loop
L_free_3_done:
    s_mov_b32 m0, 0
    s_add_u32 s30, s22, 61440
    buffer_load_dwordx4 v1, s[8:11], s30 offen offset:0 lds
    buffer_load_dwordx4 v1, s[8:11], s30 offen offset:1024 lds
    buffer_load_dwordx4 v1, s[8:11], s30 offen offset:2048 lds
    buffer_load_dwordx4 v1, s[8:11], s30 offen offset:3072 lds
    s_mov_b32 m0, 4096
    s_add_u32 s30, s22, 65536
    buffer_load_dwordx4 v1, s[8:11], s30 offen offset:0 lds
    buffer_load_dwordx4 v1, s[8:11], s30 offen offset:1024 lds
    buffer_load_dwordx4 v1, s[8:11], s30 offen offset:2048 lds
    buffer_load_dwordx4 v1, s[8:11], s30 offen offset:3072 lds
    s_mov_b32 m0, 8192
    s_add_u32 s30, s22, 69632
    buffer_load_dwordx4 v1, s[8:11], s30 offen offset:0 lds
    buffer_load_dwordx4 v1, s[8:11], s30 offen offset:1024 lds
    buffer_load_dwordx4 v1, s[8:11], s30 offen offset:2048 lds
    buffer_load_dwordx4 v1, s[8:11], s30 offen offset:3072 lds
    s_mov_b32 m0, 12288
    s_add_u32 s30, s22, 73728
    buffer_load_dwordx4 v1, s[8:11], s30 offen offset:0 lds
    buffer_load_dwordx4 v1, s[8:11], s30 offen offset:1024 lds
    buffer_load_dwordx4 v1, s[8:11], s30 offen offset:2048 lds
    buffer_load_dwordx4 v1, s[8:11], s30 offen offset:3072 lds
    s_mov_b32 m0, 16384
    s_add_u32 s30, s22, 77824
    buffer_load_dwordx4 v1, s[8:11], s30 offen offset:0 lds
    buffer_load_dwordx4 v1, s[8:11], s30 offen offset:1024 lds
    buffer_load_dwordx4 v1, s[8:11], s30 offen offset:2048 lds
    buffer_load_dwordx4 v1, s[8:11], s30 offen offset:3072 lds
    s_waitcnt vmcnt(0)
    v_mov_b32 v5, 3
    ds_write_b32 v4, v5
    v_mov_b32 v6, 143428
    s_mov_b32 s31, 1048576
L_free_4_loop:
    ds_read_b32 v7, v6
    s_waitcnt lgkmcnt(0)
    v_readfirstlane_b32 s30, v7
    s_sub_u32 s31, s31, 1
    s_cbranch_scc1 L_free_4_done
    s_cmp_ge_u32 s30, 8
    s_cbranch_scc1 L_free_4_done
    s_sleep 6
    s_branch L_free_4_loop
L_free_4_done:
    s_mov_b32 m0, 20480
    s_add_u32 s30, s22, 81920
    buffer_load_dwordx4 v1, s[8:11], s30 offen offset:0 lds
    buffer_load_dwordx4 v1, s[8:11], s30 offen offset:1024 lds
    buffer_load_dwordx4 v1, s[8:11], s30 offen offset:2048 lds
    buffer_load_dwordx4 v1, s[8:11], s30 offen offset:3072 lds
    s_mov_b32 m0, 24576
    s_add_u32 s30, s22, 86016
    buffer_load_dwordx4 v1, s[8:11], s30 offen offset:0 lds
    buffer_load_dwordx4 v1, s[8:11], s30 offen offset:1024 lds
    buffer_load_dwordx4 v1, s[8:11], s30 offen offset:2048 lds
    buffer_load_dwordx4 v1, s[8:11], s30 offen offset:3072 lds
    s_mov_b32 m0, 28672
    s_add_u32 s30, s22, 90112
    buffer_load_dwordx4 v1, s[8:11], s30 offen offset:0 lds
    buffer_load_dwordx4 v1, s[8:11], s30 offen offset:1024 lds
    buffer_load_dwordx4 v1, s[8:11], s30 offen offset:2048 lds
    buffer_load_dwordx4 v1, s[8:11], s30 offen offset:3072 lds
    s_mov_b32 m0, 32768
    s_add_u32 s30, s22, 94208
    buffer_load_dwordx4 v1, s[8:11], s30 offen offset:0 lds
    buffer_load_dwordx4 v1, s[8:11], s30 offen offset:1024 lds
    buffer_load_dwordx4 v1, s[8:11], s30 offen offset:2048 lds
    buffer_load_dwordx4 v1, s[8:11], s30 offen offset:3072 lds
    s_mov_b32 m0, 36864
    s_add_u32 s30, s22, 98304
    buffer_load_dwordx4 v1, s[8:11], s30 offen offset:0 lds
    buffer_load_dwordx4 v1, s[8:11], s30 offen offset:1024 lds
    buffer_load_dwordx4 v1, s[8:11], s30 offen offset:2048 lds
    buffer_load_dwordx4 v1, s[8:11], s30 offen offset:3072 lds
    s_waitcnt vmcnt(0)
    v_mov_b32 v5, 4
    ds_write_b32 v4, v5
    v_mov_b32 v6, 143432
    s_mov_b32 s31, 1048576
L_free_5_loop:
    ds_read_b32 v7, v6
    s_waitcnt lgkmcnt(0)
    v_readfirstlane_b32 s30, v7
    s_sub_u32 s31, s31, 1
    s_cbranch_scc1 L_free_5_done
    s_cmp_ge_u32 s30, 8
    s_cbranch_scc1 L_free_5_done
    s_sleep 6
    s_branch L_free_5_loop
L_free_5_done:
    s_mov_b32 m0, 40960
    s_add_u32 s30, s22, 102400
    buffer_load_dwordx4 v1, s[8:11], s30 offen offset:0 lds
    buffer_load_dwordx4 v1, s[8:11], s30 offen offset:1024 lds
    buffer_load_dwordx4 v1, s[8:11], s30 offen offset:2048 lds
    buffer_load_dwordx4 v1, s[8:11], s30 offen offset:3072 lds
    s_mov_b32 m0, 45056
    s_add_u32 s30, s22, 106496
    buffer_load_dwordx4 v1, s[8:11], s30 offen offset:0 lds
    buffer_load_dwordx4 v1, s[8:11], s30 offen offset:1024 lds
    buffer_load_dwordx4 v1, s[8:11], s30 offen offset:2048 lds
    buffer_load_dwordx4 v1, s[8:11], s30 offen offset:3072 lds
    s_mov_b32 m0, 49152
    s_add_u32 s30, s22, 110592
    buffer_load_dwordx4 v1, s[8:11], s30 offen offset:0 lds
    buffer_load_dwordx4 v1, s[8:11], s30 offen offset:1024 lds
    buffer_load_dwordx4 v1, s[8:11], s30 offen offset:2048 lds
    buffer_load_dwordx4 v1, s[8:11], s30 offen offset:3072 lds
    s_mov_b32 m0, 53248
    s_add_u32 s30, s22, 114688
    buffer_load_dwordx4 v1, s[8:11], s30 offen offset:0 lds
    buffer_load_dwordx4 v1, s[8:11], s30 offen offset:1024 lds
    buffer_load_dwordx4 v1, s[8:11], s30 offen offset:2048 lds
    buffer_load_dwordx4 v1, s[8:11], s30 offen offset:3072 lds
    s_mov_b32 m0, 57344
    s_add_u32 s30, s22, 118784
    buffer_load_dwordx4 v1, s[8:11], s30 offen offset:0 lds
    buffer_load_dwordx4 v1, s[8:11], s30 offen offset:1024 lds
    buffer_load_dwordx4 v1, s[8:11], s30 offen offset:2048 lds
    buffer_load_dwordx4 v1, s[8:11], s30 offen offset:3072 lds
    s_waitcnt vmcnt(0)
    v_mov_b32 v5, 5
    ds_write_b32 v4, v5
    v_mov_b32 v6, 143436
    s_mov_b32 s31, 1048576
L_free_6_loop:
    ds_read_b32 v7, v6
    s_waitcnt lgkmcnt(0)
    v_readfirstlane_b32 s30, v7
    s_sub_u32 s31, s31, 1
    s_cbranch_scc1 L_free_6_done
    s_cmp_ge_u32 s30, 8
    s_cbranch_scc1 L_free_6_done
    s_sleep 6
    s_branch L_free_6_loop
L_free_6_done:
    s_mov_b32 m0, 0
    s_add_u32 s30, s22, 122880
    buffer_load_dwordx4 v1, s[8:11], s30 offen offset:0 lds
    buffer_load_dwordx4 v1, s[8:11], s30 offen offset:1024 lds
    buffer_load_dwordx4 v1, s[8:11], s30 offen offset:2048 lds
    buffer_load_dwordx4 v1, s[8:11], s30 offen offset:3072 lds
    s_mov_b32 m0, 4096
    s_add_u32 s30, s22, 126976
    buffer_load_dwordx4 v1, s[8:11], s30 offen offset:0 lds
    buffer_load_dwordx4 v1, s[8:11], s30 offen offset:1024 lds
    buffer_load_dwordx4 v1, s[8:11], s30 offen offset:2048 lds
    buffer_load_dwordx4 v1, s[8:11], s30 offen offset:3072 lds
    s_mov_b32 m0, 8192
    s_add_u32 s30, s22, 131072
    buffer_load_dwordx4 v1, s[8:11], s30 offen offset:0 lds
    buffer_load_dwordx4 v1, s[8:11], s30 offen offset:1024 lds
    buffer_load_dwordx4 v1, s[8:11], s30 offen offset:2048 lds
    buffer_load_dwordx4 v1, s[8:11], s30 offen offset:3072 lds
    s_mov_b32 m0, 12288
    s_add_u32 s30, s22, 135168
    buffer_load_dwordx4 v1, s[8:11], s30 offen offset:0 lds
    buffer_load_dwordx4 v1, s[8:11], s30 offen offset:1024 lds
    buffer_load_dwordx4 v1, s[8:11], s30 offen offset:2048 lds
    buffer_load_dwordx4 v1, s[8:11], s30 offen offset:3072 lds
    s_mov_b32 m0, 16384
    s_add_u32 s30, s22, 139264
    buffer_load_dwordx4 v1, s[8:11], s30 offen offset:0 lds
    buffer_load_dwordx4 v1, s[8:11], s30 offen offset:1024 lds
    buffer_load_dwordx4 v1, s[8:11], s30 offen offset:2048 lds
    buffer_load_dwordx4 v1, s[8:11], s30 offen offset:3072 lds
    s_waitcnt vmcnt(0)
    v_mov_b32 v5, 6
    ds_write_b32 v4, v5
    v_mov_b32 v6, 143440
    s_mov_b32 s31, 1048576
L_free_7_loop:
    ds_read_b32 v7, v6
    s_waitcnt lgkmcnt(0)
    v_readfirstlane_b32 s30, v7
    s_sub_u32 s31, s31, 1
    s_cbranch_scc1 L_free_7_done
    s_cmp_ge_u32 s30, 8
    s_cbranch_scc1 L_free_7_done
    s_sleep 6
    s_branch L_free_7_loop
L_free_7_done:
    s_mov_b32 m0, 20480
    s_add_u32 s30, s22, 143360
    buffer_load_dwordx4 v1, s[8:11], s30 offen offset:0 lds
    buffer_load_dwordx4 v1, s[8:11], s30 offen offset:1024 lds
    buffer_load_dwordx4 v1, s[8:11], s30 offen offset:2048 lds
    buffer_load_dwordx4 v1, s[8:11], s30 offen offset:3072 lds
    s_mov_b32 m0, 24576
    s_add_u32 s30, s22, 147456
    buffer_load_dwordx4 v1, s[8:11], s30 offen offset:0 lds
    buffer_load_dwordx4 v1, s[8:11], s30 offen offset:1024 lds
    buffer_load_dwordx4 v1, s[8:11], s30 offen offset:2048 lds
    buffer_load_dwordx4 v1, s[8:11], s30 offen offset:3072 lds
    s_mov_b32 m0, 28672
    s_add_u32 s30, s22, 151552
    buffer_load_dwordx4 v1, s[8:11], s30 offen offset:0 lds
    buffer_load_dwordx4 v1, s[8:11], s30 offen offset:1024 lds
    buffer_load_dwordx4 v1, s[8:11], s30 offen offset:2048 lds
    buffer_load_dwordx4 v1, s[8:11], s30 offen offset:3072 lds
    s_mov_b32 m0, 32768
    s_add_u32 s30, s22, 155648
    buffer_load_dwordx4 v1, s[8:11], s30 offen offset:0 lds
    buffer_load_dwordx4 v1, s[8:11], s30 offen offset:1024 lds
    buffer_load_dwordx4 v1, s[8:11], s30 offen offset:2048 lds
    buffer_load_dwordx4 v1, s[8:11], s30 offen offset:3072 lds
    s_mov_b32 m0, 36864
    s_add_u32 s30, s22, 159744
    buffer_load_dwordx4 v1, s[8:11], s30 offen offset:0 lds
    buffer_load_dwordx4 v1, s[8:11], s30 offen offset:1024 lds
    buffer_load_dwordx4 v1, s[8:11], s30 offen offset:2048 lds
    buffer_load_dwordx4 v1, s[8:11], s30 offen offset:3072 lds
    s_waitcnt vmcnt(0)
    v_mov_b32 v5, 7
    ds_write_b32 v4, v5
    s_add_u32 s38, s4, 10510336
    s_addc_u32 s39, s5, 0
    s_load_dwordx16 s[64:79], s[38:39], 0
    s_load_dwordx16 s[80:95], s[38:39], 64
    s_bfe_u32 s44, s2, 0x20001
    s_lshl_b32 s12, s32, 2
    s_add_u32 s44, s44, s12
    s_and_b32 s45, s2, 1
    s_lshl_b32 s45, s45, 2
    s_bfe_u32 s12, s2, 0x20003
    s_add_u32 s45, s45, s12
    s_waitcnt lgkmcnt(0)
    s_max_u32 s42, s64, s65
    s_min_u32 s43, s64, s65
    s_min_u32 s12, s42, s66
    s_max_u32 s43, s43, s12
    s_max_u32 s42, s42, s66
    s_min_u32 s12, s42, s67
    s_max_u32 s43, s43, s12
    s_max_u32 s42, s42, s67
    s_min_u32 s12, s42, s68
    s_max_u32 s43, s43, s12
    s_max_u32 s42, s42, s68
    s_min_u32 s12, s42, s69
    s_max_u32 s43, s43, s12
    s_max_u32 s42, s42, s69
    s_min_u32 s12, s42, s70
    s_max_u32 s43, s43, s12
    s_max_u32 s42, s42, s70
    s_min_u32 s12, s42, s71
    s_max_u32 s43, s43, s12
    s_max_u32 s42, s42, s71
    s_min_u32 s12, s42, s72
    s_max_u32 s43, s43, s12
    s_max_u32 s42, s42, s72
    s_min_u32 s12, s42, s73
    s_max_u32 s43, s43, s12
    s_max_u32 s42, s42, s73
    s_min_u32 s12, s42, s74
    s_max_u32 s43, s43, s12
    s_max_u32 s42, s42, s74
    s_min_u32 s12, s42, s75
    s_max_u32 s43, s43, s12
    s_max_u32 s42, s42, s75
    s_min_u32 s12, s42, s76
    s_max_u32 s43, s43, s12
    s_max_u32 s42, s42, s76
    s_min_u32 s12, s42, s77
    s_max_u32 s43, s43, s12
    s_max_u32 s42, s42, s77
    s_min_u32 s12, s42, s78
    s_max_u32 s43, s43, s12
    s_max_u32 s42, s42, s78
    s_min_u32 s12, s42, s79
    s_max_u32 s43, s43, s12
    s_max_u32 s42, s42, s79
    s_min_u32 s12, s42, s80
    s_max_u32 s43, s43, s12
    s_max_u32 s42, s42, s80
    s_min_u32 s12, s42, s81
    s_max_u32 s43, s43, s12
    s_max_u32 s42, s42, s81
    s_min_u32 s12, s42, s82
    s_max_u32 s43, s43, s12
    s_max_u32 s42, s42, s82
    s_min_u32 s12, s42, s83
    s_max_u32 s43, s43, s12
    s_max_u32 s42, s42, s83
    s_min_u32 s12, s42, s84
    s_max_u32 s43, s43, s12
    s_max_u32 s42, s42, s84
    s_min_u32 s12, s42, s85
    s_max_u32 s43, s43, s12
    s_max_u32 s42, s42, s85
    s_min_u32 s12, s42, s86
    s_max_u32 s43, s43, s12
    s_max_u32 s42, s42, s86
    s_min_u32 s12, s42, s87
    s_max_u32 s43, s43, s12
    s_max_u32 s42, s42, s87
    s_min_u32 s12, s42, s88
    s_max_u32 s43, s43, s12
    s_max_u32 s42, s42, s88
    s_min_u32 s12, s42, s89
    s_max_u32 s43, s43, s12
    s_max_u32 s42, s42, s89
    s_min_u32 s12, s42, s90
    s_max_u32 s43, s43, s12
    s_max_u32 s42, s42, s90
    s_min_u32 s12, s42, s91
    s_max_u32 s43, s43, s12
    s_max_u32 s42, s42, s91
    s_min_u32 s12, s42, s92
    s_max_u32 s43, s43, s12
    s_max_u32 s42, s42, s92
    s_min_u32 s12, s42, s93
    s_max_u32 s43, s43, s12
    s_max_u32 s42, s42, s93
    s_min_u32 s12, s42, s94
    s_max_u32 s43, s43, s12
    s_max_u32 s42, s42, s94
    s_min_u32 s12, s42, s95
    s_max_u32 s43, s43, s12
    s_max_u32 s42, s42, s95
    s_bfe_u32 s12, s42, 0x50006
    s_bfe_u32 s13, s43, 0x50006
    s_cmp_eq_u32 s12, s44
    s_cbranch_scc1 L_k2_watch
    s_cmp_eq_u32 s13, s44
    s_cbranch_scc0 L_k2_join
L_k2_watch:
    v_mov_b32 v7, 11823360
    s_mov_b32 s13, 1048576
L_k2_poll_moe:
    global_load_dword v6, v7, s[4:5] sc1
    s_waitcnt vmcnt(0)
    v_readfirstlane_b32 s14, v6
    s_sub_u32 s13, s13, 1
    s_cbranch_scc1 L_k2_poll_moe_done
    s_cmp_ge_u32 s14, 96
    s_cbranch_scc1 L_k2_poll_moe_done
    s_sleep 8
    s_branch L_k2_poll_moe
L_k2_poll_moe_done:
    v_mov_b32 v6, 143380
    v_mov_b32 v7, 1
    ds_write_b32 v6, v7
    s_waitcnt lgkmcnt(0)
    s_branch L_k2_join
L_k2_ffn:
    s_barrier
    s_load_dwordx2 s[6:7], s[0:1], 0
    s_load_dwordx4 s[36:39], s[0:1], 40
    s_load_dwordx2 s[40:41], s[0:1], 56
    s_waitcnt lgkmcnt(0)
    s_mov_b32 s8, s4
    s_and_b32 s9, s5, 0xffff
    s_mov_b32 s10, 11993088
    s_mov_b32 s11, 0x00020000
    s_cmp_ge_u32 s2, 96
    s_cbranch_scc1 L_k2_no_ffn
    s_and_b32 s33, s2, 7
    s_mul_i32 s33, s33, 12
    s_lshr_b32 s12, s2, 3
    s_add_u32 s33, s33, s12
    s_cmp_eq_u32 s20, 11
    s_cbranch_scc1 L_k2_down
    s_sub_u32 s44, s20, 9
    s_mov_b32 s56, s6
    s_and_b32 s57, s7, 0xffff
    s_mov_b32 s58, 2621440
    s_mov_b32 s59, 0x00020000
    s_add_u32 s46, s4, 10510336
    s_addc_u32 s47, s5, 0
    s_load_dwordx16 s[64:79], s[46:47], 0
    s_load_dwordx16 s[80:95], s[46:47], 64
    s_cmp_eq_u32 s44, 0
    s_cbranch_scc0 L_k2_up_srd
    s_mov_b32 s60, s36
    s_and_b32 s61, s37, 0xffff
    s_mov_b32 s62, 1966080
    s_mov_b32 s63, 0x00020000
    s_branch L_k2_srd_done
L_k2_up_srd:
    s_mov_b32 s60, s38
    s_and_b32 s61, s39, 0xffff
    s_mov_b32 s62, 1966080
    s_mov_b32 s63, 0x00020000
L_k2_srd_done:
    v_lshrrev_b32 v4, 3, v3
    v_mul_u32_u24 v5, 3072, v4
    v_and_b32 v7, 7, v3
    v_xor_b32 v7, v7, v4
    v_lshl_add_u32 v5, v7, 4, v5
    s_and_b32 s17, s33, 3
    s_mul_i32 s15, s17, 491520
    s_lshr_b32 s16, s33, 2
    s_lshl_b32 s16, s16, 7
    s_add_u32 s15, s15, s16
    s_mul_i32 s14, s44, 20480
    s_add_u32 s14, s14, 61440
    v_lshrrev_b32 v4, 4, v3
    v_bfe_u32 v7, v3, 2, 2
    v_lshl_add_u32 v8, v4, 3, v7
    v_lshlrev_b32 v8, 7, v8
    v_bfe_u32 v9, v3, 1, 1
    v_xor_b32 v9, v9, v7
    v_lshl_add_u32 v8, v9, 4, v8
    v_and_b32 v9, 1, v3
    v_lshl_add_u32 v8, v9, 3, v8
    v_add_u32 v56, s14, v8
    v_xor_b32 v57, 32, v56
    v_xor_b32 v58, 64, v56
    v_xor_b32 v59, 96, v56
    s_mul_i32 s18, s44, 1024
    s_add_u32 s18, s18, 122880
    v_and_b32 v9, 3, v3
    v_min_u32 v6, 2, v9
    v_mul_u32_u24 v6, 320, v6
    v_lshl_add_u32 v6, v4, 4, v6
    v_add_u32 v6, s18, v6
    v_mov_b32 v8, 0x3f803f80
    v_mov_b32 v9, 0x3f803f80
    v_mov_b32 v10, 0x3f803f80
    v_mov_b32 v11, 0x3f803f80
    v_add_u32 v60, s18, v1
    s_mov_b64 exec, 0xfffff
    ds_write_b128 v60, v[8:11] offset:640
    s_mov_b64 exec, -1
    v_and_b32 v7, 15, v3
    v_lshlrev_b32 v61, 8, v7
    v_lshl_add_u32 v61, v4, 4, v61
    v_cmp_gt_u32 vcc, 3, v7
    v_min_u32 v62, 2, v4
    v_lshlrev_b32 v62, 8, v62
    v_lshl_add_u32 v62, v7, 2, v62
    s_mov_b64 s[52:53], vcc
    s_add_u32 m0, s14, 0
    s_add_u32 s16, s15, 0
    buffer_load_dwordx4 v5, s[60:63], s16 offen lds
    s_add_u32 m0, s14, 1024
    s_add_u32 s16, s15, 24576
    buffer_load_dwordx4 v5, s[60:63], s16 offen lds
    s_add_u32 m0, s14, 2048
    s_add_u32 s16, s15, 49152
    buffer_load_dwordx4 v5, s[60:63], s16 offen lds
    s_add_u32 m0, s14, 3072
    s_add_u32 s16, s15, 73728
    buffer_load_dwordx4 v5, s[60:63], s16 offen lds
    s_add_u32 m0, s14, 4096
    s_add_u32 s16, s15, 98304
    buffer_load_dwordx4 v5, s[60:63], s16 offen lds
    s_add_u32 m0, s14, 5120
    s_add_u32 s16, s15, 122880
    buffer_load_dwordx4 v5, s[60:63], s16 offen lds
    s_add_u32 m0, s14, 6144
    s_add_u32 s16, s15, 147456
    buffer_load_dwordx4 v5, s[60:63], s16 offen lds
    s_add_u32 m0, s14, 7168
    s_add_u32 s16, s15, 172032
    buffer_load_dwordx4 v5, s[60:63], s16 offen lds
    s_add_u32 m0, s14, 8192
    s_add_u32 s16, s15, 196608
    buffer_load_dwordx4 v5, s[60:63], s16 offen lds
    s_add_u32 m0, s14, 9216
    s_add_u32 s16, s15, 221184
    buffer_load_dwordx4 v5, s[60:63], s16 offen lds
    s_add_u32 m0, s14, 10240
    s_add_u32 s16, s15, 245760
    buffer_load_dwordx4 v5, s[60:63], s16 offen lds
    s_add_u32 m0, s14, 11264
    s_add_u32 s16, s15, 270336
    buffer_load_dwordx4 v5, s[60:63], s16 offen lds
    s_add_u32 m0, s14, 12288
    s_add_u32 s16, s15, 294912
    buffer_load_dwordx4 v5, s[60:63], s16 offen lds
    s_add_u32 m0, s14, 13312
    s_add_u32 s16, s15, 319488
    buffer_load_dwordx4 v5, s[60:63], s16 offen lds
    s_add_u32 m0, s14, 14336
    s_add_u32 s16, s15, 344064
    buffer_load_dwordx4 v5, s[60:63], s16 offen lds
    s_add_u32 m0, s14, 15360
    s_add_u32 s16, s15, 368640
    buffer_load_dwordx4 v5, s[60:63], s16 offen lds
    s_add_u32 m0, s14, 16384
    s_add_u32 s16, s15, 393216
    buffer_load_dwordx4 v5, s[60:63], s16 offen lds
    s_add_u32 m0, s14, 17408
    s_add_u32 s16, s15, 417792
    buffer_load_dwordx4 v5, s[60:63], s16 offen lds
    s_add_u32 m0, s14, 18432
    s_add_u32 s16, s15, 442368
    buffer_load_dwordx4 v5, s[60:63], s16 offen lds
    s_add_u32 m0, s14, 19456
    s_add_u32 s16, s15, 466944
    buffer_load_dwordx4 v5, s[60:63], s16 offen lds
    s_waitcnt lgkmcnt(0)
    s_max_u32 s42, s64, s65
    s_min_u32 s43, s64, s65
    s_min_u32 s12, s42, s66
    s_max_u32 s43, s43, s12
    s_max_u32 s42, s42, s66
    s_min_u32 s12, s42, s67
    s_max_u32 s43, s43, s12
    s_max_u32 s42, s42, s67
    s_min_u32 s12, s42, s68
    s_max_u32 s43, s43, s12
    s_max_u32 s42, s42, s68
    s_min_u32 s12, s42, s69
    s_max_u32 s43, s43, s12
    s_max_u32 s42, s42, s69
    s_min_u32 s12, s42, s70
    s_max_u32 s43, s43, s12
    s_max_u32 s42, s42, s70
    s_min_u32 s12, s42, s71
    s_max_u32 s43, s43, s12
    s_max_u32 s42, s42, s71
    s_min_u32 s12, s42, s72
    s_max_u32 s43, s43, s12
    s_max_u32 s42, s42, s72
    s_min_u32 s12, s42, s73
    s_max_u32 s43, s43, s12
    s_max_u32 s42, s42, s73
    s_min_u32 s12, s42, s74
    s_max_u32 s43, s43, s12
    s_max_u32 s42, s42, s74
    s_min_u32 s12, s42, s75
    s_max_u32 s43, s43, s12
    s_max_u32 s42, s42, s75
    s_min_u32 s12, s42, s76
    s_max_u32 s43, s43, s12
    s_max_u32 s42, s42, s76
    s_min_u32 s12, s42, s77
    s_max_u32 s43, s43, s12
    s_max_u32 s42, s42, s77
    s_min_u32 s12, s42, s78
    s_max_u32 s43, s43, s12
    s_max_u32 s42, s42, s78
    s_min_u32 s12, s42, s79
    s_max_u32 s43, s43, s12
    s_max_u32 s42, s42, s79
    s_min_u32 s12, s42, s80
    s_max_u32 s43, s43, s12
    s_max_u32 s42, s42, s80
    s_min_u32 s12, s42, s81
    s_max_u32 s43, s43, s12
    s_max_u32 s42, s42, s81
    s_min_u32 s12, s42, s82
    s_max_u32 s43, s43, s12
    s_max_u32 s42, s42, s82
    s_min_u32 s12, s42, s83
    s_max_u32 s43, s43, s12
    s_max_u32 s42, s42, s83
    s_min_u32 s12, s42, s84
    s_max_u32 s43, s43, s12
    s_max_u32 s42, s42, s84
    s_min_u32 s12, s42, s85
    s_max_u32 s43, s43, s12
    s_max_u32 s42, s42, s85
    s_min_u32 s12, s42, s86
    s_max_u32 s43, s43, s12
    s_max_u32 s42, s42, s86
    s_min_u32 s12, s42, s87
    s_max_u32 s43, s43, s12
    s_max_u32 s42, s42, s87
    s_min_u32 s12, s42, s88
    s_max_u32 s43, s43, s12
    s_max_u32 s42, s42, s88
    s_min_u32 s12, s42, s89
    s_max_u32 s43, s43, s12
    s_max_u32 s42, s42, s89
    s_min_u32 s12, s42, s90
    s_max_u32 s43, s43, s12
    s_max_u32 s42, s42, s90
    s_min_u32 s12, s42, s91
    s_max_u32 s43, s43, s12
    s_max_u32 s42, s42, s91
    s_min_u32 s12, s42, s92
    s_max_u32 s43, s43, s12
    s_max_u32 s42, s42, s92
    s_min_u32 s12, s42, s93
    s_max_u32 s43, s43, s12
    s_max_u32 s42, s42, s93
    s_min_u32 s12, s42, s94
    s_max_u32 s43, s43, s12
    s_max_u32 s42, s42, s94
    s_min_u32 s12, s42, s95
    s_max_u32 s43, s43, s12
    s_max_u32 s42, s42, s95
    s_and_b32 s42, s42, 0x7ff
    s_and_b32 s43, s43, 0x7ff
    s_lshl_b32 s12, s42, 3
    s_add_u32 s46, s4, s12
    s_addc_u32 s47, s5, 0
    s_add_u32 s46, s46, 10485760
    s_addc_u32 s47, s47, 0
    s_load_dwordx2 s[48:49], s[46:47], 0
    s_lshl_b32 s12, s43, 3
    s_add_u32 s46, s4, s12
    s_addc_u32 s47, s5, 0
    s_add_u32 s46, s46, 10485760
    s_addc_u32 s47, s47, 0
    s_load_dwordx2 s[50:51], s[46:47], 0
    s_mul_i32 s16, s17, 320
    s_mov_b64 exec, 0xfffff
    s_mul_i32 s12, s42, 1280
    s_add_u32 s12, s12, s16
    s_add_u32 m0, s18, 0
    s_nop 0
    buffer_load_dwordx4 v1, s[56:59], s12 offen lds
    s_mul_i32 s12, s43, 1280
    s_add_u32 s12, s12, s16
    s_add_u32 m0, s18, 320
    s_nop 0
    buffer_load_dwordx4 v1, s[56:59], s12 offen lds
    s_mov_b64 exec, -1
    s_waitcnt vmcnt(0) lgkmcnt(0)
    ds_read_b128 v[12:15], v6 offset:0
    ds_read_b64_tr_b16 v[16:17], v56 offset:0
    ds_read_b64_tr_b16 v[18:19], v58 offset:512
    ds_read_b64_tr_b16 v[20:21], v57 offset:0
    ds_read_b64_tr_b16 v[22:23], v59 offset:512
    ds_read_b64_tr_b16 v[24:25], v58 offset:0
    ds_read_b64_tr_b16 v[26:27], v56 offset:512
    ds_read_b64_tr_b16 v[28:29], v59 offset:0
    ds_read_b64_tr_b16 v[30:31], v57 offset:512
    s_waitcnt lgkmcnt(6)
    v_mfma_f32_16x16x32_bf16 v[64:67], v[16:19], v[12:15], 0
    s_waitcnt lgkmcnt(4)
    v_mfma_f32_16x16x32_bf16 v[68:71], v[20:23], v[12:15], 0
    s_waitcnt lgkmcnt(2)
    v_mfma_f32_16x16x32_bf16 v[72:75], v[24:27], v[12:15], 0
    s_waitcnt lgkmcnt(0)
    v_mfma_f32_16x16x32_bf16 v[76:79], v[28:31], v[12:15], 0
    ds_read_b128 v[12:15], v6 offset:64
    ds_read_b64_tr_b16 v[16:17], v56 offset:4096
    ds_read_b64_tr_b16 v[18:19], v58 offset:4608
    ds_read_b64_tr_b16 v[20:21], v57 offset:4096
    ds_read_b64_tr_b16 v[22:23], v59 offset:4608
    ds_read_b64_tr_b16 v[24:25], v58 offset:4096
    ds_read_b64_tr_b16 v[26:27], v56 offset:4608
    ds_read_b64_tr_b16 v[28:29], v59 offset:4096
    ds_read_b64_tr_b16 v[30:31], v57 offset:4608
    s_waitcnt lgkmcnt(6)
    v_mfma_f32_16x16x32_bf16 v[64:67], v[16:19], v[12:15], v[64:67]
    s_waitcnt lgkmcnt(4)
    v_mfma_f32_16x16x32_bf16 v[68:71], v[20:23], v[12:15], v[68:71]
    s_waitcnt lgkmcnt(2)
    v_mfma_f32_16x16x32_bf16 v[72:75], v[24:27], v[12:15], v[72:75]
    s_waitcnt lgkmcnt(0)
    v_mfma_f32_16x16x32_bf16 v[76:79], v[28:31], v[12:15], v[76:79]
    ds_read_b128 v[12:15], v6 offset:128
    ds_read_b64_tr_b16 v[16:17], v56 offset:8192
    ds_read_b64_tr_b16 v[18:19], v58 offset:8704
    ds_read_b64_tr_b16 v[20:21], v57 offset:8192
    ds_read_b64_tr_b16 v[22:23], v59 offset:8704
    ds_read_b64_tr_b16 v[24:25], v58 offset:8192
    ds_read_b64_tr_b16 v[26:27], v56 offset:8704
    ds_read_b64_tr_b16 v[28:29], v59 offset:8192
    ds_read_b64_tr_b16 v[30:31], v57 offset:8704
    s_waitcnt lgkmcnt(6)
    v_mfma_f32_16x16x32_bf16 v[64:67], v[16:19], v[12:15], v[64:67]
    s_waitcnt lgkmcnt(4)
    v_mfma_f32_16x16x32_bf16 v[68:71], v[20:23], v[12:15], v[68:71]
    s_waitcnt lgkmcnt(2)
    v_mfma_f32_16x16x32_bf16 v[72:75], v[24:27], v[12:15], v[72:75]
    s_waitcnt lgkmcnt(0)
    v_mfma_f32_16x16x32_bf16 v[76:79], v[28:31], v[12:15], v[76:79]
    ds_read_b128 v[12:15], v6 offset:192
    ds_read_b64_tr_b16 v[16:17], v56 offset:12288
    ds_read_b64_tr_b16 v[18:19], v58 offset:12800
    ds_read_b64_tr_b16 v[20:21], v57 offset:12288
    ds_read_b64_tr_b16 v[22:23], v59 offset:12800
    ds_read_b64_tr_b16 v[24:25], v58 offset:12288
    ds_read_b64_tr_b16 v[26:27], v56 offset:12800
    ds_read_b64_tr_b16 v[28:29], v59 offset:12288
    ds_read_b64_tr_b16 v[30:31], v57 offset:12800
    s_waitcnt lgkmcnt(6)
    v_mfma_f32_16x16x32_bf16 v[64:67], v[16:19], v[12:15], v[64:67]
    s_waitcnt lgkmcnt(4)
    v_mfma_f32_16x16x32_bf16 v[68:71], v[20:23], v[12:15], v[68:71]
    s_waitcnt lgkmcnt(2)
    v_mfma_f32_16x16x32_bf16 v[72:75], v[24:27], v[12:15], v[72:75]
    s_waitcnt lgkmcnt(0)
    v_mfma_f32_16x16x32_bf16 v[76:79], v[28:31], v[12:15], v[76:79]
    ds_read_b128 v[12:15], v6 offset:256
    ds_read_b64_tr_b16 v[16:17], v56 offset:16384
    ds_read_b64_tr_b16 v[18:19], v58 offset:16896
    ds_read_b64_tr_b16 v[20:21], v57 offset:16384
    ds_read_b64_tr_b16 v[22:23], v59 offset:16896
    ds_read_b64_tr_b16 v[24:25], v58 offset:16384
    ds_read_b64_tr_b16 v[26:27], v56 offset:16896
    ds_read_b64_tr_b16 v[28:29], v59 offset:16384
    ds_read_b64_tr_b16 v[30:31], v57 offset:16896
    s_waitcnt lgkmcnt(6)
    v_mfma_f32_16x16x32_bf16 v[64:67], v[16:19], v[12:15], v[64:67]
    s_waitcnt lgkmcnt(4)
    v_mfma_f32_16x16x32_bf16 v[68:71], v[20:23], v[12:15], v[68:71]
    s_waitcnt lgkmcnt(2)
    v_mfma_f32_16x16x32_bf16 v[72:75], v[24:27], v[12:15], v[72:75]
    s_waitcnt lgkmcnt(0)
    v_mfma_f32_16x16x32_bf16 v[76:79], v[28:31], v[12:15], v[76:79]
    s_lshl_b32 s12, s33, 1
    s_add_u32 s12, s12, s44
    s_mul_i32 s12, s12, 768
    s_add_u32 s12, s12, 11829760
    s_nop 7
    s_mov_b64 exec, s[52:53]
    buffer_store_dwordx4 v[64:67], v61, s[8:11], s12 offen offset:0 sc1
    buffer_store_dwordx4 v[68:71], v61, s[8:11], s12 offen offset:64 sc1
    buffer_store_dwordx4 v[72:75], v61, s[8:11], s12 offen offset:128 sc1
    buffer_store_dwordx4 v[76:79], v61, s[8:11], s12 offen offset:192 sc1
    s_mov_b64 exec, -1
    v_mov_b32 v52, 1
    v_mov_b32 v53, 143368
    s_waitcnt vmcnt(0)
    s_cmp_eq_u32 s44, 0
    s_cbranch_scc1 L_k2_gate
    ds_write_b32 v53, v52
    s_branch L_k2_ffn_done
L_k2_gate:
    s_mov_b32 s13, 1048576
L_wait_u_loop:
    ds_read_b32 v54, v53
    s_waitcnt lgkmcnt(0)
    v_readfirstlane_b32 s12, v54
    s_sub_u32 s13, s13, 1
    s_cbranch_scc1 L_wait_u_done
    s_cmp_ge_u32 s12, 1
    s_cbranch_scc1 L_wait_u_done
    s_sleep 4
    s_branch L_wait_u_loop
L_wait_u_done:
    s_lshr_b32 s12, s33, 2
    s_add_u32 s12, s12, 9
    s_lshl_b32 s12, s12, 8
    s_add_u32 s12, s12, 11821312
    v_mov_b32 v9, s12
    s_mov_b64 exec, 1
    global_atomic_add v9, v52, s[4:5]
    s_mov_b32 s13, 1048576
L_k2_poll_cb:
    global_load_dword v10, v9, s[4:5] sc1
    s_waitcnt vmcnt(0)
    v_readfirstlane_b32 s14, v10
    s_sub_u32 s13, s13, 1
    s_cbranch_scc1 L_k2_poll_cb_done
    s_cmp_ge_u32 s14, 4
    s_cbranch_scc1 L_k2_poll_cb_done
    s_sleep 8
    s_branch L_k2_poll_cb
L_k2_poll_cb_done:
    s_mov_b64 exec, -1
    s_andn2_b32 s12, s33, 3
    s_mul_i32 s12, s12, 1536
    s_add_u32 s12, s12, 11829760
    s_lshl_b32 s16, s17, 6
    s_add_u32 s12, s12, s16
    s_add_u32 s16, s12, 0
    buffer_load_dword v12, v62, s[8:11], s16 offen sc1
    s_add_u32 s16, s12, 768
    buffer_load_dword v16, v62, s[8:11], s16 offen sc1
    s_add_u32 s16, s12, 1536
    buffer_load_dword v13, v62, s[8:11], s16 offen sc1
    s_add_u32 s16, s12, 2304
    buffer_load_dword v17, v62, s[8:11], s16 offen sc1
    s_add_u32 s16, s12, 3072
    buffer_load_dword v14, v62, s[8:11], s16 offen sc1
    s_add_u32 s16, s12, 3840
    buffer_load_dword v18, v62, s[8:11], s16 offen sc1
    s_add_u32 s16, s12, 4608
    buffer_load_dword v15, v62, s[8:11], s16 offen sc1
    s_add_u32 s16, s12, 5376
    buffer_load_dword v19, v62, s[8:11], s16 offen sc1
    v_cmp_gt_u32 vcc, 16, v3
    v_mov_b32 v8, s50
    v_mov_b32 v9, s51
    v_mov_b32 v10, s48
    v_mov_b32 v11, s49
    v_cndmask_b32 v8, v8, v10, vcc
    v_cndmask_b32 v9, v9, v11, vcc
    s_waitcnt vmcnt(0)
    v_add_f32 v12, v12, v13
    v_add_f32 v14, v14, v15
    v_add_f32 v16, v16, v17
    v_add_f32 v18, v18, v19
    v_add_f32 v12, v12, v14
    v_add_f32 v16, v16, v18
    v_mov_b32 v13, v12
    v_mov_b32 v14, v12
    v_mov_b32 v17, v16
    v_mov_b32 v18, v16
    s_nop 1
    v_permlane32_swap_b32 v13, v14
    v_permlane32_swap_b32 v17, v18
    s_nop 1
    v_fma_f32 v12, -v8, v14, v12
    v_mul_f32 v12, v12, v9
    v_fma_f32 v16, -v8, v18, v16
    v_mul_f32 v16, v16, v9
    v_mul_f32 v20, 0xbfb8aa3b, v12
    v_exp_f32 v20, v20
    v_mul_f32 v12, v12, v16
    v_add_f32 v20, 1.0, v20
    v_rcp_f32 v20, v20
    v_lshlrev_b32 v4, 1, v3
    v_mul_f32 v12, v12, v20
    v_add_u32 v4, 131584, v4
    v_cvt_pk_bf16_f32 v12, v12, v12
    ds_write_b16 v4, v12
    v_mov_b32 v53, 143372
    s_waitcnt lgkmcnt(0)
    ds_write_b32 v53, v52
    s_branch L_k2_ffn_done
L_k2_down:
    s_mov_b32 s60, s40
    s_and_b32 s61, s41, 0xffff
    s_mov_b32 s62, 1966080
    s_mov_b32 s63, 0x00020000
    v_bfe_u32 v4, v3, 2, 2
    v_mul_u32_u24 v5, 1280, v4
    v_lshrrev_b32 v4, 4, v3
    v_lshl_add_u32 v5, v4, 5, v5
    v_and_b32 v4, 3, v3
    v_lshl_add_u32 v5, v4, 3, v5
    v_add_u32 v5, 102400, v5
    v_and_b32 v4, 1, v3
    v_lshlrev_b32 v6, 5, v4
    v_add_u32 v6, 131584, v6
    v_lshlrev_b32 v7, 2, v3
    v_mov_b32 v53, 143372
    s_mul_i32 s15, s33, 20480
    s_mov_b32 m0, 102400
    s_add_u32 s16, s15, 0
    buffer_load_dwordx4 v1, s[60:63], s16 offen offset:0 lds
    buffer_load_dwordx4 v1, s[60:63], s16 offen offset:1024 lds
    buffer_load_dwordx4 v1, s[60:63], s16 offen offset:2048 lds
    buffer_load_dwordx4 v1, s[60:63], s16 offen offset:3072 lds
    s_mov_b32 m0, 106496
    s_add_u32 s16, s15, 4096
    buffer_load_dwordx4 v1, s[60:63], s16 offen offset:0 lds
    buffer_load_dwordx4 v1, s[60:63], s16 offen offset:1024 lds
    buffer_load_dwordx4 v1, s[60:63], s16 offen offset:2048 lds
    buffer_load_dwordx4 v1, s[60:63], s16 offen offset:3072 lds
    s_mov_b32 m0, 110592
    s_add_u32 s16, s15, 8192
    buffer_load_dwordx4 v1, s[60:63], s16 offen offset:0 lds
    buffer_load_dwordx4 v1, s[60:63], s16 offen offset:1024 lds
    buffer_load_dwordx4 v1, s[60:63], s16 offen offset:2048 lds
    buffer_load_dwordx4 v1, s[60:63], s16 offen offset:3072 lds
    s_mov_b32 m0, 114688
    s_add_u32 s16, s15, 12288
    buffer_load_dwordx4 v1, s[60:63], s16 offen offset:0 lds
    buffer_load_dwordx4 v1, s[60:63], s16 offen offset:1024 lds
    buffer_load_dwordx4 v1, s[60:63], s16 offen offset:2048 lds
    buffer_load_dwordx4 v1, s[60:63], s16 offen offset:3072 lds
    s_mov_b32 m0, 118784
    s_add_u32 s16, s15, 16384
    buffer_load_dwordx4 v1, s[60:63], s16 offen offset:0 lds
    buffer_load_dwordx4 v1, s[60:63], s16 offen offset:1024 lds
    buffer_load_dwordx4 v1, s[60:63], s16 offen offset:2048 lds
    buffer_load_dwordx4 v1, s[60:63], s16 offen offset:3072 lds
    s_mul_i32 s15, s33, 5120
    s_add_u32 s15, s15, 10510592
    s_waitcnt vmcnt(0)
    s_mov_b32 s13, 1048576
L_wait_h_loop:
    ds_read_b32 v54, v53
    s_waitcnt lgkmcnt(0)
    v_readfirstlane_b32 s12, v54
    s_sub_u32 s13, s13, 1
    s_cbranch_scc1 L_wait_h_done
    s_cmp_ge_u32 s12, 1
    s_cbranch_scc1 L_wait_h_done
    s_sleep 8
    s_branch L_wait_h_loop
L_wait_h_done:
    ds_read_b128 v[8:11], v6
    ds_read_b128 v[12:15], v6 offset:16
    ds_read_b64_tr_b16 v[16:17], v5 offset:0
    ds_read_b64_tr_b16 v[18:19], v5 offset:128
    ds_read_b64_tr_b16 v[20:21], v5 offset:256
    ds_read_b64_tr_b16 v[22:23], v5 offset:384
    ds_read_b64_tr_b16 v[24:25], v5 offset:512
    ds_read_b64_tr_b16 v[26:27], v5 offset:640
    ds_read_b64_tr_b16 v[28:29], v5 offset:768
    ds_read_b64_tr_b16 v[30:31], v5 offset:896
    ds_read_b64_tr_b16 v[32:33], v5 offset:1024
    ds_read_b64_tr_b16 v[34:35], v5 offset:1152
    s_waitcnt lgkmcnt(9)
    v_mfma_f32_4x4x4bf16_1k v[56:59], v[8:9], v[16:17], 0
    s_waitcnt lgkmcnt(8)
    v_mfma_f32_4x4x4bf16_1k v[60:63], v[8:9], v[18:19], 0
    s_waitcnt lgkmcnt(7)
    v_mfma_f32_4x4x4bf16_1k v[64:67], v[8:9], v[20:21], 0
    s_waitcnt lgkmcnt(6)
    v_mfma_f32_4x4x4bf16_1k v[68:71], v[8:9], v[22:23], 0
    s_waitcnt lgkmcnt(5)
    v_mfma_f32_4x4x4bf16_1k v[72:75], v[8:9], v[24:25], 0
    s_waitcnt lgkmcnt(4)
    v_mfma_f32_4x4x4bf16_1k v[76:79], v[8:9], v[26:27], 0
    s_waitcnt lgkmcnt(3)
    v_mfma_f32_4x4x4bf16_1k v[80:83], v[8:9], v[28:29], 0
    s_waitcnt lgkmcnt(2)
    v_mfma_f32_4x4x4bf16_1k v[84:87], v[8:9], v[30:31], 0
    s_waitcnt lgkmcnt(1)
    v_mfma_f32_4x4x4bf16_1k v[88:91], v[8:9], v[32:33], 0
    s_waitcnt lgkmcnt(0)
    v_mfma_f32_4x4x4bf16_1k v[92:95], v[8:9], v[34:35], 0
    ds_read_b64_tr_b16 v[16:17], v5 offset:5120
    ds_read_b64_tr_b16 v[18:19], v5 offset:5248
    ds_read_b64_tr_b16 v[20:21], v5 offset:5376
    ds_read_b64_tr_b16 v[22:23], v5 offset:5504
    ds_read_b64_tr_b16 v[24:25], v5 offset:5632
    ds_read_b64_tr_b16 v[26:27], v5 offset:5760
    ds_read_b64_tr_b16 v[28:29], v5 offset:5888
    ds_read_b64_tr_b16 v[30:31], v5 offset:6016
    ds_read_b64_tr_b16 v[32:33], v5 offset:6144
    ds_read_b64_tr_b16 v[34:35], v5 offset:6272
    s_waitcnt lgkmcnt(9)
    v_mfma_f32_4x4x4bf16_1k v[56:59], v[10:11], v[16:17], v[56:59]
    s_waitcnt lgkmcnt(8)
    v_mfma_f32_4x4x4bf16_1k v[60:63], v[10:11], v[18:19], v[60:63]
    s_waitcnt lgkmcnt(7)
    v_mfma_f32_4x4x4bf16_1k v[64:67], v[10:11], v[20:21], v[64:67]
    s_waitcnt lgkmcnt(6)
    v_mfma_f32_4x4x4bf16_1k v[68:71], v[10:11], v[22:23], v[68:71]
    s_waitcnt lgkmcnt(5)
    v_mfma_f32_4x4x4bf16_1k v[72:75], v[10:11], v[24:25], v[72:75]
    s_waitcnt lgkmcnt(4)
    v_mfma_f32_4x4x4bf16_1k v[76:79], v[10:11], v[26:27], v[76:79]
    s_waitcnt lgkmcnt(3)
    v_mfma_f32_4x4x4bf16_1k v[80:83], v[10:11], v[28:29], v[80:83]
    s_waitcnt lgkmcnt(2)
    v_mfma_f32_4x4x4bf16_1k v[84:87], v[10:11], v[30:31], v[84:87]
    s_waitcnt lgkmcnt(1)
    v_mfma_f32_4x4x4bf16_1k v[88:91], v[10:11], v[32:33], v[88:91]
    s_waitcnt lgkmcnt(0)
    v_mfma_f32_4x4x4bf16_1k v[92:95], v[10:11], v[34:35], v[92:95]
    ds_read_b64_tr_b16 v[16:17], v5 offset:10240
    ds_read_b64_tr_b16 v[18:19], v5 offset:10368
    ds_read_b64_tr_b16 v[20:21], v5 offset:10496
    ds_read_b64_tr_b16 v[22:23], v5 offset:10624
    ds_read_b64_tr_b16 v[24:25], v5 offset:10752
    ds_read_b64_tr_b16 v[26:27], v5 offset:10880
    ds_read_b64_tr_b16 v[28:29], v5 offset:11008
    ds_read_b64_tr_b16 v[30:31], v5 offset:11136
    ds_read_b64_tr_b16 v[32:33], v5 offset:11264
    ds_read_b64_tr_b16 v[34:35], v5 offset:11392
    s_waitcnt lgkmcnt(9)
    v_mfma_f32_4x4x4bf16_1k v[56:59], v[12:13], v[16:17], v[56:59]
    s_waitcnt lgkmcnt(8)
    v_mfma_f32_4x4x4bf16_1k v[60:63], v[12:13], v[18:19], v[60:63]
    s_waitcnt lgkmcnt(7)
    v_mfma_f32_4x4x4bf16_1k v[64:67], v[12:13], v[20:21], v[64:67]
    s_waitcnt lgkmcnt(6)
    v_mfma_f32_4x4x4bf16_1k v[68:71], v[12:13], v[22:23], v[68:71]
    s_waitcnt lgkmcnt(5)
    v_mfma_f32_4x4x4bf16_1k v[72:75], v[12:13], v[24:25], v[72:75]
    s_waitcnt lgkmcnt(4)
    v_mfma_f32_4x4x4bf16_1k v[76:79], v[12:13], v[26:27], v[76:79]
    s_waitcnt lgkmcnt(3)
    v_mfma_f32_4x4x4bf16_1k v[80:83], v[12:13], v[28:29], v[80:83]
    s_waitcnt lgkmcnt(2)
    v_mfma_f32_4x4x4bf16_1k v[84:87], v[12:13], v[30:31], v[84:87]
    s_waitcnt lgkmcnt(1)
    v_mfma_f32_4x4x4bf16_1k v[88:91], v[12:13], v[32:33], v[88:91]
    s_waitcnt lgkmcnt(0)
    v_mfma_f32_4x4x4bf16_1k v[92:95], v[12:13], v[34:35], v[92:95]
    ds_read_b64_tr_b16 v[16:17], v5 offset:15360
    ds_read_b64_tr_b16 v[18:19], v5 offset:15488
    ds_read_b64_tr_b16 v[20:21], v5 offset:15616
    ds_read_b64_tr_b16 v[22:23], v5 offset:15744
    ds_read_b64_tr_b16 v[24:25], v5 offset:15872
    ds_read_b64_tr_b16 v[26:27], v5 offset:16000
    ds_read_b64_tr_b16 v[28:29], v5 offset:16128
    ds_read_b64_tr_b16 v[30:31], v5 offset:16256
    ds_read_b64_tr_b16 v[32:33], v5 offset:16384
    ds_read_b64_tr_b16 v[34:35], v5 offset:16512
    s_waitcnt lgkmcnt(9)
    v_mfma_f32_4x4x4bf16_1k v[56:59], v[14:15], v[16:17], v[56:59]
    s_waitcnt lgkmcnt(8)
    v_mfma_f32_4x4x4bf16_1k v[60:63], v[14:15], v[18:19], v[60:63]
    s_waitcnt lgkmcnt(7)
    v_mfma_f32_4x4x4bf16_1k v[64:67], v[14:15], v[20:21], v[64:67]
    s_waitcnt lgkmcnt(6)
    v_mfma_f32_4x4x4bf16_1k v[68:71], v[14:15], v[22:23], v[68:71]
    s_waitcnt lgkmcnt(5)
    v_mfma_f32_4x4x4bf16_1k v[72:75], v[14:15], v[24:25], v[72:75]
    s_waitcnt lgkmcnt(4)
    v_mfma_f32_4x4x4bf16_1k v[76:79], v[14:15], v[26:27], v[76:79]
    s_waitcnt lgkmcnt(3)
    v_mfma_f32_4x4x4bf16_1k v[80:83], v[14:15], v[28:29], v[80:83]
    s_waitcnt lgkmcnt(2)
    v_mfma_f32_4x4x4bf16_1k v[84:87], v[14:15], v[30:31], v[84:87]
    s_waitcnt lgkmcnt(1)
    v_mfma_f32_4x4x4bf16_1k v[88:91], v[14:15], v[32:33], v[88:91]
    s_waitcnt lgkmcnt(0)
    v_mfma_f32_4x4x4bf16_1k v[92:95], v[14:15], v[34:35], v[92:95]
    s_nop 7
    s_add_u32 s16, s15, 0
    buffer_store_dword v56, v7, s[8:11], s16 offen sc1
    s_add_u32 s16, s15, 256
    buffer_store_dword v60, v7, s[8:11], s16 offen sc1
    s_add_u32 s16, s15, 512
    buffer_store_dword v64, v7, s[8:11], s16 offen sc1
    s_add_u32 s16, s15, 768
    buffer_store_dword v68, v7, s[8:11], s16 offen sc1
    s_add_u32 s16, s15, 1024
    buffer_store_dword v72, v7, s[8:11], s16 offen sc1
    s_add_u32 s16, s15, 1280
    buffer_store_dword v76, v7, s[8:11], s16 offen sc1
    s_add_u32 s16, s15, 1536
    buffer_store_dword v80, v7, s[8:11], s16 offen sc1
    s_add_u32 s16, s15, 1792
    buffer_store_dword v84, v7, s[8:11], s16 offen sc1
    s_add_u32 s16, s15, 2048
    buffer_store_dword v88, v7, s[8:11], s16 offen sc1
    s_add_u32 s16, s15, 2304
    buffer_store_dword v92, v7, s[8:11], s16 offen sc1
    s_add_u32 s16, s15, 2560
    buffer_store_dword v57, v7, s[8:11], s16 offen sc1
    s_add_u32 s16, s15, 2816
    buffer_store_dword v61, v7, s[8:11], s16 offen sc1
    s_add_u32 s16, s15, 3072
    buffer_store_dword v65, v7, s[8:11], s16 offen sc1
    s_add_u32 s16, s15, 3328
    buffer_store_dword v69, v7, s[8:11], s16 offen sc1
    s_add_u32 s16, s15, 3584
    buffer_store_dword v73, v7, s[8:11], s16 offen sc1
    s_add_u32 s16, s15, 3840
    buffer_store_dword v77, v7, s[8:11], s16 offen sc1
    s_add_u32 s16, s15, 4096
    buffer_store_dword v81, v7, s[8:11], s16 offen sc1
    s_add_u32 s16, s15, 4352
    buffer_store_dword v85, v7, s[8:11], s16 offen sc1
    s_add_u32 s16, s15, 4608
    buffer_store_dword v89, v7, s[8:11], s16 offen sc1
    s_add_u32 s16, s15, 4864
    buffer_store_dword v93, v7, s[8:11], s16 offen sc1
    s_waitcnt vmcnt(0)
    v_mov_b32 v7, 11823360
    v_mov_b32 v8, 1
    s_mov_b64 exec, 1
    global_atomic_add v7, v8, s[4:5]
    s_mov_b64 exec, -1
L_k2_ffn_done:
    v_mov_b32 v53, 143376
    v_mov_b32 v52, 1
    s_waitcnt lgkmcnt(0)
    s_mov_b64 exec, 1
    ds_add_u32 v53, v52
    s_mov_b64 exec, -1
    s_mov_b32 s13, 1048576
L_wait_moe_loop:
    ds_read_b32 v54, v53
    s_waitcnt lgkmcnt(0)
    v_readfirstlane_b32 s12, v54
    s_sub_u32 s13, s13, 1
    s_cbranch_scc1 L_wait_moe_done
    s_cmp_ge_u32 s12, 3
    s_cbranch_scc1 L_wait_moe_done
    s_sleep 8
    s_branch L_wait_moe_loop
L_wait_moe_done:
    s_branch L_k2_wo_prefetch
L_k2_no_ffn:
L_k2_wo_prefetch:
    s_bfe_u32 s44, s2, 0x20001
    s_lshl_b32 s12, s32, 2
    s_add_u32 s44, s44, s12
    s_and_b32 s45, s2, 1
    s_lshl_b32 s45, s45, 2
    s_bfe_u32 s12, s2, 0x20003
    s_add_u32 s45, s45, s12
    s_mul_i32 s12, s45, 102400
    s_add_u32 s12, s12, 11002112
    s_sub_u32 s13, s20, 9
    s_add_u32 s14, s13, 0
    s_lshl_b32 s14, s14, 12
    s_add_u32 m0, s14, 61440
    s_add_u32 s14, s14, s12
    buffer_load_dwordx4 v1, s[8:11], s14 offen offset:0 lds
    buffer_load_dwordx4 v1, s[8:11], s14 offen offset:1024 lds
    buffer_load_dwordx4 v1, s[8:11], s14 offen offset:2048 lds
    buffer_load_dwordx4 v1, s[8:11], s14 offen offset:3072 lds
    s_add_u32 s14, s13, 3
    s_lshl_b32 s14, s14, 12
    s_add_u32 m0, s14, 61440
    s_add_u32 s14, s14, s12
    buffer_load_dwordx4 v1, s[8:11], s14 offen offset:0 lds
    buffer_load_dwordx4 v1, s[8:11], s14 offen offset:1024 lds
    buffer_load_dwordx4 v1, s[8:11], s14 offen offset:2048 lds
    buffer_load_dwordx4 v1, s[8:11], s14 offen offset:3072 lds
    s_add_u32 s14, s13, 6
    s_lshl_b32 s14, s14, 12
    s_add_u32 m0, s14, 61440
    s_add_u32 s14, s14, s12
    buffer_load_dwordx4 v1, s[8:11], s14 offen offset:0 lds
    buffer_load_dwordx4 v1, s[8:11], s14 offen offset:1024 lds
    buffer_load_dwordx4 v1, s[8:11], s14 offen offset:2048 lds
    buffer_load_dwordx4 v1, s[8:11], s14 offen offset:3072 lds
    s_add_u32 s14, s13, 9
    s_lshl_b32 s14, s14, 12
    s_add_u32 m0, s14, 61440
    s_add_u32 s14, s14, s12
    buffer_load_dwordx4 v1, s[8:11], s14 offen offset:0 lds
    buffer_load_dwordx4 v1, s[8:11], s14 offen offset:1024 lds
    buffer_load_dwordx4 v1, s[8:11], s14 offen offset:2048 lds
    buffer_load_dwordx4 v1, s[8:11], s14 offen offset:3072 lds
    s_add_u32 s14, s13, 12
    s_lshl_b32 s14, s14, 12
    s_add_u32 m0, s14, 61440
    s_add_u32 s14, s14, s12
    buffer_load_dwordx4 v1, s[8:11], s14 offen offset:0 lds
    buffer_load_dwordx4 v1, s[8:11], s14 offen offset:1024 lds
    buffer_load_dwordx4 v1, s[8:11], s14 offen offset:2048 lds
    buffer_load_dwordx4 v1, s[8:11], s14 offen offset:3072 lds
    s_add_u32 s14, s13, 15
    s_lshl_b32 s14, s14, 12
    s_add_u32 m0, s14, 61440
    s_add_u32 s14, s14, s12
    buffer_load_dwordx4 v1, s[8:11], s14 offen offset:0 lds
    buffer_load_dwordx4 v1, s[8:11], s14 offen offset:1024 lds
    buffer_load_dwordx4 v1, s[8:11], s14 offen offset:2048 lds
    buffer_load_dwordx4 v1, s[8:11], s14 offen offset:3072 lds
    s_cmp_eq_u32 s13, 2
    s_cbranch_scc1 L_k2_prefetched
    s_add_u32 s14, s13, 18
    s_lshl_b32 s14, s14, 12
    s_add_u32 m0, s14, 61440
    s_add_u32 s14, s14, s12
    buffer_load_dwordx4 v1, s[8:11], s14 offen offset:0 lds
    buffer_load_dwordx4 v1, s[8:11], s14 offen offset:1024 lds
    buffer_load_dwordx4 v1, s[8:11], s14 offen offset:2048 lds
    buffer_load_dwordx4 v1, s[8:11], s14 offen offset:3072 lds
L_k2_prefetched:
    s_add_u32 s38, s4, 10510336
    s_addc_u32 s39, s5, 0
    s_load_dwordx16 s[64:79], s[38:39], 0
    s_load_dwordx16 s[80:95], s[38:39], 64
    s_waitcnt lgkmcnt(0)
    s_max_u32 s42, s64, s65
    s_min_u32 s43, s64, s65
    s_min_u32 s12, s42, s66
    s_max_u32 s43, s43, s12
    s_max_u32 s42, s42, s66
    s_min_u32 s12, s42, s67
    s_max_u32 s43, s43, s12
    s_max_u32 s42, s42, s67
    s_min_u32 s12, s42, s68
    s_max_u32 s43, s43, s12
    s_max_u32 s42, s42, s68
    s_min_u32 s12, s42, s69
    s_max_u32 s43, s43, s12
    s_max_u32 s42, s42, s69
    s_min_u32 s12, s42, s70
    s_max_u32 s43, s43, s12
    s_max_u32 s42, s42, s70
    s_min_u32 s12, s42, s71
    s_max_u32 s43, s43, s12
    s_max_u32 s42, s42, s71
    s_min_u32 s12, s42, s72
    s_max_u32 s43, s43, s12
    s_max_u32 s42, s42, s72
    s_min_u32 s12, s42, s73
    s_max_u32 s43, s43, s12
    s_max_u32 s42, s42, s73
    s_min_u32 s12, s42, s74
    s_max_u32 s43, s43, s12
    s_max_u32 s42, s42, s74
    s_min_u32 s12, s42, s75
    s_max_u32 s43, s43, s12
    s_max_u32 s42, s42, s75
    s_min_u32 s12, s42, s76
    s_max_u32 s43, s43, s12
    s_max_u32 s42, s42, s76
    s_min_u32 s12, s42, s77
    s_max_u32 s43, s43, s12
    s_max_u32 s42, s42, s77
    s_min_u32 s12, s42, s78
    s_max_u32 s43, s43, s12
    s_max_u32 s42, s42, s78
    s_min_u32 s12, s42, s79
    s_max_u32 s43, s43, s12
    s_max_u32 s42, s42, s79
    s_min_u32 s12, s42, s80
    s_max_u32 s43, s43, s12
    s_max_u32 s42, s42, s80
    s_min_u32 s12, s42, s81
    s_max_u32 s43, s43, s12
    s_max_u32 s42, s42, s81
    s_min_u32 s12, s42, s82
    s_max_u32 s43, s43, s12
    s_max_u32 s42, s42, s82
    s_min_u32 s12, s42, s83
    s_max_u32 s43, s43, s12
    s_max_u32 s42, s42, s83
    s_min_u32 s12, s42, s84
    s_max_u32 s43, s43, s12
    s_max_u32 s42, s42, s84
    s_min_u32 s12, s42, s85
    s_max_u32 s43, s43, s12
    s_max_u32 s42, s42, s85
    s_min_u32 s12, s42, s86
    s_max_u32 s43, s43, s12
    s_max_u32 s42, s42, s86
    s_min_u32 s12, s42, s87
    s_max_u32 s43, s43, s12
    s_max_u32 s42, s42, s87
    s_min_u32 s12, s42, s88
    s_max_u32 s43, s43, s12
    s_max_u32 s42, s42, s88
    s_min_u32 s12, s42, s89
    s_max_u32 s43, s43, s12
    s_max_u32 s42, s42, s89
    s_min_u32 s12, s42, s90
    s_max_u32 s43, s43, s12
    s_max_u32 s42, s42, s90
    s_min_u32 s12, s42, s91
    s_max_u32 s43, s43, s12
    s_max_u32 s42, s42, s91
    s_min_u32 s12, s42, s92
    s_max_u32 s43, s43, s12
    s_max_u32 s42, s42, s92
    s_min_u32 s12, s42, s93
    s_max_u32 s43, s43, s12
    s_max_u32 s42, s42, s93
    s_min_u32 s12, s42, s94
    s_max_u32 s43, s43, s12
    s_max_u32 s42, s42, s94
    s_min_u32 s12, s42, s95
    s_max_u32 s43, s43, s12
    s_max_u32 s42, s42, s95
    s_and_b32 s42, s42, 0x7ff
    s_and_b32 s43, s43, 0x7ff
    s_lshr_b32 s12, s42, 6
    s_lshr_b32 s13, s43, 6
    s_cmp_eq_u32 s12, s44
    s_cbranch_scc1 L_k2_routed
    s_cmp_eq_u32 s13, s44
    s_cbranch_scc0 L_k2_join
L_k2_routed:
    v_mov_b32 v7, 143380
    s_mov_b32 s15, 1048576
L_rt_all_loop:
    ds_read_b32 v6, v7
    s_waitcnt lgkmcnt(0)
    v_readfirstlane_b32 s14, v6
    s_sub_u32 s15, s15, 1
    s_cbranch_scc1 L_rt_all_done
    s_cmp_ge_u32 s14, 1
    s_cbranch_scc1 L_rt_all_done
    s_sleep 8
    s_branch L_rt_all_loop
L_rt_all_done:
    v_subrev_u32 v4, 576, v0
    v_mul_u32_u24 v5, 52429, v4
    v_lshrrev_b32 v5, 20, v5
    v_mul_u32_u24 v6, 20, v5
    v_sub_u32 v6, v4, v6
    v_mul_u32_u24 v8, 61440, v5
    v_lshl_add_u32 v8, v6, 4, v8
    v_mul_u32_u24 v9, 320, v5
    v_lshl_add_u32 v9, v6, 4, v9
    v_add_u32 v9, 144384, v9
    v_lshlrev_b32 v10, 2, v4
    v_mov_b32 v11, 143384
    v_mov_b32 v12, 1
    s_lshr_b32 s12, s42, 6
    s_cmp_lg_u32 s12, s44
    s_cbranch_scc1 L_k2_rt_skip0
    s_lshl_b32 s12, s42, 2
    s_add_u32 s38, s4, s12
    s_addc_u32 s39, s5, 0
    s_add_u32 s38, s38, 10502144
    s_addc_u32 s39, s39, 0
    s_load_dword s40, s[38:39], 0
    s_mul_i32 s12, s45, 320
    s_add_u32 s12, s12, 10510592
    v_cmp_gt_u32 vcc, 160, v4
    s_and_saveexec_b64 s[48:49], vcc
    s_add_u32 s13, s12, 0
    buffer_load_dwordx4 v[20:23], v8, s[8:11], s13 offen sc1
    s_add_u32 s13, s12, 5120
    buffer_load_dwordx4 v[24:27], v8, s[8:11], s13 offen sc1
    s_add_u32 s13, s12, 10240
    buffer_load_dwordx4 v[28:31], v8, s[8:11], s13 offen sc1
    s_add_u32 s13, s12, 15360
    buffer_load_dwordx4 v[32:35], v8, s[8:11], s13 offen sc1
    s_add_u32 s13, s12, 20480
    buffer_load_dwordx4 v[36:39], v8, s[8:11], s13 offen sc1
    s_add_u32 s13, s12, 25600
    buffer_load_dwordx4 v[40:43], v8, s[8:11], s13 offen sc1
    s_add_u32 s13, s12, 30720
    buffer_load_dwordx4 v[44:47], v8, s[8:11], s13 offen sc1
    s_add_u32 s13, s12, 35840
    buffer_load_dwordx4 v[48:51], v8, s[8:11], s13 offen sc1
    s_add_u32 s13, s12, 40960
    buffer_load_dwordx4 v[52:55], v8, s[8:11], s13 offen sc1
    s_add_u32 s13, s12, 46080
    buffer_load_dwordx4 v[56:59], v8, s[8:11], s13 offen sc1
    s_add_u32 s13, s12, 51200
    buffer_load_dwordx4 v[60:63], v8, s[8:11], s13 offen sc1
    s_add_u32 s13, s12, 56320
    buffer_load_dwordx4 v[64:67], v8, s[8:11], s13 offen sc1
    s_waitcnt vmcnt(0)
    v_add_f32 v20, v20, v24
    v_add_f32 v21, v21, v25
    v_add_f32 v22, v22, v26
    v_add_f32 v23, v23, v27
    v_add_f32 v20, v20, v28
    v_add_f32 v21, v21, v29
    v_add_f32 v22, v22, v30
    v_add_f32 v23, v23, v31
    v_add_f32 v20, v20, v32
    v_add_f32 v21, v21, v33
    v_add_f32 v22, v22, v34
    v_add_f32 v23, v23, v35
    v_add_f32 v20, v20, v36
    v_add_f32 v21, v21, v37
    v_add_f32 v22, v22, v38
    v_add_f32 v23, v23, v39
    v_add_f32 v20, v20, v40
    v_add_f32 v21, v21, v41
    v_add_f32 v22, v22, v42
    v_add_f32 v23, v23, v43
    v_add_f32 v20, v20, v44
    v_add_f32 v21, v21, v45
    v_add_f32 v22, v22, v46
    v_add_f32 v23, v23, v47
    v_add_f32 v20, v20, v48
    v_add_f32 v21, v21, v49
    v_add_f32 v22, v22, v50
    v_add_f32 v23, v23, v51
    v_add_f32 v20, v20, v52
    v_add_f32 v21, v21, v53
    v_add_f32 v22, v22, v54
    v_add_f32 v23, v23, v55
    v_add_f32 v20, v20, v56
    v_add_f32 v21, v21, v57
    v_add_f32 v22, v22, v58
    v_add_f32 v23, v23, v59
    v_add_f32 v20, v20, v60
    v_add_f32 v21, v21, v61
    v_add_f32 v22, v22, v62
    v_add_f32 v23, v23, v63
    v_add_f32 v20, v20, v64
    v_add_f32 v21, v21, v65
    v_add_f32 v22, v22, v66
    v_add_f32 v23, v23, v67
    ds_write_b128 v9, v[20:23]
    s_waitcnt lgkmcnt(0)
    s_mov_b64 exec, 1
    ds_add_u32 v11, v12 offset:0
    s_mov_b64 exec, -1
    v_add_u32 v13, 0, v11
    s_mov_b32 s15, 1048576
L_rt_a0_loop:
    ds_read_b32 v14, v13
    s_waitcnt lgkmcnt(0)
    v_readfirstlane_b32 s14, v14
    s_sub_u32 s15, s15, 1
    s_cbranch_scc1 L_rt_a0_done
    s_cmp_ge_u32 s14, 3
    s_cbranch_scc1 L_rt_a0_done
    s_sleep 2
    s_branch L_rt_a0_loop
L_rt_a0_done:
    v_add_u32 v13, 144384, v10
    v_cmp_gt_u32 vcc, 80, v4
    s_and_saveexec_b64 s[48:49], vcc
    s_cbranch_execz L_k2_rt_c0
    ds_read_b32 v20, v13 offset:0
    ds_read_b32 v21, v13 offset:320
    ds_read_b32 v22, v13 offset:640
    ds_read_b32 v23, v13 offset:960
    ds_read_b32 v24, v13 offset:1280
    ds_read_b32 v25, v13 offset:1600
    ds_read_b32 v26, v13 offset:1920
    ds_read_b32 v27, v13 offset:2240
    v_mov_b32 v15, s40
    v_mul_f32 v15, 0xbfb8aa3b, v15
    v_exp_f32 v15, v15
    s_nop 0
    v_add_f32 v15, 1.0, v15
    v_rcp_f32 v15, v15
    s_waitcnt lgkmcnt(0)
    v_add_f32 v20, v20, v21
    v_add_f32 v20, v20, v22
    v_add_f32 v20, v20, v23
    v_add_f32 v20, v20, v24
    v_add_f32 v20, v20, v25
    v_add_f32 v20, v20, v26
    v_add_f32 v20, v20, v27
    v_mul_f32 v20, v20, v15
    v_add_u32 v13, 148224, v10
    ds_write_b32 v13, v20
L_k2_rt_c0:
    s_mov_b64 exec, -1
    s_waitcnt lgkmcnt(0)
    s_mov_b64 exec, 1
    ds_add_u32 v11, v12 offset:4
    s_mov_b64 exec, -1
    v_add_u32 v13, 4, v11
    s_mov_b32 s15, 1048576
L_rt_b0_loop:
    ds_read_b32 v14, v13
    s_waitcnt lgkmcnt(0)
    v_readfirstlane_b32 s14, v14
    s_sub_u32 s15, s15, 1
    s_cbranch_scc1 L_rt_b0_done
    s_cmp_ge_u32 s14, 3
    s_cbranch_scc1 L_rt_b0_done
    s_sleep 2
    s_branch L_rt_b0_loop
L_rt_b0_done:
L_k2_rt_skip0:
    s_lshr_b32 s12, s43, 6
    s_cmp_lg_u32 s12, s44
    s_cbranch_scc1 L_k2_rt_skip1
    s_lshl_b32 s12, s43, 2
    s_add_u32 s38, s4, s12
    s_addc_u32 s39, s5, 0
    s_add_u32 s38, s38, 10502144
    s_addc_u32 s39, s39, 0
    s_load_dword s40, s[38:39], 0
    s_mul_i32 s12, s45, 320
    s_add_u32 s12, s12, 10513152
    v_cmp_gt_u32 vcc, 160, v4
    s_and_saveexec_b64 s[48:49], vcc
    s_add_u32 s13, s12, 0
    buffer_load_dwordx4 v[20:23], v8, s[8:11], s13 offen sc1
    s_add_u32 s13, s12, 5120
    buffer_load_dwordx4 v[24:27], v8, s[8:11], s13 offen sc1
    s_add_u32 s13, s12, 10240
    buffer_load_dwordx4 v[28:31], v8, s[8:11], s13 offen sc1
    s_add_u32 s13, s12, 15360
    buffer_load_dwordx4 v[32:35], v8, s[8:11], s13 offen sc1
    s_add_u32 s13, s12, 20480
    buffer_load_dwordx4 v[36:39], v8, s[8:11], s13 offen sc1
    s_add_u32 s13, s12, 25600
    buffer_load_dwordx4 v[40:43], v8, s[8:11], s13 offen sc1
    s_add_u32 s13, s12, 30720
    buffer_load_dwordx4 v[44:47], v8, s[8:11], s13 offen sc1
    s_add_u32 s13, s12, 35840
    buffer_load_dwordx4 v[48:51], v8, s[8:11], s13 offen sc1
    s_add_u32 s13, s12, 40960
    buffer_load_dwordx4 v[52:55], v8, s[8:11], s13 offen sc1
    s_add_u32 s13, s12, 46080
    buffer_load_dwordx4 v[56:59], v8, s[8:11], s13 offen sc1
    s_add_u32 s13, s12, 51200
    buffer_load_dwordx4 v[60:63], v8, s[8:11], s13 offen sc1
    s_add_u32 s13, s12, 56320
    buffer_load_dwordx4 v[64:67], v8, s[8:11], s13 offen sc1
    s_waitcnt vmcnt(0)
    v_add_f32 v20, v20, v24
    v_add_f32 v21, v21, v25
    v_add_f32 v22, v22, v26
    v_add_f32 v23, v23, v27
    v_add_f32 v20, v20, v28
    v_add_f32 v21, v21, v29
    v_add_f32 v22, v22, v30
    v_add_f32 v23, v23, v31
    v_add_f32 v20, v20, v32
    v_add_f32 v21, v21, v33
    v_add_f32 v22, v22, v34
    v_add_f32 v23, v23, v35
    v_add_f32 v20, v20, v36
    v_add_f32 v21, v21, v37
    v_add_f32 v22, v22, v38
    v_add_f32 v23, v23, v39
    v_add_f32 v20, v20, v40
    v_add_f32 v21, v21, v41
    v_add_f32 v22, v22, v42
    v_add_f32 v23, v23, v43
    v_add_f32 v20, v20, v44
    v_add_f32 v21, v21, v45
    v_add_f32 v22, v22, v46
    v_add_f32 v23, v23, v47
    v_add_f32 v20, v20, v48
    v_add_f32 v21, v21, v49
    v_add_f32 v22, v22, v50
    v_add_f32 v23, v23, v51
    v_add_f32 v20, v20, v52
    v_add_f32 v21, v21, v53
    v_add_f32 v22, v22, v54
    v_add_f32 v23, v23, v55
    v_add_f32 v20, v20, v56
    v_add_f32 v21, v21, v57
    v_add_f32 v22, v22, v58
    v_add_f32 v23, v23, v59
    v_add_f32 v20, v20, v60
    v_add_f32 v21, v21, v61
    v_add_f32 v22, v22, v62
    v_add_f32 v23, v23, v63
    v_add_f32 v20, v20, v64
    v_add_f32 v21, v21, v65
    v_add_f32 v22, v22, v66
    v_add_f32 v23, v23, v67
    ds_write_b128 v9, v[20:23]
    s_waitcnt lgkmcnt(0)
    s_mov_b64 exec, 1
    ds_add_u32 v11, v12 offset:8
    s_mov_b64 exec, -1
    v_add_u32 v13, 8, v11
    s_mov_b32 s15, 1048576
L_rt_a1_loop:
    ds_read_b32 v14, v13
    s_waitcnt lgkmcnt(0)
    v_readfirstlane_b32 s14, v14
    s_sub_u32 s15, s15, 1
    s_cbranch_scc1 L_rt_a1_done
    s_cmp_ge_u32 s14, 3
    s_cbranch_scc1 L_rt_a1_done
    s_sleep 2
    s_branch L_rt_a1_loop
L_rt_a1_done:
    v_add_u32 v13, 144384, v10
    v_cmp_gt_u32 vcc, 80, v4
    s_and_saveexec_b64 s[48:49], vcc
    s_cbranch_execz L_k2_rt_c1
    ds_read_b32 v20, v13 offset:0
    ds_read_b32 v21, v13 offset:320
    ds_read_b32 v22, v13 offset:640
    ds_read_b32 v23, v13 offset:960
    ds_read_b32 v24, v13 offset:1280
    ds_read_b32 v25, v13 offset:1600
    ds_read_b32 v26, v13 offset:1920
    ds_read_b32 v27, v13 offset:2240
    v_mov_b32 v15, s40
    v_mul_f32 v15, 0xbfb8aa3b, v15
    v_exp_f32 v15, v15
    s_nop 0
    v_add_f32 v15, 1.0, v15
    v_rcp_f32 v15, v15
    s_waitcnt lgkmcnt(0)
    v_add_f32 v20, v20, v21
    v_add_f32 v20, v20, v22
    v_add_f32 v20, v20, v23
    v_add_f32 v20, v20, v24
    v_add_f32 v20, v20, v25
    v_add_f32 v20, v20, v26
    v_add_f32 v20, v20, v27
    v_mul_f32 v20, v20, v15
    v_add_u32 v13, 148544, v10
    ds_write_b32 v13, v20
L_k2_rt_c1:
    s_mov_b64 exec, -1
    s_waitcnt lgkmcnt(0)
    s_mov_b64 exec, 1
    ds_add_u32 v11, v12 offset:12
    s_mov_b64 exec, -1
    v_add_u32 v13, 12, v11
    s_mov_b32 s15, 1048576
L_rt_b1_loop:
    ds_read_b32 v14, v13
    s_waitcnt lgkmcnt(0)
    v_readfirstlane_b32 s14, v14
    s_sub_u32 s15, s15, 1
    s_cbranch_scc1 L_rt_b1_done
    s_cmp_ge_u32 s14, 3
    s_cbranch_scc1 L_rt_b1_done
    s_sleep 2
    s_branch L_rt_b1_loop
L_rt_b1_done:
L_k2_rt_skip1:
    s_branch L_k2_join
L_k2_join:
    s_load_dwordx2 s[6:7], s[0:1], 0
    s_load_dwordx2 s[36:37], s[0:1], 64
    s_add_u32 s38, s4, 10510336
    s_addc_u32 s39, s5, 0
    s_load_dwordx16 s[64:79], s[38:39], 0
    s_load_dwordx16 s[80:95], s[38:39], 64
    s_bfe_u32 s44, s2, 0x20001
    s_lshl_b32 s12, s32, 2
    s_add_u32 s44, s44, s12
    s_and_b32 s45, s2, 1
    s_lshl_b32 s45, s45, 2
    s_bfe_u32 s12, s2, 0x20003
    s_add_u32 s45, s45, s12
    v_and_b32 v3, 63, v0
    s_waitcnt vmcnt(0)
    s_barrier
    s_waitcnt lgkmcnt(0)
    s_mov_b32 s56, s6
    s_and_b32 s57, s7, 0xffff
    s_mov_b32 s58, 2621440
    s_mov_b32 s59, 0x00020000
    s_mov_b32 s60, s36
    s_and_b32 s61, s37, 0xffff
    s_mov_b32 s62, 2621440
    s_mov_b32 s63, 0x00020000
    s_cmp_eq_u32 s20, 8
    s_cbranch_scc1 L_k2_sync
    s_cmp_ge_u32 s20, 4
    s_cbranch_scc1 L_k2_side
    v_and_b32 v2, 15, v3
    v_lshrrev_b32 v8, 4, v3
    s_lshl_b32 s12, s44, 6
    s_lshl_b32 s13, s20, 4
    s_add_u32 s12, s12, s13
    v_add_u32 v11, s12, v2
    v_mul_u32_u24 v10, 1280, v11
    v_lshl_add_u32 v10, v8, 3, v10
    s_mul_i32 s13, s45, 160
    v_add_u32 v10, s13, v10
    v_lshlrev_b32 v5, 3, v11
    s_mov_b32 s12, 10485760
    buffer_load_dwordx2 v[12:13], v5, s[8:11], s12 offen
    buffer_load_dwordx2 v[14:15], v10, s[56:59], 0 offen offset:0
    buffer_load_dwordx2 v[16:17], v10, s[56:59], 0 offen offset:32
    buffer_load_dwordx2 v[18:19], v10, s[56:59], 0 offen offset:64
    buffer_load_dwordx2 v[20:21], v10, s[56:59], 0 offen offset:96
    buffer_load_dwordx2 v[22:23], v10, s[56:59], 0 offen offset:128
    s_lshl_b32 s12, s44, 2
    s_add_u32 s12, s12, s20
    s_mul_i32 s46, s12, 20480
    s_add_u32 s46, s46, 7864320
    v_add_u32 v9, 61440, v1
    v_add_u32 v3, 102400, v1
    s_max_u32 s42, s64, s65
    s_min_u32 s43, s64, s65
    s_min_u32 s12, s42, s66
    s_max_u32 s43, s43, s12
    s_max_u32 s42, s42, s66
    s_min_u32 s12, s42, s67
    s_max_u32 s43, s43, s12
    s_max_u32 s42, s42, s67
    s_min_u32 s12, s42, s68
    s_max_u32 s43, s43, s12
    s_max_u32 s42, s42, s68
    s_min_u32 s12, s42, s69
    s_max_u32 s43, s43, s12
    s_max_u32 s42, s42, s69
    s_min_u32 s12, s42, s70
    s_max_u32 s43, s43, s12
    s_max_u32 s42, s42, s70
    s_min_u32 s12, s42, s71
    s_max_u32 s43, s43, s12
    s_max_u32 s42, s42, s71
    s_min_u32 s12, s42, s72
    s_max_u32 s43, s43, s12
    s_max_u32 s42, s42, s72
    s_min_u32 s12, s42, s73
    s_max_u32 s43, s43, s12
    s_max_u32 s42, s42, s73
    s_min_u32 s12, s42, s74
    s_max_u32 s43, s43, s12
    s_max_u32 s42, s42, s74
    s_min_u32 s12, s42, s75
    s_max_u32 s43, s43, s12
    s_max_u32 s42, s42, s75
    s_min_u32 s12, s42, s76
    s_max_u32 s43, s43, s12
    s_max_u32 s42, s42, s76
    s_min_u32 s12, s42, s77
    s_max_u32 s43, s43, s12
    s_max_u32 s42, s42, s77
    s_min_u32 s12, s42, s78
    s_max_u32 s43, s43, s12
    s_max_u32 s42, s42, s78
    s_min_u32 s12, s42, s79
    s_max_u32 s43, s43, s12
    s_max_u32 s42, s42, s79
    s_min_u32 s12, s42, s80
    s_max_u32 s43, s43, s12
    s_max_u32 s42, s42, s80
    s_min_u32 s12, s42, s81
    s_max_u32 s43, s43, s12
    s_max_u32 s42, s42, s81
    s_min_u32 s12, s42, s82
    s_max_u32 s43, s43, s12
    s_max_u32 s42, s42, s82
    s_min_u32 s12, s42, s83
    s_max_u32 s43, s43, s12
    s_max_u32 s42, s42, s83
    s_min_u32 s12, s42, s84
    s_max_u32 s43, s43, s12
    s_max_u32 s42, s42, s84
    s_min_u32 s12, s42, s85
    s_max_u32 s43, s43, s12
    s_max_u32 s42, s42, s85
    s_min_u32 s12, s42, s86
    s_max_u32 s43, s43, s12
    s_max_u32 s42, s42, s86
    s_min_u32 s12, s42, s87
    s_max_u32 s43, s43, s12
    s_max_u32 s42, s42, s87
    s_min_u32 s12, s42, s88
    s_max_u32 s43, s43, s12
    s_max_u32 s42, s42, s88
    s_min_u32 s12, s42, s89
    s_max_u32 s43, s43, s12
    s_max_u32 s42, s42, s89
    s_min_u32 s12, s42, s90
    s_max_u32 s43, s43, s12
    s_max_u32 s42, s42, s90
    s_min_u32 s12, s42, s91
    s_max_u32 s43, s43, s12
    s_max_u32 s42, s42, s91
    s_min_u32 s12, s42, s92
    s_max_u32 s43, s43, s12
    s_max_u32 s42, s42, s92
    s_min_u32 s12, s42, s93
    s_max_u32 s43, s43, s12
    s_max_u32 s42, s42, s93
    s_min_u32 s12, s42, s94
    s_max_u32 s43, s43, s12
    s_max_u32 s42, s42, s94
    s_min_u32 s12, s42, s95
    s_max_u32 s43, s43, s12
    s_max_u32 s42, s42, s95
    s_and_b32 s42, s42, 0x7ff
    s_and_b32 s43, s43, 0x7ff
    s_waitcnt vmcnt(0)
    v_add_f32 v4, 1.0, v13
    v_mul_f32 v5, v12, v13
    v_lshlrev_b32 v6, 16, v14
    v_and_b32 v7, 0xffff0000, v14
    v_fma_f32 v24, v6, v4, -v5
    v_fma_f32 v25, v7, v4, -v5
    v_lshlrev_b32 v6, 16, v15
    v_and_b32 v7, 0xffff0000, v15
    v_fma_f32 v26, v6, v4, -v5
    v_fma_f32 v27, v7, v4, -v5
    v_lshlrev_b32 v6, 16, v16
    v_and_b32 v7, 0xffff0000, v16
    v_fma_f32 v28, v6, v4, -v5
    v_fma_f32 v29, v7, v4, -v5
    v_lshlrev_b32 v6, 16, v17
    v_and_b32 v7, 0xffff0000, v17
    v_fma_f32 v30, v6, v4, -v5
    v_fma_f32 v31, v7, v4, -v5
    v_lshlrev_b32 v6, 16, v18
    v_and_b32 v7, 0xffff0000, v18
    v_fma_f32 v32, v6, v4, -v5
    v_fma_f32 v33, v7, v4, -v5
    v_lshlrev_b32 v6, 16, v19
    v_and_b32 v7, 0xffff0000, v19
    v_fma_f32 v34, v6, v4, -v5
    v_fma_f32 v35, v7, v4, -v5
    v_lshlrev_b32 v6, 16, v20
    v_and_b32 v7, 0xffff0000, v20
    v_fma_f32 v36, v6, v4, -v5
    v_fma_f32 v37, v7, v4, -v5
    v_lshlrev_b32 v6, 16, v21
    v_and_b32 v7, 0xffff0000, v21
    v_fma_f32 v38, v6, v4, -v5
    v_fma_f32 v39, v7, v4, -v5
    v_lshlrev_b32 v6, 16, v22
    v_and_b32 v7, 0xffff0000, v22
    v_fma_f32 v40, v6, v4, -v5
    v_fma_f32 v41, v7, v4, -v5
    v_lshlrev_b32 v6, 16, v23
    v_and_b32 v7, 0xffff0000, v23
    v_fma_f32 v42, v6, v4, -v5
    v_fma_f32 v43, v7, v4, -v5
    s_barrier
    s_add_u32 s12, s46, 0
    buffer_load_dwordx4 v[84:87], v1, s[8:11], s12 offen offset:0 sc1
    buffer_load_dwordx4 v[88:91], v1, s[8:11], s12 offen offset:1024 sc1
    buffer_load_dwordx4 v[92:95], v1, s[8:11], s12 offen offset:2048 sc1
    buffer_load_dwordx4 v[96:99], v1, s[8:11], s12 offen offset:3072 sc1
    s_add_u32 s12, s46, 4096
    buffer_load_dwordx4 v[100:103], v1, s[8:11], s12 offen offset:0 sc1
    buffer_load_dwordx4 v[104:107], v1, s[8:11], s12 offen offset:1024 sc1
    buffer_load_dwordx4 v[108:111], v1, s[8:11], s12 offen offset:2048 sc1
    buffer_load_dwordx4 v[112:115], v1, s[8:11], s12 offen offset:3072 sc1
    s_add_u32 s12, s46, 8192
    buffer_load_dwordx4 v[116:119], v1, s[8:11], s12 offen offset:0 sc1
    buffer_load_dwordx4 v[120:123], v1, s[8:11], s12 offen offset:1024 sc1
    buffer_load_dwordx4 v[124:127], v1, s[8:11], s12 offen offset:2048 sc1
    buffer_load_dwordx4 v[128:131], v1, s[8:11], s12 offen offset:3072 sc1
    s_add_u32 s12, s46, 12288
    buffer_load_dwordx4 v[132:135], v1, s[8:11], s12 offen offset:0 sc1
    buffer_load_dwordx4 v[136:139], v1, s[8:11], s12 offen offset:1024 sc1
    buffer_load_dwordx4 v[140:143], v1, s[8:11], s12 offen offset:2048 sc1
    buffer_load_dwordx4 v[144:147], v1, s[8:11], s12 offen offset:3072 sc1
    s_add_u32 s12, s46, 16384
    buffer_load_dwordx4 v[148:151], v1, s[8:11], s12 offen offset:0 sc1
    buffer_load_dwordx4 v[152:155], v1, s[8:11], s12 offen offset:1024 sc1
    buffer_load_dwordx4 v[156:159], v1, s[8:11], s12 offen offset:2048 sc1
    buffer_load_dwordx4 v[160:163], v1, s[8:11], s12 offen offset:3072 sc1
    ds_read_b128 v[44:47], v9 offset:0
    ds_read_b128 v[48:51], v9 offset:1024
    ds_read_b128 v[52:55], v9 offset:2048
    ds_read_b128 v[56:59], v9 offset:3072
    ds_read_b128 v[60:63], v9 offset:4096
    ds_read_b128 v[64:67], v9 offset:5120
    ds_read_b128 v[68:71], v9 offset:6144
    ds_read_b128 v[72:75], v9 offset:7168
    ds_read_b128 v[76:79], v9 offset:8192
    ds_read_b128 v[80:83], v9 offset:9216
    s_waitcnt vmcnt(19) lgkmcnt(5)
    v_mfma_f32_16x16x32_bf16 v[24:27], v[44:47], v[84:87], v[24:27]
    v_mfma_f32_16x16x32_bf16 v[28:31], v[48:51], v[84:87], v[28:31]
    v_mfma_f32_16x16x32_bf16 v[32:35], v[52:55], v[84:87], v[32:35]
    v_mfma_f32_16x16x32_bf16 v[36:39], v[56:59], v[84:87], v[36:39]
    v_mfma_f32_16x16x32_bf16 v[40:43], v[60:63], v[84:87], v[40:43]
    ds_read_b128 v[44:47], v9 offset:10240
    ds_read_b128 v[48:51], v9 offset:11264
    ds_read_b128 v[52:55], v9 offset:12288
    ds_read_b128 v[56:59], v9 offset:13312
    ds_read_b128 v[60:63], v9 offset:14336
    s_waitcnt vmcnt(18) lgkmcnt(5)
    v_mfma_f32_16x16x32_bf16 v[24:27], v[64:67], v[88:91], v[24:27]
    v_mfma_f32_16x16x32_bf16 v[28:31], v[68:71], v[88:91], v[28:31]
    v_mfma_f32_16x16x32_bf16 v[32:35], v[72:75], v[88:91], v[32:35]
    v_mfma_f32_16x16x32_bf16 v[36:39], v[76:79], v[88:91], v[36:39]
    v_mfma_f32_16x16x32_bf16 v[40:43], v[80:83], v[88:91], v[40:43]
    ds_read_b128 v[64:67], v9 offset:15360
    ds_read_b128 v[68:71], v9 offset:16384
    ds_read_b128 v[72:75], v9 offset:17408
    ds_read_b128 v[76:79], v9 offset:18432
    ds_read_b128 v[80:83], v9 offset:19456
    s_waitcnt vmcnt(17) lgkmcnt(5)
    v_mfma_f32_16x16x32_bf16 v[24:27], v[44:47], v[92:95], v[24:27]
    v_mfma_f32_16x16x32_bf16 v[28:31], v[48:51], v[92:95], v[28:31]
    v_mfma_f32_16x16x32_bf16 v[32:35], v[52:55], v[92:95], v[32:35]
    v_mfma_f32_16x16x32_bf16 v[36:39], v[56:59], v[92:95], v[36:39]
    v_mfma_f32_16x16x32_bf16 v[40:43], v[60:63], v[92:95], v[40:43]
    ds_read_b128 v[44:47], v9 offset:20480
    ds_read_b128 v[48:51], v9 offset:21504
    ds_read_b128 v[52:55], v9 offset:22528
    ds_read_b128 v[56:59], v9 offset:23552
    ds_read_b128 v[60:63], v9 offset:24576
    s_waitcnt vmcnt(16) lgkmcnt(5)
    v_mfma_f32_16x16x32_bf16 v[24:27], v[64:67], v[96:99], v[24:27]
    v_mfma_f32_16x16x32_bf16 v[28:31], v[68:71], v[96:99], v[28:31]
    v_mfma_f32_16x16x32_bf16 v[32:35], v[72:75], v[96:99], v[32:35]
    v_mfma_f32_16x16x32_bf16 v[36:39], v[76:79], v[96:99], v[36:39]
    v_mfma_f32_16x16x32_bf16 v[40:43], v[80:83], v[96:99], v[40:43]
    ds_read_b128 v[64:67], v9 offset:25600
    ds_read_b128 v[68:71], v9 offset:26624
    ds_read_b128 v[72:75], v9 offset:27648
    ds_read_b128 v[76:79], v9 offset:28672
    ds_read_b128 v[80:83], v9 offset:29696
    s_waitcnt vmcnt(15) lgkmcnt(5)
    v_mfma_f32_16x16x32_bf16 v[24:27], v[44:47], v[100:103], v[24:27]
    v_mfma_f32_16x16x32_bf16 v[28:31], v[48:51], v[100:103], v[28:31]
    v_mfma_f32_16x16x32_bf16 v[32:35], v[52:55], v[100:103], v[32:35]
    v_mfma_f32_16x16x32_bf16 v[36:39], v[56:59], v[100:103], v[36:39]
    v_mfma_f32_16x16x32_bf16 v[40:43], v[60:63], v[100:103], v[40:43]
    ds_read_b128 v[44:47], v9 offset:30720
    ds_read_b128 v[48:51], v9 offset:31744
    ds_read_b128 v[52:55], v9 offset:32768
    ds_read_b128 v[56:59], v9 offset:33792
    ds_read_b128 v[60:63], v9 offset:34816
    s_waitcnt vmcnt(14) lgkmcnt(5)
    v_mfma_f32_16x16x32_bf16 v[24:27], v[64:67], v[104:107], v[24:27]
    v_mfma_f32_16x16x32_bf16 v[28:31], v[68:71], v[104:107], v[28:31]
    v_mfma_f32_16x16x32_bf16 v[32:35], v[72:75], v[104:107], v[32:35]
    v_mfma_f32_16x16x32_bf16 v[36:39], v[76:79], v[104:107], v[36:39]
    v_mfma_f32_16x16x32_bf16 v[40:43], v[80:83], v[104:107], v[40:43]
    ds_read_b128 v[64:67], v9 offset:35840
    ds_read_b128 v[68:71], v9 offset:36864
    ds_read_b128 v[72:75], v9 offset:37888
    ds_read_b128 v[76:79], v9 offset:38912
    ds_read_b128 v[80:83], v9 offset:39936
    s_waitcnt vmcnt(13) lgkmcnt(5)
    v_mfma_f32_16x16x32_bf16 v[24:27], v[44:47], v[108:111], v[24:27]
    v_mfma_f32_16x16x32_bf16 v[28:31], v[48:51], v[108:111], v[28:31]
    v_mfma_f32_16x16x32_bf16 v[32:35], v[52:55], v[108:111], v[32:35]
    v_mfma_f32_16x16x32_bf16 v[36:39], v[56:59], v[108:111], v[36:39]
    v_mfma_f32_16x16x32_bf16 v[40:43], v[60:63], v[108:111], v[40:43]
    ds_read_b128 v[44:47], v3 offset:0
    ds_read_b128 v[48:51], v3 offset:1024
    ds_read_b128 v[52:55], v3 offset:2048
    ds_read_b128 v[56:59], v3 offset:3072
    ds_read_b128 v[60:63], v3 offset:4096
    s_waitcnt vmcnt(12) lgkmcnt(5)
    v_mfma_f32_16x16x32_bf16 v[24:27], v[64:67], v[112:115], v[24:27]
    v_mfma_f32_16x16x32_bf16 v[28:31], v[68:71], v[112:115], v[28:31]
    v_mfma_f32_16x16x32_bf16 v[32:35], v[72:75], v[112:115], v[32:35]
    v_mfma_f32_16x16x32_bf16 v[36:39], v[76:79], v[112:115], v[36:39]
    v_mfma_f32_16x16x32_bf16 v[40:43], v[80:83], v[112:115], v[40:43]
    ds_read_b128 v[64:67], v3 offset:5120
    ds_read_b128 v[68:71], v3 offset:6144
    ds_read_b128 v[72:75], v3 offset:7168
    ds_read_b128 v[76:79], v3 offset:8192
    ds_read_b128 v[80:83], v3 offset:9216
    s_waitcnt vmcnt(11) lgkmcnt(5)
    v_mfma_f32_16x16x32_bf16 v[24:27], v[44:47], v[116:119], v[24:27]
    v_mfma_f32_16x16x32_bf16 v[28:31], v[48:51], v[116:119], v[28:31]
    v_mfma_f32_16x16x32_bf16 v[32:35], v[52:55], v[116:119], v[32:35]
    v_mfma_f32_16x16x32_bf16 v[36:39], v[56:59], v[116:119], v[36:39]
    v_mfma_f32_16x16x32_bf16 v[40:43], v[60:63], v[116:119], v[40:43]
    ds_read_b128 v[44:47], v3 offset:10240
    ds_read_b128 v[48:51], v3 offset:11264
    ds_read_b128 v[52:55], v3 offset:12288
    ds_read_b128 v[56:59], v3 offset:13312
    ds_read_b128 v[60:63], v3 offset:14336
    s_waitcnt vmcnt(10) lgkmcnt(5)
    v_mfma_f32_16x16x32_bf16 v[24:27], v[64:67], v[120:123], v[24:27]
    v_mfma_f32_16x16x32_bf16 v[28:31], v[68:71], v[120:123], v[28:31]
    v_mfma_f32_16x16x32_bf16 v[32:35], v[72:75], v[120:123], v[32:35]
    v_mfma_f32_16x16x32_bf16 v[36:39], v[76:79], v[120:123], v[36:39]
    v_mfma_f32_16x16x32_bf16 v[40:43], v[80:83], v[120:123], v[40:43]
    ds_read_b128 v[64:67], v3 offset:15360
    ds_read_b128 v[68:71], v3 offset:16384
    ds_read_b128 v[72:75], v3 offset:17408
    ds_read_b128 v[76:79], v3 offset:18432
    ds_read_b128 v[80:83], v3 offset:19456
    s_waitcnt vmcnt(9) lgkmcnt(5)
    v_mfma_f32_16x16x32_bf16 v[24:27], v[44:47], v[124:127], v[24:27]
    v_mfma_f32_16x16x32_bf16 v[28:31], v[48:51], v[124:127], v[28:31]
    v_mfma_f32_16x16x32_bf16 v[32:35], v[52:55], v[124:127], v[32:35]
    v_mfma_f32_16x16x32_bf16 v[36:39], v[56:59], v[124:127], v[36:39]
    v_mfma_f32_16x16x32_bf16 v[40:43], v[60:63], v[124:127], v[40:43]
    ds_read_b128 v[44:47], v3 offset:20480
    ds_read_b128 v[48:51], v3 offset:21504
    ds_read_b128 v[52:55], v3 offset:22528
    ds_read_b128 v[56:59], v3 offset:23552
    ds_read_b128 v[60:63], v3 offset:24576
    s_waitcnt vmcnt(8) lgkmcnt(5)
    v_mfma_f32_16x16x32_bf16 v[24:27], v[64:67], v[128:131], v[24:27]
    v_mfma_f32_16x16x32_bf16 v[28:31], v[68:71], v[128:131], v[28:31]
    v_mfma_f32_16x16x32_bf16 v[32:35], v[72:75], v[128:131], v[32:35]
    v_mfma_f32_16x16x32_bf16 v[36:39], v[76:79], v[128:131], v[36:39]
    v_mfma_f32_16x16x32_bf16 v[40:43], v[80:83], v[128:131], v[40:43]
    ds_read_b128 v[64:67], v3 offset:25600
    ds_read_b128 v[68:71], v3 offset:26624
    ds_read_b128 v[72:75], v3 offset:27648
    ds_read_b128 v[76:79], v3 offset:28672
    ds_read_b128 v[80:83], v3 offset:29696
    s_waitcnt vmcnt(7) lgkmcnt(5)
    v_mfma_f32_16x16x32_bf16 v[24:27], v[44:47], v[132:135], v[24:27]
    v_mfma_f32_16x16x32_bf16 v[28:31], v[48:51], v[132:135], v[28:31]
    v_mfma_f32_16x16x32_bf16 v[32:35], v[52:55], v[132:135], v[32:35]
    v_mfma_f32_16x16x32_bf16 v[36:39], v[56:59], v[132:135], v[36:39]
    v_mfma_f32_16x16x32_bf16 v[40:43], v[60:63], v[132:135], v[40:43]
    ds_read_b128 v[44:47], v3 offset:30720
    ds_read_b128 v[48:51], v3 offset:31744
    ds_read_b128 v[52:55], v3 offset:32768
    ds_read_b128 v[56:59], v3 offset:33792
    ds_read_b128 v[60:63], v3 offset:34816
    s_waitcnt vmcnt(6) lgkmcnt(5)
    v_mfma_f32_16x16x32_bf16 v[24:27], v[64:67], v[136:139], v[24:27]
    v_mfma_f32_16x16x32_bf16 v[28:31], v[68:71], v[136:139], v[28:31]
    v_mfma_f32_16x16x32_bf16 v[32:35], v[72:75], v[136:139], v[32:35]
    v_mfma_f32_16x16x32_bf16 v[36:39], v[76:79], v[136:139], v[36:39]
    v_mfma_f32_16x16x32_bf16 v[40:43], v[80:83], v[136:139], v[40:43]
    ds_read_b128 v[64:67], v3 offset:35840
    ds_read_b128 v[68:71], v3 offset:36864
    ds_read_b128 v[72:75], v3 offset:37888
    ds_read_b128 v[76:79], v3 offset:38912
    ds_read_b128 v[80:83], v3 offset:39936
    s_waitcnt vmcnt(5) lgkmcnt(5)
    v_mfma_f32_16x16x32_bf16 v[24:27], v[44:47], v[140:143], v[24:27]
    v_mfma_f32_16x16x32_bf16 v[28:31], v[48:51], v[140:143], v[28:31]
    v_mfma_f32_16x16x32_bf16 v[32:35], v[52:55], v[140:143], v[32:35]
    v_mfma_f32_16x16x32_bf16 v[36:39], v[56:59], v[140:143], v[36:39]
    v_mfma_f32_16x16x32_bf16 v[40:43], v[60:63], v[140:143], v[40:43]
    s_barrier
    ds_read_b128 v[44:47], v1 offset:0
    ds_read_b128 v[48:51], v1 offset:1024
    ds_read_b128 v[52:55], v1 offset:2048
    ds_read_b128 v[56:59], v1 offset:3072
    ds_read_b128 v[60:63], v1 offset:4096
    s_waitcnt vmcnt(4) lgkmcnt(5)
    v_mfma_f32_16x16x32_bf16 v[24:27], v[64:67], v[144:147], v[24:27]
    v_mfma_f32_16x16x32_bf16 v[28:31], v[68:71], v[144:147], v[28:31]
    v_mfma_f32_16x16x32_bf16 v[32:35], v[72:75], v[144:147], v[32:35]
    v_mfma_f32_16x16x32_bf16 v[36:39], v[76:79], v[144:147], v[36:39]
    v_mfma_f32_16x16x32_bf16 v[40:43], v[80:83], v[144:147], v[40:43]
    ds_read_b128 v[64:67], v1 offset:5120
    ds_read_b128 v[68:71], v1 offset:6144
    ds_read_b128 v[72:75], v1 offset:7168
    ds_read_b128 v[76:79], v1 offset:8192
    ds_read_b128 v[80:83], v1 offset:9216
    s_waitcnt vmcnt(3) lgkmcnt(5)
    v_mfma_f32_16x16x32_bf16 v[24:27], v[44:47], v[148:151], v[24:27]
    v_mfma_f32_16x16x32_bf16 v[28:31], v[48:51], v[148:151], v[28:31]
    v_mfma_f32_16x16x32_bf16 v[32:35], v[52:55], v[148:151], v[32:35]
    v_mfma_f32_16x16x32_bf16 v[36:39], v[56:59], v[148:151], v[36:39]
    v_mfma_f32_16x16x32_bf16 v[40:43], v[60:63], v[148:151], v[40:43]
    ds_read_b128 v[44:47], v1 offset:10240
    ds_read_b128 v[48:51], v1 offset:11264
    ds_read_b128 v[52:55], v1 offset:12288
    ds_read_b128 v[56:59], v1 offset:13312
    ds_read_b128 v[60:63], v1 offset:14336
    s_waitcnt vmcnt(2) lgkmcnt(5)
    v_mfma_f32_16x16x32_bf16 v[24:27], v[64:67], v[152:155], v[24:27]
    v_mfma_f32_16x16x32_bf16 v[28:31], v[68:71], v[152:155], v[28:31]
    v_mfma_f32_16x16x32_bf16 v[32:35], v[72:75], v[152:155], v[32:35]
    v_mfma_f32_16x16x32_bf16 v[36:39], v[76:79], v[152:155], v[36:39]
    v_mfma_f32_16x16x32_bf16 v[40:43], v[80:83], v[152:155], v[40:43]
    ds_read_b128 v[64:67], v1 offset:15360
    ds_read_b128 v[68:71], v1 offset:16384
    ds_read_b128 v[72:75], v1 offset:17408
    ds_read_b128 v[76:79], v1 offset:18432
    ds_read_b128 v[80:83], v1 offset:19456
    s_waitcnt vmcnt(1) lgkmcnt(5)
    v_mfma_f32_16x16x32_bf16 v[24:27], v[44:47], v[156:159], v[24:27]
    v_mfma_f32_16x16x32_bf16 v[28:31], v[48:51], v[156:159], v[28:31]
    v_mfma_f32_16x16x32_bf16 v[32:35], v[52:55], v[156:159], v[32:35]
    v_mfma_f32_16x16x32_bf16 v[36:39], v[56:59], v[156:159], v[36:39]
    v_mfma_f32_16x16x32_bf16 v[40:43], v[60:63], v[156:159], v[40:43]
    s_waitcnt vmcnt(0) lgkmcnt(0)
    v_mfma_f32_16x16x32_bf16 v[24:27], v[64:67], v[160:163], v[24:27]
    v_mfma_f32_16x16x32_bf16 v[28:31], v[68:71], v[160:163], v[28:31]
    v_mfma_f32_16x16x32_bf16 v[32:35], v[72:75], v[160:163], v[32:35]
    v_mfma_f32_16x16x32_bf16 v[36:39], v[76:79], v[160:163], v[36:39]
    v_mfma_f32_16x16x32_bf16 v[40:43], v[80:83], v[160:163], v[40:43]
    v_lshlrev_b32 v4, 4, v8
    v_add_u32 v4, 148224, v4
    s_nop 7
    s_lshr_b32 s12, s42, 6
    s_cmp_lg_u32 s12, s44
    s_cbranch_scc1 L_k2_noupd0
    ds_read_b128 v[44:47], v4 offset:0
    ds_read_b128 v[48:51], v4 offset:64
    ds_read_b128 v[52:55], v4 offset:128
    ds_read_b128 v[56:59], v4 offset:192
    ds_read_b128 v[60:63], v4 offset:256
    v_cmp_eq_u32 vcc, s42, v11
    s_waitcnt lgkmcnt(0)
    s_nop 1
    v_cndmask_b32 v44, 0, v44, vcc
    v_add_f32 v24, v24, v44
    v_cndmask_b32 v45, 0, v45, vcc
    v_add_f32 v25, v25, v45
    v_cndmask_b32 v46, 0, v46, vcc
    v_add_f32 v26, v26, v46
    v_cndmask_b32 v47, 0, v47, vcc
    v_add_f32 v27, v27, v47
    v_cndmask_b32 v48, 0, v48, vcc
    v_add_f32 v28, v28, v48
    v_cndmask_b32 v49, 0, v49, vcc
    v_add_f32 v29, v29, v49
    v_cndmask_b32 v50, 0, v50, vcc
    v_add_f32 v30, v30, v50
    v_cndmask_b32 v51, 0, v51, vcc
    v_add_f32 v31, v31, v51
    v_cndmask_b32 v52, 0, v52, vcc
    v_add_f32 v32, v32, v52
    v_cndmask_b32 v53, 0, v53, vcc
    v_add_f32 v33, v33, v53
    v_cndmask_b32 v54, 0, v54, vcc
    v_add_f32 v34, v34, v54
    v_cndmask_b32 v55, 0, v55, vcc
    v_add_f32 v35, v35, v55
    v_cndmask_b32 v56, 0, v56, vcc
    v_add_f32 v36, v36, v56
    v_cndmask_b32 v57, 0, v57, vcc
    v_add_f32 v37, v37, v57
    v_cndmask_b32 v58, 0, v58, vcc
    v_add_f32 v38, v38, v58
    v_cndmask_b32 v59, 0, v59, vcc
    v_add_f32 v39, v39, v59
    v_cndmask_b32 v60, 0, v60, vcc
    v_add_f32 v40, v40, v60
    v_cndmask_b32 v61, 0, v61, vcc
    v_add_f32 v41, v41, v61
    v_cndmask_b32 v62, 0, v62, vcc
    v_add_f32 v42, v42, v62
    v_cndmask_b32 v63, 0, v63, vcc
    v_add_f32 v43, v43, v63
L_k2_noupd0:
    s_lshr_b32 s12, s43, 6
    s_cmp_lg_u32 s12, s44
    s_cbranch_scc1 L_k2_noupd1
    ds_read_b128 v[44:47], v4 offset:320
    ds_read_b128 v[48:51], v4 offset:384
    ds_read_b128 v[52:55], v4 offset:448
    ds_read_b128 v[56:59], v4 offset:512
    ds_read_b128 v[60:63], v4 offset:576
    v_cmp_eq_u32 vcc, s43, v11
    s_waitcnt lgkmcnt(0)
    s_nop 1
    v_cndmask_b32 v44, 0, v44, vcc
    v_add_f32 v24, v24, v44
    v_cndmask_b32 v45, 0, v45, vcc
    v_add_f32 v25, v25, v45
    v_cndmask_b32 v46, 0, v46, vcc
    v_add_f32 v26, v26, v46
    v_cndmask_b32 v47, 0, v47, vcc
    v_add_f32 v27, v27, v47
    v_cndmask_b32 v48, 0, v48, vcc
    v_add_f32 v28, v28, v48
    v_cndmask_b32 v49, 0, v49, vcc
    v_add_f32 v29, v29, v49
    v_cndmask_b32 v50, 0, v50, vcc
    v_add_f32 v30, v30, v50
    v_cndmask_b32 v51, 0, v51, vcc
    v_add_f32 v31, v31, v51
    v_cndmask_b32 v52, 0, v52, vcc
    v_add_f32 v32, v32, v52
    v_cndmask_b32 v53, 0, v53, vcc
    v_add_f32 v33, v33, v53
    v_cndmask_b32 v54, 0, v54, vcc
    v_add_f32 v34, v34, v54
    v_cndmask_b32 v55, 0, v55, vcc
    v_add_f32 v35, v35, v55
    v_cndmask_b32 v56, 0, v56, vcc
    v_add_f32 v36, v36, v56
    v_cndmask_b32 v57, 0, v57, vcc
    v_add_f32 v37, v37, v57
    v_cndmask_b32 v58, 0, v58, vcc
    v_add_f32 v38, v38, v58
    v_cndmask_b32 v59, 0, v59, vcc
    v_add_f32 v39, v39, v59
    v_cndmask_b32 v60, 0, v60, vcc
    v_add_f32 v40, v40, v60
    v_cndmask_b32 v61, 0, v61, vcc
    v_add_f32 v41, v41, v61
    v_cndmask_b32 v62, 0, v62, vcc
    v_add_f32 v42, v42, v62
    v_cndmask_b32 v63, 0, v63, vcc
    v_add_f32 v43, v43, v63
L_k2_noupd1:
    v_cvt_pk_bf16_f32 v14, v24, v25
    v_cvt_pk_bf16_f32 v15, v26, v27
    buffer_store_dwordx2 v[14:15], v10, s[60:63], 0 offen offset:0
    v_cvt_pk_bf16_f32 v16, v28, v29
    v_cvt_pk_bf16_f32 v17, v30, v31
    buffer_store_dwordx2 v[16:17], v10, s[60:63], 0 offen offset:32
    v_cvt_pk_bf16_f32 v18, v32, v33
    v_cvt_pk_bf16_f32 v19, v34, v35
    buffer_store_dwordx2 v[18:19], v10, s[60:63], 0 offen offset:64
    v_cvt_pk_bf16_f32 v20, v36, v37
    v_cvt_pk_bf16_f32 v21, v38, v39
    buffer_store_dwordx2 v[20:21], v10, s[60:63], 0 offen offset:96
    v_cvt_pk_bf16_f32 v22, v40, v41
    v_cvt_pk_bf16_f32 v23, v42, v43
    buffer_store_dwordx2 v[22:23], v10, s[60:63], 0 offen offset:128
    s_endpgm
L_k2_sync:
    s_lshl_b32 s12, s32, 8
    s_add_u32 s12, s12, 11821312
    v_mov_b32 v4, s12
    v_mov_b32 v5, 1
    s_mov_b64 exec, 1
    global_atomic_add v6, v4, v5, s[4:5] sc0
    s_waitcnt vmcnt(0)
    v_readfirstlane_b32 s14, v6
    s_mov_b32 s13, 1048576
    s_cmp_ge_u32 s14, 31
    s_cbranch_scc1 L_k2_poll_done
    global_load_dword v8, v4, s[4:5] sc1
    s_sleep 2
    global_load_dword v9, v4, s[4:5] sc1
    s_sleep 2
    global_load_dword v10, v4, s[4:5] sc1
    s_sleep 2
L_k2_poll:
    global_load_dword v11, v4, s[4:5] sc1
    s_waitcnt vmcnt(3)
    v_readfirstlane_b32 s14, v8
    s_sub_u32 s13, s13, 1
    s_cbranch_scc1 L_k2_poll_done
    s_cmp_ge_u32 s14, 32
    s_cbranch_scc1 L_k2_poll_done
    s_sleep 2
    global_load_dword v8, v4, s[4:5] sc1
    s_waitcnt vmcnt(3)
    v_readfirstlane_b32 s14, v9
    s_sub_u32 s13, s13, 1
    s_cbranch_scc1 L_k2_poll_done
    s_cmp_ge_u32 s14, 32
    s_cbranch_scc1 L_k2_poll_done
    s_sleep 2
    global_load_dword v9, v4, s[4:5] sc1
    s_waitcnt vmcnt(3)
    v_readfirstlane_b32 s14, v10
    s_sub_u32 s13, s13, 1
    s_cbranch_scc1 L_k2_poll_done
    s_cmp_ge_u32 s14, 32
    s_cbranch_scc1 L_k2_poll_done
    s_sleep 2
    global_load_dword v10, v4, s[4:5] sc1
    s_waitcnt vmcnt(3)
    v_readfirstlane_b32 s14, v11
    s_sub_u32 s13, s13, 1
    s_cbranch_scc1 L_k2_poll_done
    s_cmp_ge_u32 s14, 32
    s_cbranch_scc1 L_k2_poll_done
    s_sleep 2
    s_branch L_k2_poll
L_k2_poll_done:
    s_mov_b64 exec, -1
    s_barrier
    s_barrier
    s_endpgm
L_k2_side:
    s_cmp_ge_u32 s20, 8
    s_cbranch_scc1 L_k2_side_b
    s_sub_u32 s13, s20, 4
    s_mul_i32 s12, s45, 102400
    s_add_u32 s12, s12, 11084032
    s_mul_i32 s14, s13, 5120
    s_add_u32 s12, s12, s14
    s_mov_b32 m0, s14
    s_nop 0
    buffer_load_dwordx4 v1, s[8:11], s12 offen offset:0 lds
    buffer_load_dwordx4 v1, s[8:11], s12 offen offset:1024 lds
    buffer_load_dwordx4 v1, s[8:11], s12 offen offset:2048 lds
    buffer_load_dwordx4 v1, s[8:11], s12 offen offset:3072 lds
    s_add_u32 m0, s14, 4096
    s_add_u32 s12, s12, 4096
    buffer_load_dwordx4 v1, s[8:11], s12 offen lds
    s_waitcnt vmcnt(0)
L_k2_side_b:
    s_barrier
    s_barrier
    s_endpgm
L_k2_exit:
    s_endpgm
L_k2_end:
.section .rodata,"a"
.p2align 6
.amdhsa_kernel qkv_kernel
  .amdhsa_next_free_vgpr 152
  .amdhsa_next_free_sgpr 100
  .amdhsa_accum_offset 152
  .amdhsa_group_segment_fixed_size 0
  .amdhsa_kernarg_size 88
  .amdhsa_user_sgpr_count 2
  .amdhsa_user_sgpr_kernarg_segment_ptr 1
  .amdhsa_system_sgpr_workgroup_id_x 1
.end_amdhsa_kernel
.p2align 6
.amdhsa_kernel attn_proj_kernel
  .amdhsa_next_free_vgpr 168
  .amdhsa_next_free_sgpr 100
  .amdhsa_accum_offset 168
  .amdhsa_group_segment_fixed_size 0
  .amdhsa_kernarg_size 88
  .amdhsa_user_sgpr_count 2
  .amdhsa_user_sgpr_kernarg_segment_ptr 1
  .amdhsa_system_sgpr_workgroup_id_x 1
.end_amdhsa_kernel
```
